```python
import torch

def _softmax(x, axis=-1):
    return torch.softmax(x, dim=axis)
def _gelu(x):
    return torch.nn.functional.gelu(x, approximate="tanh")
def _silu(x):
    return torch.nn.functional.silu(x)
def _sigmoid(x):
    return torch.sigmoid(x)
def _layernorm(x, axis=-1, eps=1e-5):
    m = x.mean(dim=axis, keepdim=True)
    v = x.var(dim=axis, keepdim=True, unbiased=False)
    return (x - m) / torch.sqrt(v + eps)
def _scatter_add(tgt, idx, src, axis=0):
    return tgt.clone().index_add_(axis, idx, src)
def _segment_sum(src, seg, n):
    out = torch.zeros((n,) + src.shape[1:], dtype=src.dtype)
    return out.index_add_(0, seg, src)
def _pad(x, pw):
    flat = tuple(v for pair in reversed(pw) for v in pair)
    return torch.nn.functional.pad(x, flat)

kernel_name = 'standalone__mha_softmax__near_ridge'

def setup_inputs():

    _w = (lambda a: (lambda t: t.to(torch.bfloat16) if t.is_floating_point() else t)(torch.as_tensor(a)))
    B, H, Sq, Sk, D = 32, 16, 256, 256, 256
    return {
        "q": _w((lambda *s: torch.randn(*s, dtype=torch.bfloat16) * 0.8)(B, H, Sq, D)),
        "k": _w((lambda *s: torch.randn(*s, dtype=torch.bfloat16) * 0.8)(B, H, Sk, D)),
        "v": _w((lambda *s: torch.randn(*s, dtype=torch.bfloat16) * 0.05)(B, H, Sk, D)),
    }

def reference(q, k, v):
    scale = q.shape[-1] ** -0.5
    scores = torch.einsum("bhqd,bhkd->bhqk", q, k) * scale
    p = _softmax(scores, axis=-1)
    return torch.einsum("bhqk,bhkd->bhqd", p, v)
```

```asm
; @launch grid=(256,1,1) block=(256,1,1) lds=163840
.amdgcn_target "amdgcn-amd-amdhsa--gfx950"
.text
.globl standalone__mha_softmax__near_ridge_kernel
.p2align 8
.type standalone__mha_softmax__near_ridge_kernel,@function
standalone__mha_softmax__near_ridge_kernel:
s_load_dwordx8 s[4:11], s[0:1], 0
s_cmp_ge_u32 s2, 256
s_cbranch_scc1 L_end
v_lshrrev_b32 v248, 6, v0
v_and_b32 v249, 63, v0
v_readfirstlane_b32 s3, v248
s_nop 1
v_lshrrev_b32 v251, 3, v249
v_and_b32 v250, 6, v251
v_and_b32 v252, 7, v249
v_xor_b32 v250, v250, v252
v_lshlrev_b32 v250, 4, v250
v_bfe_u32 v252, v251, 0, 1
v_lshl_add_u32 v250, v252, 9, v250
v_bfe_u32 v252, v251, 1, 1
v_lshl_add_u32 v250, v252, 15, v250
v_bfe_u32 v252, v251, 2, 1
v_lshl_add_u32 v224, v252, 16, v250
s_lshl_b32 s37, s2, 17
s_lshl_b32 s39, s3, 10
s_lshl_b32 s36, s3, 10
s_add_u32 s40, s37, s36
s_lshl_b32 s36, s3, 10
s_add_u32 s42, s37, s36
s_mul_i32 s36, s2, 0x9e3779b1
s_lshr_b32 s36, s36, 8
s_and_b32 s36, s36, 0x7c00
s_xor_b32 s40, s40, s36
s_xor_b32 s42, s42, s36
s_getpc_b64 s[12:13]
L_pc:
s_lshr_b32 s36, s2, 3
s_and_b32 s36, s36, 31
s_lshl_b32 s36, s36, 11
v_and_b32 v250, 15, v0
v_lshl_add_u32 v250, v250, 7, s36
v_min_u32 v250, L_end-L_pc, v250
v_mov_b32 v251, s13
v_add_co_u32 v250, vcc, s12, v250
s_cmp_lg_u32 s3, 3
s_nop 0
v_addc_co_u32 v251, vcc, 0, v251, vcc
s_cbranch_scc1 L_nopf
global_load_dword v255, v[250:251], off
L_nopf:
s_waitcnt lgkmcnt(0)
s_mov_b32 s16, s4
s_and_b32 s17, s5, 0xffff
s_mov_b32 s18, 0x4000000
s_mov_b32 s19, 0x20000
s_xor_b32 s96, s40, 0
s_add_u32 m0, s39, 0
s_nop 0
buffer_load_dwordx4 v224, s[16:19], s96 offen nt lds
s_xor_b32 s96, s40, 8192
s_add_u32 m0, s39, 4096
s_nop 0
buffer_load_dwordx4 v224, s[16:19], s96 offen nt lds
s_xor_b32 s96, s40, 16384
s_add_u32 m0, s39, 8192
s_nop 0
buffer_load_dwordx4 v224, s[16:19], s96 offen nt lds
s_xor_b32 s96, s40, 24576
s_add_u32 m0, s39, 12288
s_nop 0
buffer_load_dwordx4 v224, s[16:19], s96 offen nt lds
s_xor_b32 s96, s40, 4096
s_add_u32 m0, s39, 16384
s_nop 0
buffer_load_dwordx4 v224, s[16:19], s96 offen nt lds
s_mov_b32 s20, s6
s_and_b32 s21, s7, 0xffff
s_mov_b32 s22, 0x4000000
s_mov_b32 s23, 0x20000
s_mov_b32 s24, s8
s_and_b32 s25, s9, 0xffff
s_mov_b32 s26, 0x4000000
s_mov_b32 s27, 0x20000
s_mov_b32 s28, s10
s_and_b32 s29, s11, 0xffff
s_mov_b32 s30, 0x4000000
s_mov_b32 s31, 0x20000
s_add_u32 s41, s40, 33554432
s_add_u32 s43, s42, 33554432
v_lshrrev_b32 v252, 4, v249
v_and_b32 v250, 6, v249
v_xor_b32 v250, v250, v252
v_lshlrev_b32 v250, 4, v250
v_and_b32 v251, 15, v249
v_lshl_add_u32 v225, v251, 7, v250
v_bfe_u32 v251, v249, 3, 1
v_lshlrev_b32 v251, 12, v251
v_and_b32 v253, 7, v249
v_lshl_add_u32 v251, v253, 7, v251
v_lshl_add_u32 v251, v248, 10, v251
v_add_u32 v226, v250, v251
v_lshrrev_b32 v250, 1, v252
v_xor_b32 v250, v250, v253
v_lshl_add_u32 v251, v250, 4, v251
v_and_b32 v250, 1, v252
v_lshl_add_u32 v228, v250, 3, v251
v_lshrrev_b32 v251, 2, v249
v_and_b32 v250, 6, v251
v_bfe_u32 v252, v249, 1, 1
v_xor_b32 v250, v250, v252
v_lshlrev_b32 v250, 4, v250
v_lshl_add_u32 v250, v251, 7, v250
v_and_b32 v252, 1, v249
v_lshl_add_u32 v227, v252, 3, v250
v_lshrrev_b32 v251, 3, v249
v_xor_b32 v250, v253, v251
v_lshlrev_b32 v250, 4, v250
v_bfe_u32 v252, v251, 0, 1
v_lshl_add_u32 v250, v252, 9, v250
v_bfe_u32 v252, v251, 1, 1
v_lshl_add_u32 v250, v252, 15, v250
v_bfe_u32 v252, v251, 2, 1
v_lshl_add_u32 v230, v252, 16, v250
v_lshlrev_b32 v250, 4, v249
v_lshl_add_u32 v229, v248, 10, v250
s_mov_b32 s34, 0x3db8aa3b
s_mov_b32 s35, s34
s_xor_b32 s96, s40, 12288
s_add_u32 m0, s39, 20480
s_waitcnt vmcnt(4)
buffer_load_dwordx4 v224, s[16:19], s96 offen nt lds
s_xor_b32 s96, s40, 20480
s_add_u32 m0, s39, 24576
s_waitcnt vmcnt(4)
buffer_load_dwordx4 v224, s[16:19], s96 offen nt lds
s_xor_b32 s96, s40, 28672
s_add_u32 m0, s39, 28672
s_waitcnt vmcnt(4)
buffer_load_dwordx4 v224, s[16:19], s96 offen nt lds
s_xor_b32 s96, s42, 0
s_add_u32 m0, s39, 32768
s_waitcnt vmcnt(4)
buffer_load_dwordx4 v224, s[20:23], s96 offen nt lds
s_xor_b32 s96, s42, 8192
s_add_u32 m0, s39, 36864
s_waitcnt vmcnt(4)
buffer_load_dwordx4 v224, s[20:23], s96 offen nt lds
s_xor_b32 s96, s42, 16384
s_add_u32 m0, s39, 40960
s_waitcnt vmcnt(4)
buffer_load_dwordx4 v224, s[20:23], s96 offen nt lds
s_xor_b32 s96, s42, 24576
s_add_u32 m0, s39, 45056
s_waitcnt vmcnt(4)
buffer_load_dwordx4 v224, s[20:23], s96 offen nt lds
s_xor_b32 s96, s42, 4096
s_add_u32 m0, s39, 49152
s_waitcnt vmcnt(4)
buffer_load_dwordx4 v224, s[20:23], s96 offen nt lds
v_add_u32 v236, 0, v226
v_xor_b32 v237, 64, v236
ds_read_b128 v[192:195], v236 offset:0
ds_read_b128 v[196:199], v237 offset:0
ds_read_b128 v[200:203], v236 offset:8192
ds_read_b128 v[204:207], v237 offset:8192
ds_read_b128 v[208:211], v236 offset:16384
ds_read_b128 v[212:215], v237 offset:16384
ds_read_b128 v[216:219], v236 offset:24576
ds_read_b128 v[220:223], v237 offset:24576
s_waitcnt vmcnt(4)
s_xor_b32 s96, s42, 12288
s_add_u32 m0, s39, 53248
s_nop 0
buffer_load_dwordx4 v224, s[20:23], s96 offen nt lds
s_waitcnt lgkmcnt(0)
s_barrier
v_add_u32 v232, 32768, v225
v_xor_b32 v233, 64, v232
ds_read_b128 a[96:99], v232 offset:0
ds_read_b128 a[100:103], v233 offset:0
ds_read_b128 a[104:107], v232 offset:2048
ds_read_b128 a[108:111], v233 offset:2048
s_waitcnt lgkmcnt(2)
v_mfma_f32_16x16x32_bf16 v[0:3], a[96:99], v[192:195], 0
s_xor_b32 s96, s42, 20480
s_add_u32 m0, s39, 57344
s_waitcnt vmcnt(4)
buffer_load_dwordx4 v224, s[20:23], s96 offen nt lds
s_waitcnt vmcnt(4)
s_xor_b32 s96, s42, 28672
s_add_u32 m0, s39, 61440
s_nop 0
buffer_load_dwordx4 v224, s[20:23], s96 offen nt lds
s_barrier
ds_read_b128 a[112:115], v232 offset:4096
v_mfma_f32_16x16x32_bf16 v[0:3], a[100:103], v[196:199], v[0:3]
ds_read_b128 a[116:119], v233 offset:4096
v_mfma_f32_16x16x32_bf16 v[64:67], a[96:99], v[200:203], 0
v_mfma_f32_16x16x32_bf16 v[64:67], a[100:103], v[204:207], v[64:67]
v_mfma_f32_16x16x32_bf16 v[128:131], a[96:99], v[208:211], 0
v_mfma_f32_16x16x32_bf16 v[128:131], a[100:103], v[212:215], v[128:131]
v_mfma_f32_16x16x32_bf16 a[0:3], a[96:99], v[216:219], 0
v_mfma_f32_16x16x32_bf16 a[0:3], a[100:103], v[220:223], a[0:3]
s_xor_b32 s96, s40, 128
s_add_u32 m0, s39, 65536
s_waitcnt vmcnt(4)
buffer_load_dwordx4 v224, s[16:19], s96 offen nt lds
s_waitcnt lgkmcnt(2)
v_mfma_f32_16x16x32_bf16 v[4:7], a[104:107], v[192:195], 0
ds_read_b128 a[120:123], v232 offset:6144
v_mfma_f32_16x16x32_bf16 v[4:7], a[108:111], v[196:199], v[4:7]
ds_read_b128 a[124:127], v233 offset:6144
v_mfma_f32_16x16x32_bf16 v[68:71], a[104:107], v[200:203], 0
v_mfma_f32_16x16x32_bf16 v[68:71], a[108:111], v[204:207], v[68:71]
v_mfma_f32_16x16x32_bf16 v[132:135], a[104:107], v[208:211], 0
v_mfma_f32_16x16x32_bf16 v[132:135], a[108:111], v[212:215], v[132:135]
v_mfma_f32_16x16x32_bf16 a[4:7], a[104:107], v[216:219], 0
s_xor_b32 s96, s40, 8320
s_add_u32 m0, s39, 69632
s_waitcnt vmcnt(4)
buffer_load_dwordx4 v224, s[16:19], s96 offen nt lds
v_mfma_f32_16x16x32_bf16 a[4:7], a[108:111], v[220:223], a[4:7]
s_waitcnt lgkmcnt(2)
v_mfma_f32_16x16x32_bf16 v[8:11], a[112:115], v[192:195], 0
ds_read_b128 a[96:99], v232 offset:8192
v_mfma_f32_16x16x32_bf16 v[8:11], a[116:119], v[196:199], v[8:11]
ds_read_b128 a[100:103], v233 offset:8192
v_mfma_f32_16x16x32_bf16 v[72:75], a[112:115], v[200:203], 0
v_mfma_f32_16x16x32_bf16 v[72:75], a[116:119], v[204:207], v[72:75]
v_mfma_f32_16x16x32_bf16 v[136:139], a[112:115], v[208:211], 0
v_mfma_f32_16x16x32_bf16 v[136:139], a[116:119], v[212:215], v[136:139]
s_xor_b32 s96, s40, 16512
s_add_u32 m0, s39, 73728
s_waitcnt vmcnt(4)
buffer_load_dwordx4 v224, s[16:19], s96 offen nt lds
v_mfma_f32_16x16x32_bf16 a[8:11], a[112:115], v[216:219], 0
v_mfma_f32_16x16x32_bf16 a[8:11], a[116:119], v[220:223], a[8:11]
s_waitcnt lgkmcnt(2)
v_mfma_f32_16x16x32_bf16 v[12:15], a[120:123], v[192:195], 0
ds_read_b128 a[104:107], v232 offset:10240
v_mfma_f32_16x16x32_bf16 v[12:15], a[124:127], v[196:199], v[12:15]
ds_read_b128 a[108:111], v233 offset:10240
v_mfma_f32_16x16x32_bf16 v[76:79], a[120:123], v[200:203], 0
v_mfma_f32_16x16x32_bf16 v[76:79], a[124:127], v[204:207], v[76:79]
v_mfma_f32_16x16x32_bf16 v[140:143], a[120:123], v[208:211], 0
s_xor_b32 s96, s40, 24704
s_add_u32 m0, s39, 77824
s_waitcnt vmcnt(4)
buffer_load_dwordx4 v224, s[16:19], s96 offen nt lds
v_mfma_f32_16x16x32_bf16 v[140:143], a[124:127], v[212:215], v[140:143]
v_mfma_f32_16x16x32_bf16 a[12:15], a[120:123], v[216:219], 0
v_mfma_f32_16x16x32_bf16 a[12:15], a[124:127], v[220:223], a[12:15]
s_waitcnt lgkmcnt(2)
v_mfma_f32_16x16x32_bf16 v[16:19], a[96:99], v[192:195], 0
s_waitcnt vmcnt(4)
s_barrier
ds_read_b128 a[112:115], v232 offset:12288
v_mfma_f32_16x16x32_bf16 v[16:19], a[100:103], v[196:199], v[16:19]
ds_read_b128 a[116:119], v233 offset:12288
v_mfma_f32_16x16x32_bf16 v[80:83], a[96:99], v[200:203], 0
v_mfma_f32_16x16x32_bf16 v[80:83], a[100:103], v[204:207], v[80:83]
s_xor_b32 s96, s40, 4224
s_add_u32 m0, s39, 81920
s_nop 0
buffer_load_dwordx4 v224, s[16:19], s96 offen nt lds
v_mfma_f32_16x16x32_bf16 v[144:147], a[96:99], v[208:211], 0
v_mfma_f32_16x16x32_bf16 v[144:147], a[100:103], v[212:215], v[144:147]
v_mfma_f32_16x16x32_bf16 a[16:19], a[96:99], v[216:219], 0
v_mfma_f32_16x16x32_bf16 a[16:19], a[100:103], v[220:223], a[16:19]
s_waitcnt lgkmcnt(2)
v_mfma_f32_16x16x32_bf16 v[20:23], a[104:107], v[192:195], 0
ds_read_b128 a[120:123], v232 offset:14336
v_mfma_f32_16x16x32_bf16 v[20:23], a[108:111], v[196:199], v[20:23]
ds_read_b128 a[124:127], v233 offset:14336
v_mfma_f32_16x16x32_bf16 v[84:87], a[104:107], v[200:203], 0
s_xor_b32 s96, s40, 12416
s_add_u32 m0, s39, 86016
s_waitcnt vmcnt(4)
buffer_load_dwordx4 v224, s[16:19], s96 offen nt lds
v_mfma_f32_16x16x32_bf16 v[84:87], a[108:111], v[204:207], v[84:87]
v_mfma_f32_16x16x32_bf16 v[148:151], a[104:107], v[208:211], 0
v_mfma_f32_16x16x32_bf16 v[148:151], a[108:111], v[212:215], v[148:151]
v_mfma_f32_16x16x32_bf16 a[20:23], a[104:107], v[216:219], 0
v_mfma_f32_16x16x32_bf16 a[20:23], a[108:111], v[220:223], a[20:23]
s_waitcnt lgkmcnt(2)
v_mfma_f32_16x16x32_bf16 v[24:27], a[112:115], v[192:195], 0
ds_read_b128 a[96:99], v232 offset:16384
v_mfma_f32_16x16x32_bf16 v[24:27], a[116:119], v[196:199], v[24:27]
s_xor_b32 s96, s40, 20608
s_add_u32 m0, s39, 90112
s_waitcnt vmcnt(4)
buffer_load_dwordx4 v224, s[16:19], s96 offen nt lds
ds_read_b128 a[100:103], v233 offset:16384
v_mfma_f32_16x16x32_bf16 v[88:91], a[112:115], v[200:203], 0
v_mfma_f32_16x16x32_bf16 v[88:91], a[116:119], v[204:207], v[88:91]
v_mfma_f32_16x16x32_bf16 v[152:155], a[112:115], v[208:211], 0
v_mfma_f32_16x16x32_bf16 v[152:155], a[116:119], v[212:215], v[152:155]
v_mfma_f32_16x16x32_bf16 a[24:27], a[112:115], v[216:219], 0
v_mfma_f32_16x16x32_bf16 a[24:27], a[116:119], v[220:223], a[24:27]
s_xor_b32 s96, s40, 28800
s_add_u32 m0, s39, 94208
s_waitcnt vmcnt(4)
buffer_load_dwordx4 v224, s[16:19], s96 offen nt lds
s_waitcnt lgkmcnt(2)
v_mfma_f32_16x16x32_bf16 v[28:31], a[120:123], v[192:195], 0
ds_read_b128 a[104:107], v232 offset:18432
v_mfma_f32_16x16x32_bf16 v[28:31], a[124:127], v[196:199], v[28:31]
ds_read_b128 a[108:111], v233 offset:18432
v_mfma_f32_16x16x32_bf16 v[92:95], a[120:123], v[200:203], 0
v_mfma_f32_16x16x32_bf16 v[92:95], a[124:127], v[204:207], v[92:95]
v_mfma_f32_16x16x32_bf16 v[156:159], a[120:123], v[208:211], 0
v_mfma_f32_16x16x32_bf16 v[156:159], a[124:127], v[212:215], v[156:159]
v_mfma_f32_16x16x32_bf16 a[28:31], a[120:123], v[216:219], 0
s_xor_b32 s96, s42, 128
s_add_u32 m0, s39, 98304
s_waitcnt vmcnt(4)
buffer_load_dwordx4 v224, s[20:23], s96 offen nt lds
v_mfma_f32_16x16x32_bf16 a[28:31], a[124:127], v[220:223], a[28:31]
s_waitcnt lgkmcnt(2)
v_mfma_f32_16x16x32_bf16 v[32:35], a[96:99], v[192:195], 0
ds_read_b128 a[112:115], v232 offset:20480
v_mfma_f32_16x16x32_bf16 v[32:35], a[100:103], v[196:199], v[32:35]
ds_read_b128 a[116:119], v233 offset:20480
v_mfma_f32_16x16x32_bf16 v[96:99], a[96:99], v[200:203], 0
v_mfma_f32_16x16x32_bf16 v[96:99], a[100:103], v[204:207], v[96:99]
v_mfma_f32_16x16x32_bf16 v[160:163], a[96:99], v[208:211], 0
v_mfma_f32_16x16x32_bf16 v[160:163], a[100:103], v[212:215], v[160:163]
s_xor_b32 s96, s42, 8320
s_add_u32 m0, s39, 102400
s_waitcnt vmcnt(4)
buffer_load_dwordx4 v224, s[20:23], s96 offen nt lds
v_mfma_f32_16x16x32_bf16 a[32:35], a[96:99], v[216:219], 0
v_mfma_f32_16x16x32_bf16 a[32:35], a[100:103], v[220:223], a[32:35]
s_waitcnt lgkmcnt(2)
v_mfma_f32_16x16x32_bf16 v[36:39], a[104:107], v[192:195], 0
ds_read_b128 a[120:123], v232 offset:22528
v_mfma_f32_16x16x32_bf16 v[36:39], a[108:111], v[196:199], v[36:39]
ds_read_b128 a[124:127], v233 offset:22528
v_mfma_f32_16x16x32_bf16 v[100:103], a[104:107], v[200:203], 0
v_mfma_f32_16x16x32_bf16 v[100:103], a[108:111], v[204:207], v[100:103]
v_mfma_f32_16x16x32_bf16 v[164:167], a[104:107], v[208:211], 0
s_xor_b32 s96, s42, 16512
s_add_u32 m0, s39, 106496
s_waitcnt vmcnt(4)
buffer_load_dwordx4 v224, s[20:23], s96 offen nt lds
v_mfma_f32_16x16x32_bf16 v[164:167], a[108:111], v[212:215], v[164:167]
v_mfma_f32_16x16x32_bf16 a[36:39], a[104:107], v[216:219], 0
v_mfma_f32_16x16x32_bf16 a[36:39], a[108:111], v[220:223], a[36:39]
s_waitcnt lgkmcnt(2)
v_mfma_f32_16x16x32_bf16 v[40:43], a[112:115], v[192:195], 0
ds_read_b128 a[96:99], v232 offset:24576
v_mfma_f32_16x16x32_bf16 v[40:43], a[116:119], v[196:199], v[40:43]
ds_read_b128 a[100:103], v233 offset:24576
v_mfma_f32_16x16x32_bf16 v[104:107], a[112:115], v[200:203], 0
v_mfma_f32_16x16x32_bf16 v[104:107], a[116:119], v[204:207], v[104:107]
s_xor_b32 s96, s42, 24704
s_add_u32 m0, s39, 110592
s_waitcnt vmcnt(4)
buffer_load_dwordx4 v224, s[20:23], s96 offen nt lds
v_mfma_f32_16x16x32_bf16 v[168:171], a[112:115], v[208:211], 0
v_mfma_f32_16x16x32_bf16 v[168:171], a[116:119], v[212:215], v[168:171]
v_mfma_f32_16x16x32_bf16 a[40:43], a[112:115], v[216:219], 0
v_mfma_f32_16x16x32_bf16 a[40:43], a[116:119], v[220:223], a[40:43]
s_waitcnt lgkmcnt(2)
v_mfma_f32_16x16x32_bf16 v[44:47], a[120:123], v[192:195], 0
ds_read_b128 a[104:107], v232 offset:26624
v_mfma_f32_16x16x32_bf16 v[44:47], a[124:127], v[196:199], v[44:47]
ds_read_b128 a[108:111], v233 offset:26624
v_mfma_f32_16x16x32_bf16 v[108:111], a[120:123], v[200:203], 0
s_xor_b32 s96, s42, 4224
s_add_u32 m0, s39, 114688
s_waitcnt vmcnt(4)
buffer_load_dwordx4 v224, s[20:23], s96 offen nt lds
v_mfma_f32_16x16x32_bf16 v[108:111], a[124:127], v[204:207], v[108:111]
v_add_u32 v236, 65536, v226
v_xor_b32 v237, 64, v236
ds_read_b128 a[64:67], v236 offset:0
ds_read_b128 a[68:71], v237 offset:0
ds_read_b128 a[72:75], v236 offset:8192
ds_read_b128 a[76:79], v237 offset:8192
ds_read_b128 a[80:83], v236 offset:16384
ds_read_b128 a[84:87], v237 offset:16384
ds_read_b128 a[88:91], v236 offset:24576
ds_read_b128 a[92:95], v237 offset:24576
v_mfma_f32_16x16x32_bf16 v[172:175], a[120:123], v[208:211], 0
v_mfma_f32_16x16x32_bf16 v[172:175], a[124:127], v[212:215], v[172:175]
v_mfma_f32_16x16x32_bf16 a[44:47], a[120:123], v[216:219], 0
v_mfma_f32_16x16x32_bf16 a[44:47], a[124:127], v[220:223], a[44:47]
s_waitcnt lgkmcnt(10)
v_mfma_f32_16x16x32_bf16 v[48:51], a[96:99], v[192:195], 0
ds_read_b128 a[112:115], v232 offset:28672
v_mfma_f32_16x16x32_bf16 v[48:51], a[100:103], v[196:199], v[48:51]
s_xor_b32 s96, s42, 12416
s_add_u32 m0, s39, 118784
s_waitcnt vmcnt(4)
buffer_load_dwordx4 v224, s[20:23], s96 offen nt lds
ds_read_b128 a[116:119], v233 offset:28672
v_mfma_f32_16x16x32_bf16 v[112:115], a[96:99], v[200:203], 0
v_mfma_f32_16x16x32_bf16 v[112:115], a[100:103], v[204:207], v[112:115]
v_mfma_f32_16x16x32_bf16 v[176:179], a[96:99], v[208:211], 0
v_mfma_f32_16x16x32_bf16 v[176:179], a[100:103], v[212:215], v[176:179]
v_mfma_f32_16x16x32_bf16 a[48:51], a[96:99], v[216:219], 0
v_mfma_f32_16x16x32_bf16 a[48:51], a[100:103], v[220:223], a[48:51]
s_waitcnt lgkmcnt(10)
v_mfma_f32_16x16x32_bf16 v[52:55], a[104:107], v[192:195], 0
s_xor_b32 s96, s42, 20608
s_add_u32 m0, s39, 122880
s_waitcnt vmcnt(4)
buffer_load_dwordx4 v224, s[20:23], s96 offen nt lds
ds_read_b128 a[120:123], v232 offset:30720
v_mfma_f32_16x16x32_bf16 v[52:55], a[108:111], v[196:199], v[52:55]
ds_read_b128 a[124:127], v233 offset:30720
v_mfma_f32_16x16x32_bf16 v[116:119], a[104:107], v[200:203], 0
v_mfma_f32_16x16x32_bf16 v[116:119], a[108:111], v[204:207], v[116:119]
v_mfma_f32_16x16x32_bf16 v[180:183], a[104:107], v[208:211], 0
v_mfma_f32_16x16x32_bf16 v[180:183], a[108:111], v[212:215], v[180:183]
v_mfma_f32_16x16x32_bf16 a[52:55], a[104:107], v[216:219], 0
s_xor_b32 s96, s42, 28800
s_add_u32 m0, s39, 126976
s_waitcnt vmcnt(4)
buffer_load_dwordx4 v224, s[20:23], s96 offen nt lds
v_mfma_f32_16x16x32_bf16 a[52:55], a[108:111], v[220:223], a[52:55]
s_waitcnt lgkmcnt(2)
v_mfma_f32_16x16x32_bf16 v[56:59], a[112:115], v[192:195], 0
s_waitcnt lgkmcnt(0)
s_barrier
v_add_u32 v232, 98304, v225
v_xor_b32 v233, 64, v232
ds_read_b128 a[96:99], v232 offset:0
v_mfma_f32_16x16x32_bf16 v[56:59], a[116:119], v[196:199], v[56:59]
ds_read_b128 a[100:103], v233 offset:0
v_mfma_f32_16x16x32_bf16 v[120:123], a[112:115], v[200:203], 0
v_mfma_f32_16x16x32_bf16 v[120:123], a[116:119], v[204:207], v[120:123]
v_mfma_f32_16x16x32_bf16 v[184:187], a[112:115], v[208:211], 0
v_mfma_f32_16x16x32_bf16 v[184:187], a[116:119], v[212:215], v[184:187]
s_xor_b32 s96, s40, 256
s_add_u32 m0, s39, 131072
s_waitcnt vmcnt(4)
buffer_load_dwordx4 v224, s[16:19], s96 offen nt lds
v_mfma_f32_16x16x32_bf16 a[56:59], a[112:115], v[216:219], 0
v_mfma_f32_16x16x32_bf16 a[56:59], a[116:119], v[220:223], a[56:59]
v_mfma_f32_16x16x32_bf16 v[60:63], a[120:123], v[192:195], 0
ds_read_b128 a[104:107], v232 offset:2048
v_mfma_f32_16x16x32_bf16 v[60:63], a[124:127], v[196:199], v[60:63]
ds_read_b128 a[108:111], v233 offset:2048
v_mfma_f32_16x16x32_bf16 v[124:127], a[120:123], v[200:203], 0
v_mfma_f32_16x16x32_bf16 v[124:127], a[124:127], v[204:207], v[124:127]
v_mfma_f32_16x16x32_bf16 v[188:191], a[120:123], v[208:211], 0
s_xor_b32 s96, s40, 8448
s_add_u32 m0, s39, 135168
s_waitcnt vmcnt(4)
buffer_load_dwordx4 v224, s[16:19], s96 offen nt lds
v_mfma_f32_16x16x32_bf16 v[188:191], a[124:127], v[212:215], v[188:191]
v_mfma_f32_16x16x32_bf16 a[60:63], a[120:123], v[216:219], 0
v_mfma_f32_16x16x32_bf16 a[60:63], a[124:127], v[220:223], a[60:63]
s_waitcnt lgkmcnt(2)
v_mfma_f32_16x16x32_bf16 v[0:3], a[96:99], a[64:67], v[0:3]
ds_read_b128 a[112:115], v232 offset:4096
v_mfma_f32_16x16x32_bf16 v[0:3], a[100:103], a[68:71], v[0:3]
ds_read_b128 a[116:119], v233 offset:4096
v_mfma_f32_16x16x32_bf16 v[64:67], a[96:99], a[72:75], v[64:67]
v_mfma_f32_16x16x32_bf16 v[64:67], a[100:103], a[76:79], v[64:67]
v_mfma_f32_16x16x32_bf16 v[128:131], a[96:99], a[80:83], v[128:131]
s_xor_b32 s96, s40, 16640
s_add_u32 m0, s39, 139264
s_waitcnt vmcnt(4)
buffer_load_dwordx4 v224, s[16:19], s96 offen nt lds
v_mfma_f32_16x16x32_bf16 v[128:131], a[100:103], a[84:87], v[128:131]
v_mfma_f32_16x16x32_bf16 a[0:3], a[96:99], a[88:91], a[0:3]
v_mfma_f32_16x16x32_bf16 a[0:3], a[100:103], a[92:95], a[0:3]
s_waitcnt lgkmcnt(2)
v_mfma_f32_16x16x32_bf16 v[4:7], a[104:107], a[64:67], v[4:7]
ds_read_b128 a[120:123], v232 offset:6144
v_mfma_f32_16x16x32_bf16 v[4:7], a[108:111], a[68:71], v[4:7]
ds_read_b128 a[124:127], v233 offset:6144
v_mfma_f32_16x16x32_bf16 v[68:71], a[104:107], a[72:75], v[68:71]
v_mfma_f32_16x16x32_bf16 v[68:71], a[108:111], a[76:79], v[68:71]
s_xor_b32 s96, s40, 24832
s_add_u32 m0, s39, 143360
s_waitcnt vmcnt(4)
buffer_load_dwordx4 v224, s[16:19], s96 offen nt lds
v_mfma_f32_16x16x32_bf16 v[132:135], a[104:107], a[80:83], v[132:135]
v_mfma_f32_16x16x32_bf16 v[132:135], a[108:111], a[84:87], v[132:135]
v_mfma_f32_16x16x32_bf16 a[4:7], a[104:107], a[88:91], a[4:7]
v_mfma_f32_16x16x32_bf16 a[4:7], a[108:111], a[92:95], a[4:7]
s_waitcnt lgkmcnt(2)
v_mfma_f32_16x16x32_bf16 v[8:11], a[112:115], a[64:67], v[8:11]
ds_read_b128 a[96:99], v232 offset:8192
v_mfma_f32_16x16x32_bf16 v[8:11], a[116:119], a[68:71], v[8:11]
ds_read_b128 a[100:103], v233 offset:8192
v_mfma_f32_16x16x32_bf16 v[72:75], a[112:115], a[72:75], v[72:75]
s_xor_b32 s96, s40, 4352
s_add_u32 m0, s39, 147456
s_waitcnt vmcnt(4)
buffer_load_dwordx4 v224, s[16:19], s96 offen nt lds
v_mfma_f32_16x16x32_bf16 v[72:75], a[116:119], a[76:79], v[72:75]
v_mfma_f32_16x16x32_bf16 v[136:139], a[112:115], a[80:83], v[136:139]
v_mfma_f32_16x16x32_bf16 v[136:139], a[116:119], a[84:87], v[136:139]
v_mfma_f32_16x16x32_bf16 a[8:11], a[112:115], a[88:91], a[8:11]
v_mfma_f32_16x16x32_bf16 a[8:11], a[116:119], a[92:95], a[8:11]
s_waitcnt lgkmcnt(2)
v_mfma_f32_16x16x32_bf16 v[12:15], a[120:123], a[64:67], v[12:15]
ds_read_b128 a[104:107], v232 offset:10240
v_mfma_f32_16x16x32_bf16 v[12:15], a[124:127], a[68:71], v[12:15]
ds_read_b128 a[108:111], v233 offset:10240
v_mfma_f32_16x16x32_bf16 v[76:79], a[120:123], a[72:75], v[76:79]
s_xor_b32 s96, s40, 12544
s_add_u32 m0, s39, 151552
s_waitcnt vmcnt(4)
buffer_load_dwordx4 v224, s[16:19], s96 offen nt lds
v_mfma_f32_16x16x32_bf16 v[76:79], a[124:127], a[76:79], v[76:79]
v_mfma_f32_16x16x32_bf16 v[140:143], a[120:123], a[80:83], v[140:143]
v_mfma_f32_16x16x32_bf16 v[140:143], a[124:127], a[84:87], v[140:143]
v_mfma_f32_16x16x32_bf16 a[12:15], a[120:123], a[88:91], a[12:15]
v_mfma_f32_16x16x32_bf16 a[12:15], a[124:127], a[92:95], a[12:15]
s_waitcnt lgkmcnt(2)
v_mfma_f32_16x16x32_bf16 v[16:19], a[96:99], a[64:67], v[16:19]
s_barrier
ds_read_b128 a[112:115], v232 offset:12288
v_mfma_f32_16x16x32_bf16 v[16:19], a[100:103], a[68:71], v[16:19]
s_xor_b32 s96, s40, 20736
s_add_u32 m0, s39, 155648
s_waitcnt vmcnt(4)
buffer_load_dwordx4 v224, s[16:19], s96 offen nt lds
ds_read_b128 a[116:119], v233 offset:12288
v_mfma_f32_16x16x32_bf16 v[80:83], a[96:99], a[72:75], v[80:83]
v_mfma_f32_16x16x32_bf16 v[80:83], a[100:103], a[76:79], v[80:83]
v_mfma_f32_16x16x32_bf16 v[144:147], a[96:99], a[80:83], v[144:147]
v_mfma_f32_16x16x32_bf16 v[144:147], a[100:103], a[84:87], v[144:147]
v_mfma_f32_16x16x32_bf16 a[16:19], a[96:99], a[88:91], a[16:19]
v_mfma_f32_16x16x32_bf16 a[16:19], a[100:103], a[92:95], a[16:19]
s_waitcnt lgkmcnt(2)
v_mfma_f32_16x16x32_bf16 v[20:23], a[104:107], a[64:67], v[20:23]
s_xor_b32 s96, s40, 28928
s_add_u32 m0, s39, 159744
s_waitcnt vmcnt(4)
buffer_load_dwordx4 v224, s[16:19], s96 offen nt lds
ds_read_b128 a[120:123], v232 offset:14336
v_mfma_f32_16x16x32_bf16 v[20:23], a[108:111], a[68:71], v[20:23]
ds_read_b128 a[124:127], v233 offset:14336
v_mfma_f32_16x16x32_bf16 v[84:87], a[104:107], a[72:75], v[84:87]
v_mfma_f32_16x16x32_bf16 v[84:87], a[108:111], a[76:79], v[84:87]
v_mfma_f32_16x16x32_bf16 v[148:151], a[104:107], a[80:83], v[148:151]
v_mfma_f32_16x16x32_bf16 v[148:151], a[108:111], a[84:87], v[148:151]
v_mfma_f32_16x16x32_bf16 a[20:23], a[104:107], a[88:91], a[20:23]
v_mfma_f32_16x16x32_bf16 a[20:23], a[108:111], a[92:95], a[20:23]
s_waitcnt lgkmcnt(2)
v_mfma_f32_16x16x32_bf16 v[24:27], a[112:115], a[64:67], v[24:27]
s_xor_b32 s96, s42, 256
s_add_u32 m0, s39, 0
s_waitcnt vmcnt(4)
buffer_load_dwordx4 v224, s[20:23], s96 offen nt lds
ds_read_b128 a[96:99], v232 offset:16384
v_mfma_f32_16x16x32_bf16 v[24:27], a[116:119], a[68:71], v[24:27]
ds_read_b128 a[100:103], v233 offset:16384
v_mfma_f32_16x16x32_bf16 v[88:91], a[112:115], a[72:75], v[88:91]
v_mfma_f32_16x16x32_bf16 v[88:91], a[116:119], a[76:79], v[88:91]
v_mfma_f32_16x16x32_bf16 v[152:155], a[112:115], a[80:83], v[152:155]
v_mfma_f32_16x16x32_bf16 v[152:155], a[116:119], a[84:87], v[152:155]
v_mfma_f32_16x16x32_bf16 a[24:27], a[112:115], a[88:91], a[24:27]
v_mfma_f32_16x16x32_bf16 a[24:27], a[116:119], a[92:95], a[24:27]
s_xor_b32 s96, s42, 8448
s_add_u32 m0, s39, 4096
s_waitcnt vmcnt(4)
buffer_load_dwordx4 v224, s[20:23], s96 offen nt lds
s_waitcnt lgkmcnt(2)
v_mfma_f32_16x16x32_bf16 v[28:31], a[120:123], a[64:67], v[28:31]
ds_read_b128 a[104:107], v232 offset:18432
v_mfma_f32_16x16x32_bf16 v[28:31], a[124:127], a[68:71], v[28:31]
ds_read_b128 a[108:111], v233 offset:18432
v_mfma_f32_16x16x32_bf16 v[92:95], a[120:123], a[72:75], v[92:95]
v_mfma_f32_16x16x32_bf16 v[92:95], a[124:127], a[76:79], v[92:95]
v_mfma_f32_16x16x32_bf16 v[156:159], a[120:123], a[80:83], v[156:159]
v_mfma_f32_16x16x32_bf16 v[156:159], a[124:127], a[84:87], v[156:159]
v_mfma_f32_16x16x32_bf16 a[28:31], a[120:123], a[88:91], a[28:31]
v_mfma_f32_16x16x32_bf16 a[28:31], a[124:127], a[92:95], a[28:31]
s_xor_b32 s96, s42, 16640
s_add_u32 m0, s39, 8192
s_waitcnt vmcnt(4)
buffer_load_dwordx4 v224, s[20:23], s96 offen nt lds
s_waitcnt lgkmcnt(2)
v_mfma_f32_16x16x32_bf16 v[32:35], a[96:99], a[64:67], v[32:35]
ds_read_b128 a[112:115], v232 offset:20480
v_mfma_f32_16x16x32_bf16 v[32:35], a[100:103], a[68:71], v[32:35]
ds_read_b128 a[116:119], v233 offset:20480
v_mfma_f32_16x16x32_bf16 v[96:99], a[96:99], a[72:75], v[96:99]
v_mfma_f32_16x16x32_bf16 v[96:99], a[100:103], a[76:79], v[96:99]
v_mfma_f32_16x16x32_bf16 v[160:163], a[96:99], a[80:83], v[160:163]
v_mfma_f32_16x16x32_bf16 v[160:163], a[100:103], a[84:87], v[160:163]
v_mfma_f32_16x16x32_bf16 a[32:35], a[96:99], a[88:91], a[32:35]
s_xor_b32 s96, s42, 24832
s_add_u32 m0, s39, 12288
s_waitcnt vmcnt(4)
buffer_load_dwordx4 v224, s[20:23], s96 offen nt lds
v_mfma_f32_16x16x32_bf16 a[32:35], a[100:103], a[92:95], a[32:35]
s_waitcnt lgkmcnt(2)
v_mfma_f32_16x16x32_bf16 v[36:39], a[104:107], a[64:67], v[36:39]
ds_read_b128 a[120:123], v232 offset:22528
v_mfma_f32_16x16x32_bf16 v[36:39], a[108:111], a[68:71], v[36:39]
ds_read_b128 a[124:127], v233 offset:22528
v_mfma_f32_16x16x32_bf16 v[100:103], a[104:107], a[72:75], v[100:103]
v_mfma_f32_16x16x32_bf16 v[100:103], a[108:111], a[76:79], v[100:103]
v_mfma_f32_16x16x32_bf16 v[164:167], a[104:107], a[80:83], v[164:167]
v_mfma_f32_16x16x32_bf16 v[164:167], a[108:111], a[84:87], v[164:167]
s_xor_b32 s96, s42, 4352
s_add_u32 m0, s39, 16384
s_waitcnt vmcnt(4)
buffer_load_dwordx4 v224, s[20:23], s96 offen nt lds
v_mfma_f32_16x16x32_bf16 a[36:39], a[104:107], a[88:91], a[36:39]
v_add_u32 v236, 131072, v226
v_xor_b32 v237, 64, v236
ds_read_b128 v[192:195], v236 offset:0
ds_read_b128 v[196:199], v237 offset:0
ds_read_b128 v[200:203], v236 offset:8192
ds_read_b128 v[204:207], v237 offset:8192
ds_read_b128 v[208:211], v236 offset:16384
ds_read_b128 v[212:215], v237 offset:16384
ds_read_b128 v[216:219], v236 offset:24576
ds_read_b128 v[220:223], v237 offset:24576
v_mfma_f32_16x16x32_bf16 a[36:39], a[108:111], a[92:95], a[36:39]
s_waitcnt lgkmcnt(10)
v_mfma_f32_16x16x32_bf16 v[40:43], a[112:115], a[64:67], v[40:43]
ds_read_b128 a[96:99], v232 offset:24576
v_mfma_f32_16x16x32_bf16 v[40:43], a[116:119], a[68:71], v[40:43]
ds_read_b128 a[100:103], v233 offset:24576
v_mfma_f32_16x16x32_bf16 v[104:107], a[112:115], a[72:75], v[104:107]
v_mfma_f32_16x16x32_bf16 v[104:107], a[116:119], a[76:79], v[104:107]
v_mfma_f32_16x16x32_bf16 v[168:171], a[112:115], a[80:83], v[168:171]
v_mfma_f32_16x16x32_bf16 v[168:171], a[116:119], a[84:87], v[168:171]
s_xor_b32 s96, s42, 12544
s_add_u32 m0, s39, 20480
s_waitcnt vmcnt(4)
buffer_load_dwordx4 v224, s[20:23], s96 offen nt lds
v_mfma_f32_16x16x32_bf16 a[40:43], a[112:115], a[88:91], a[40:43]
v_mfma_f32_16x16x32_bf16 a[40:43], a[116:119], a[92:95], a[40:43]
s_waitcnt lgkmcnt(10)
v_mfma_f32_16x16x32_bf16 v[44:47], a[120:123], a[64:67], v[44:47]
ds_read_b128 a[104:107], v232 offset:26624
v_mfma_f32_16x16x32_bf16 v[44:47], a[124:127], a[68:71], v[44:47]
ds_read_b128 a[108:111], v233 offset:26624
v_mfma_f32_16x16x32_bf16 v[108:111], a[120:123], a[72:75], v[108:111]
v_mfma_f32_16x16x32_bf16 v[108:111], a[124:127], a[76:79], v[108:111]
v_mfma_f32_16x16x32_bf16 v[172:175], a[120:123], a[80:83], v[172:175]
s_xor_b32 s96, s42, 20736
s_add_u32 m0, s39, 24576
s_waitcnt vmcnt(4)
buffer_load_dwordx4 v224, s[20:23], s96 offen nt lds
v_mfma_f32_16x16x32_bf16 v[172:175], a[124:127], a[84:87], v[172:175]
v_mfma_f32_16x16x32_bf16 a[44:47], a[120:123], a[88:91], a[44:47]
v_mfma_f32_16x16x32_bf16 a[44:47], a[124:127], a[92:95], a[44:47]
s_waitcnt lgkmcnt(2)
v_mfma_f32_16x16x32_bf16 v[48:51], a[96:99], a[64:67], v[48:51]
ds_read_b128 a[112:115], v232 offset:28672
v_mfma_f32_16x16x32_bf16 v[48:51], a[100:103], a[68:71], v[48:51]
ds_read_b128 a[116:119], v233 offset:28672
v_mfma_f32_16x16x32_bf16 v[112:115], a[96:99], a[72:75], v[112:115]
v_mfma_f32_16x16x32_bf16 v[112:115], a[100:103], a[76:79], v[112:115]
s_xor_b32 s96, s42, 28928
s_add_u32 m0, s39, 28672
s_waitcnt vmcnt(4)
buffer_load_dwordx4 v224, s[20:23], s96 offen nt lds
v_mfma_f32_16x16x32_bf16 v[176:179], a[96:99], a[80:83], v[176:179]
v_mfma_f32_16x16x32_bf16 v[176:179], a[100:103], a[84:87], v[176:179]
v_mfma_f32_16x16x32_bf16 a[48:51], a[96:99], a[88:91], a[48:51]
v_mfma_f32_16x16x32_bf16 a[48:51], a[100:103], a[92:95], a[48:51]
s_waitcnt lgkmcnt(2)
v_mfma_f32_16x16x32_bf16 v[52:55], a[104:107], a[64:67], v[52:55]
ds_read_b128 a[120:123], v232 offset:30720
v_mfma_f32_16x16x32_bf16 v[52:55], a[108:111], a[68:71], v[52:55]
ds_read_b128 a[124:127], v233 offset:30720
v_mfma_f32_16x16x32_bf16 v[116:119], a[104:107], a[72:75], v[116:119]
v_mfma_f32_16x16x32_bf16 v[116:119], a[108:111], a[76:79], v[116:119]
s_xor_b32 s96, s40, 384
s_add_u32 m0, s39, 65536
s_waitcnt vmcnt(4)
buffer_load_dwordx4 v224, s[16:19], s96 offen nt lds
v_mfma_f32_16x16x32_bf16 v[180:183], a[104:107], a[80:83], v[180:183]
v_mfma_f32_16x16x32_bf16 v[180:183], a[108:111], a[84:87], v[180:183]
v_mfma_f32_16x16x32_bf16 a[52:55], a[104:107], a[88:91], a[52:55]
v_mfma_f32_16x16x32_bf16 a[52:55], a[108:111], a[92:95], a[52:55]
s_waitcnt lgkmcnt(2)
v_mfma_f32_16x16x32_bf16 v[56:59], a[112:115], a[64:67], v[56:59]
s_waitcnt lgkmcnt(0)
s_barrier
v_add_u32 v232, 0, v225
v_xor_b32 v233, 64, v232
ds_read_b128 a[96:99], v232 offset:0
v_mfma_f32_16x16x32_bf16 v[56:59], a[116:119], a[68:71], v[56:59]
ds_read_b128 a[100:103], v233 offset:0
v_mfma_f32_16x16x32_bf16 v[120:123], a[112:115], a[72:75], v[120:123]
s_xor_b32 s96, s40, 8576
s_add_u32 m0, s39, 69632
s_waitcnt vmcnt(4)
buffer_load_dwordx4 v224, s[16:19], s96 offen nt lds
v_mfma_f32_16x16x32_bf16 v[120:123], a[116:119], a[76:79], v[120:123]
v_mfma_f32_16x16x32_bf16 v[184:187], a[112:115], a[80:83], v[184:187]
v_mfma_f32_16x16x32_bf16 v[184:187], a[116:119], a[84:87], v[184:187]
v_mfma_f32_16x16x32_bf16 a[56:59], a[112:115], a[88:91], a[56:59]
v_mfma_f32_16x16x32_bf16 a[56:59], a[116:119], a[92:95], a[56:59]
v_mfma_f32_16x16x32_bf16 v[60:63], a[120:123], a[64:67], v[60:63]
ds_read_b128 a[104:107], v232 offset:2048
v_mfma_f32_16x16x32_bf16 v[60:63], a[124:127], a[68:71], v[60:63]
ds_read_b128 a[108:111], v233 offset:2048
v_mfma_f32_16x16x32_bf16 v[124:127], a[120:123], a[72:75], v[124:127]
s_xor_b32 s96, s40, 16768
s_add_u32 m0, s39, 73728
s_waitcnt vmcnt(4)
buffer_load_dwordx4 v224, s[16:19], s96 offen nt lds
v_mfma_f32_16x16x32_bf16 v[124:127], a[124:127], a[76:79], v[124:127]
v_mfma_f32_16x16x32_bf16 v[188:191], a[120:123], a[80:83], v[188:191]
v_mfma_f32_16x16x32_bf16 v[188:191], a[124:127], a[84:87], v[188:191]
v_mfma_f32_16x16x32_bf16 a[60:63], a[120:123], a[88:91], a[60:63]
v_mfma_f32_16x16x32_bf16 a[60:63], a[124:127], a[92:95], a[60:63]
s_waitcnt lgkmcnt(2)
v_mfma_f32_16x16x32_bf16 v[0:3], a[96:99], v[192:195], v[0:3]
ds_read_b128 a[112:115], v232 offset:4096
v_mfma_f32_16x16x32_bf16 v[0:3], a[100:103], v[196:199], v[0:3]
ds_read_b128 a[116:119], v233 offset:4096
v_mfma_f32_16x16x32_bf16 v[64:67], a[96:99], v[200:203], v[64:67]
v_mfma_f32_16x16x32_bf16 v[64:67], a[100:103], v[204:207], v[64:67]
s_xor_b32 s96, s40, 24960
s_add_u32 m0, s39, 77824
s_waitcnt vmcnt(4)
buffer_load_dwordx4 v224, s[16:19], s96 offen nt lds
v_mfma_f32_16x16x32_bf16 v[128:131], a[96:99], v[208:211], v[128:131]
v_mfma_f32_16x16x32_bf16 v[128:131], a[100:103], v[212:215], v[128:131]
v_mfma_f32_16x16x32_bf16 a[0:3], a[96:99], v[216:219], a[0:3]
v_mfma_f32_16x16x32_bf16 a[0:3], a[100:103], v[220:223], a[0:3]
s_waitcnt lgkmcnt(2)
v_mfma_f32_16x16x32_bf16 v[4:7], a[104:107], v[192:195], v[4:7]
ds_read_b128 a[120:123], v232 offset:6144
v_mfma_f32_16x16x32_bf16 v[4:7], a[108:111], v[196:199], v[4:7]
ds_read_b128 a[124:127], v233 offset:6144
v_mfma_f32_16x16x32_bf16 v[68:71], a[104:107], v[200:203], v[68:71]
v_mfma_f32_16x16x32_bf16 v[68:71], a[108:111], v[204:207], v[68:71]
v_mfma_f32_16x16x32_bf16 v[132:135], a[104:107], v[208:211], v[132:135]
s_xor_b32 s96, s40, 4480
s_add_u32 m0, s39, 81920
s_waitcnt vmcnt(4)
buffer_load_dwordx4 v224, s[16:19], s96 offen nt lds
v_mfma_f32_16x16x32_bf16 v[132:135], a[108:111], v[212:215], v[132:135]
v_mfma_f32_16x16x32_bf16 a[4:7], a[104:107], v[216:219], a[4:7]
v_mfma_f32_16x16x32_bf16 a[4:7], a[108:111], v[220:223], a[4:7]
s_waitcnt lgkmcnt(2)
v_mfma_f32_16x16x32_bf16 v[8:11], a[112:115], v[192:195], v[8:11]
ds_read_b128 a[96:99], v232 offset:8192
v_mfma_f32_16x16x32_bf16 v[8:11], a[116:119], v[196:199], v[8:11]
ds_read_b128 a[100:103], v233 offset:8192
v_mfma_f32_16x16x32_bf16 v[72:75], a[112:115], v[200:203], v[72:75]
v_mfma_f32_16x16x32_bf16 v[72:75], a[116:119], v[204:207], v[72:75]
v_mfma_f32_16x16x32_bf16 v[136:139], a[112:115], v[208:211], v[136:139]
v_mfma_f32_16x16x32_bf16 v[136:139], a[116:119], v[212:215], v[136:139]
s_xor_b32 s96, s40, 12672
s_add_u32 m0, s39, 86016
s_waitcnt vmcnt(4)
buffer_load_dwordx4 v224, s[16:19], s96 offen nt lds
v_mfma_f32_16x16x32_bf16 a[8:11], a[112:115], v[216:219], a[8:11]
v_mfma_f32_16x16x32_bf16 a[8:11], a[116:119], v[220:223], a[8:11]
s_waitcnt lgkmcnt(2)
v_mfma_f32_16x16x32_bf16 v[12:15], a[120:123], v[192:195], v[12:15]
ds_read_b128 a[104:107], v232 offset:10240
v_mfma_f32_16x16x32_bf16 v[12:15], a[124:127], v[196:199], v[12:15]
ds_read_b128 a[108:111], v233 offset:10240
v_mfma_f32_16x16x32_bf16 v[76:79], a[120:123], v[200:203], v[76:79]
v_mfma_f32_16x16x32_bf16 v[76:79], a[124:127], v[204:207], v[76:79]
v_mfma_f32_16x16x32_bf16 v[140:143], a[120:123], v[208:211], v[140:143]
v_mfma_f32_16x16x32_bf16 v[140:143], a[124:127], v[212:215], v[140:143]
v_mfma_f32_16x16x32_bf16 a[12:15], a[120:123], v[216:219], a[12:15]
s_xor_b32 s96, s40, 20864
s_add_u32 m0, s39, 90112
s_waitcnt vmcnt(4)
buffer_load_dwordx4 v224, s[16:19], s96 offen nt lds
v_mfma_f32_16x16x32_bf16 a[12:15], a[124:127], v[220:223], a[12:15]
s_waitcnt lgkmcnt(2)
v_mfma_f32_16x16x32_bf16 v[16:19], a[96:99], v[192:195], v[16:19]
s_barrier
ds_read_b128 a[112:115], v232 offset:12288
v_mfma_f32_16x16x32_bf16 v[16:19], a[100:103], v[196:199], v[16:19]
ds_read_b128 a[116:119], v233 offset:12288
v_mfma_f32_16x16x32_bf16 v[80:83], a[96:99], v[200:203], v[80:83]
v_mfma_f32_16x16x32_bf16 v[80:83], a[100:103], v[204:207], v[80:83]
v_mfma_f32_16x16x32_bf16 v[144:147], a[96:99], v[208:211], v[144:147]
v_mfma_f32_16x16x32_bf16 v[144:147], a[100:103], v[212:215], v[144:147]
v_mfma_f32_16x16x32_bf16 a[16:19], a[96:99], v[216:219], a[16:19]
v_mfma_f32_16x16x32_bf16 a[16:19], a[100:103], v[220:223], a[16:19]
s_xor_b32 s96, s40, 29056
s_add_u32 m0, s39, 94208
s_waitcnt vmcnt(4)
buffer_load_dwordx4 v224, s[16:19], s96 offen nt lds
s_waitcnt lgkmcnt(2)
v_mfma_f32_16x16x32_bf16 v[20:23], a[104:107], v[192:195], v[20:23]
ds_read_b128 a[120:123], v232 offset:14336
v_mfma_f32_16x16x32_bf16 v[20:23], a[108:111], v[196:199], v[20:23]
ds_read_b128 a[124:127], v233 offset:14336
v_mfma_f32_16x16x32_bf16 v[84:87], a[104:107], v[200:203], v[84:87]
v_mfma_f32_16x16x32_bf16 v[84:87], a[108:111], v[204:207], v[84:87]
v_mfma_f32_16x16x32_bf16 v[148:151], a[104:107], v[208:211], v[148:151]
v_mfma_f32_16x16x32_bf16 v[148:151], a[108:111], v[212:215], v[148:151]
v_mfma_f32_16x16x32_bf16 a[20:23], a[104:107], v[216:219], a[20:23]
v_mfma_f32_16x16x32_bf16 a[20:23], a[108:111], v[220:223], a[20:23]
s_waitcnt lgkmcnt(2)
v_mfma_f32_16x16x32_bf16 v[24:27], a[112:115], v[192:195], v[24:27]
s_xor_b32 s96, s42, 384
s_add_u32 m0, s39, 32768
s_waitcnt vmcnt(4)
buffer_load_dwordx4 v224, s[20:23], s96 offen nt lds
ds_read_b128 a[96:99], v232 offset:16384
v_mfma_f32_16x16x32_bf16 v[24:27], a[116:119], v[196:199], v[24:27]
ds_read_b128 a[100:103], v233 offset:16384
v_mfma_f32_16x16x32_bf16 v[88:91], a[112:115], v[200:203], v[88:91]
v_mfma_f32_16x16x32_bf16 v[88:91], a[116:119], v[204:207], v[88:91]
v_mfma_f32_16x16x32_bf16 v[152:155], a[112:115], v[208:211], v[152:155]
v_mfma_f32_16x16x32_bf16 v[152:155], a[116:119], v[212:215], v[152:155]
v_mfma_f32_16x16x32_bf16 a[24:27], a[112:115], v[216:219], a[24:27]
v_mfma_f32_16x16x32_bf16 a[24:27], a[116:119], v[220:223], a[24:27]
s_waitcnt lgkmcnt(2)
v_mfma_f32_16x16x32_bf16 v[28:31], a[120:123], v[192:195], v[28:31]
ds_read_b128 a[104:107], v232 offset:18432
v_mfma_f32_16x16x32_bf16 v[28:31], a[124:127], v[196:199], v[28:31]
s_xor_b32 s96, s42, 8576
s_add_u32 m0, s39, 36864
s_waitcnt vmcnt(4)
buffer_load_dwordx4 v224, s[20:23], s96 offen nt lds
ds_read_b128 a[108:111], v233 offset:18432
v_mfma_f32_16x16x32_bf16 v[92:95], a[120:123], v[200:203], v[92:95]
v_mfma_f32_16x16x32_bf16 v[92:95], a[124:127], v[204:207], v[92:95]
v_mfma_f32_16x16x32_bf16 v[156:159], a[120:123], v[208:211], v[156:159]
v_mfma_f32_16x16x32_bf16 v[156:159], a[124:127], v[212:215], v[156:159]
v_mfma_f32_16x16x32_bf16 a[28:31], a[120:123], v[216:219], a[28:31]
v_mfma_f32_16x16x32_bf16 a[28:31], a[124:127], v[220:223], a[28:31]
s_waitcnt lgkmcnt(2)
v_mfma_f32_16x16x32_bf16 v[32:35], a[96:99], v[192:195], v[32:35]
ds_read_b128 a[112:115], v232 offset:20480
v_mfma_f32_16x16x32_bf16 v[32:35], a[100:103], v[196:199], v[32:35]
ds_read_b128 a[116:119], v233 offset:20480
v_mfma_f32_16x16x32_bf16 v[96:99], a[96:99], v[200:203], v[96:99]
s_xor_b32 s96, s42, 16768
s_add_u32 m0, s39, 40960
s_waitcnt vmcnt(4)
buffer_load_dwordx4 v224, s[20:23], s96 offen nt lds
v_mfma_f32_16x16x32_bf16 v[96:99], a[100:103], v[204:207], v[96:99]
v_mfma_f32_16x16x32_bf16 v[160:163], a[96:99], v[208:211], v[160:163]
v_mfma_f32_16x16x32_bf16 v[160:163], a[100:103], v[212:215], v[160:163]
v_mfma_f32_16x16x32_bf16 a[32:35], a[96:99], v[216:219], a[32:35]
v_mfma_f32_16x16x32_bf16 a[32:35], a[100:103], v[220:223], a[32:35]
s_waitcnt lgkmcnt(2)
v_mfma_f32_16x16x32_bf16 v[36:39], a[104:107], v[192:195], v[36:39]
ds_read_b128 a[120:123], v232 offset:22528
v_mfma_f32_16x16x32_bf16 v[36:39], a[108:111], v[196:199], v[36:39]
ds_read_b128 a[124:127], v233 offset:22528
v_mfma_f32_16x16x32_bf16 v[100:103], a[104:107], v[200:203], v[100:103]
v_mfma_f32_16x16x32_bf16 v[100:103], a[108:111], v[204:207], v[100:103]
s_xor_b32 s96, s42, 24960
s_add_u32 m0, s39, 45056
s_waitcnt vmcnt(4)
buffer_load_dwordx4 v224, s[20:23], s96 offen nt lds
v_mfma_f32_16x16x32_bf16 v[164:167], a[104:107], v[208:211], v[164:167]
v_mfma_f32_16x16x32_bf16 v[164:167], a[108:111], v[212:215], v[164:167]
v_mfma_f32_16x16x32_bf16 a[36:39], a[104:107], v[216:219], a[36:39]
v_mfma_f32_16x16x32_bf16 a[36:39], a[108:111], v[220:223], a[36:39]
s_waitcnt lgkmcnt(2)
v_mfma_f32_16x16x32_bf16 v[40:43], a[112:115], v[192:195], v[40:43]
ds_read_b128 a[96:99], v232 offset:24576
v_mfma_f32_16x16x32_bf16 v[40:43], a[116:119], v[196:199], v[40:43]
ds_read_b128 a[100:103], v233 offset:24576
v_mfma_f32_16x16x32_bf16 v[104:107], a[112:115], v[200:203], v[104:107]
v_mfma_f32_16x16x32_bf16 v[104:107], a[116:119], v[204:207], v[104:107]
v_mfma_f32_16x16x32_bf16 v[168:171], a[112:115], v[208:211], v[168:171]
s_xor_b32 s96, s42, 4480
s_add_u32 m0, s39, 49152
s_waitcnt vmcnt(4)
buffer_load_dwordx4 v224, s[20:23], s96 offen nt lds
v_mfma_f32_16x16x32_bf16 v[168:171], a[116:119], v[212:215], v[168:171]
v_add_u32 v236, 65536, v226
v_xor_b32 v237, 64, v236
ds_read_b128 a[64:67], v236 offset:0
ds_read_b128 a[68:71], v237 offset:0
ds_read_b128 a[72:75], v236 offset:8192
ds_read_b128 a[76:79], v237 offset:8192
ds_read_b128 a[80:83], v236 offset:16384
ds_read_b128 a[84:87], v237 offset:16384
ds_read_b128 a[88:91], v236 offset:24576
ds_read_b128 a[92:95], v237 offset:24576
v_mfma_f32_16x16x32_bf16 a[40:43], a[112:115], v[216:219], a[40:43]
v_mfma_f32_16x16x32_bf16 a[40:43], a[116:119], v[220:223], a[40:43]
s_waitcnt lgkmcnt(10)
v_mfma_f32_16x16x32_bf16 v[44:47], a[120:123], v[192:195], v[44:47]
ds_read_b128 a[104:107], v232 offset:26624
v_mfma_f32_16x16x32_bf16 v[44:47], a[124:127], v[196:199], v[44:47]
ds_read_b128 a[108:111], v233 offset:26624
v_mfma_f32_16x16x32_bf16 v[108:111], a[120:123], v[200:203], v[108:111]
v_mfma_f32_16x16x32_bf16 v[108:111], a[124:127], v[204:207], v[108:111]
v_mfma_f32_16x16x32_bf16 v[172:175], a[120:123], v[208:211], v[172:175]
v_mfma_f32_16x16x32_bf16 v[172:175], a[124:127], v[212:215], v[172:175]
s_xor_b32 s96, s42, 12672
s_add_u32 m0, s39, 53248
s_waitcnt vmcnt(4)
buffer_load_dwordx4 v224, s[20:23], s96 offen nt lds
v_mfma_f32_16x16x32_bf16 a[44:47], a[120:123], v[216:219], a[44:47]
v_mfma_f32_16x16x32_bf16 a[44:47], a[124:127], v[220:223], a[44:47]
s_waitcnt lgkmcnt(10)
v_mfma_f32_16x16x32_bf16 v[48:51], a[96:99], v[192:195], v[48:51]
ds_read_b128 a[112:115], v232 offset:28672
v_mfma_f32_16x16x32_bf16 v[48:51], a[100:103], v[196:199], v[48:51]
ds_read_b128 a[116:119], v233 offset:28672
v_mfma_f32_16x16x32_bf16 v[112:115], a[96:99], v[200:203], v[112:115]
v_mfma_f32_16x16x32_bf16 v[112:115], a[100:103], v[204:207], v[112:115]
v_mfma_f32_16x16x32_bf16 v[176:179], a[96:99], v[208:211], v[176:179]
v_mfma_f32_16x16x32_bf16 v[176:179], a[100:103], v[212:215], v[176:179]
v_mfma_f32_16x16x32_bf16 a[48:51], a[96:99], v[216:219], a[48:51]
s_xor_b32 s96, s42, 20864
s_add_u32 m0, s39, 57344
s_waitcnt vmcnt(4)
buffer_load_dwordx4 v224, s[20:23], s96 offen nt lds
v_mfma_f32_16x16x32_bf16 a[48:51], a[100:103], v[220:223], a[48:51]
s_waitcnt lgkmcnt(2)
v_mfma_f32_16x16x32_bf16 v[52:55], a[104:107], v[192:195], v[52:55]
ds_read_b128 a[120:123], v232 offset:30720
v_mfma_f32_16x16x32_bf16 v[52:55], a[108:111], v[196:199], v[52:55]
ds_read_b128 a[124:127], v233 offset:30720
v_mfma_f32_16x16x32_bf16 v[116:119], a[104:107], v[200:203], v[116:119]
v_mfma_f32_16x16x32_bf16 v[116:119], a[108:111], v[204:207], v[116:119]
v_mfma_f32_16x16x32_bf16 v[180:183], a[104:107], v[208:211], v[180:183]
v_mfma_f32_16x16x32_bf16 v[180:183], a[108:111], v[212:215], v[180:183]
v_mfma_f32_16x16x32_bf16 a[52:55], a[104:107], v[216:219], a[52:55]
v_mfma_f32_16x16x32_bf16 a[52:55], a[108:111], v[220:223], a[52:55]
s_xor_b32 s96, s42, 29056
s_add_u32 m0, s39, 61440
s_waitcnt vmcnt(4)
buffer_load_dwordx4 v224, s[20:23], s96 offen nt lds
s_waitcnt lgkmcnt(2)
v_mfma_f32_16x16x32_bf16 v[56:59], a[112:115], v[192:195], v[56:59]
s_waitcnt lgkmcnt(0)
s_barrier
v_add_u32 v232, 32768, v225
v_xor_b32 v233, 64, v232
ds_read_b128 a[96:99], v232 offset:0
v_mfma_f32_16x16x32_bf16 v[56:59], a[116:119], v[196:199], v[56:59]
ds_read_b128 a[100:103], v233 offset:0
v_mfma_f32_16x16x32_bf16 v[120:123], a[112:115], v[200:203], v[120:123]
v_mfma_f32_16x16x32_bf16 v[120:123], a[116:119], v[204:207], v[120:123]
v_mfma_f32_16x16x32_bf16 v[184:187], a[112:115], v[208:211], v[184:187]
v_mfma_f32_16x16x32_bf16 v[184:187], a[116:119], v[212:215], v[184:187]
v_mfma_f32_16x16x32_bf16 a[56:59], a[112:115], v[216:219], a[56:59]
v_mfma_f32_16x16x32_bf16 a[56:59], a[116:119], v[220:223], a[56:59]
v_mfma_f32_16x16x32_bf16 v[60:63], a[120:123], v[192:195], v[60:63]
s_xor_b32 s96, s42, 0
s_add_u32 m0, s39, 131072
s_waitcnt vmcnt(4)
buffer_load_dwordx4 v224, s[24:27], s96 offen nt lds
ds_read_b128 a[104:107], v232 offset:2048
v_mfma_f32_16x16x32_bf16 v[60:63], a[124:127], v[196:199], v[60:63]
ds_read_b128 a[108:111], v233 offset:2048
v_mfma_f32_16x16x32_bf16 v[124:127], a[120:123], v[200:203], v[124:127]
v_mfma_f32_16x16x32_bf16 v[124:127], a[124:127], v[204:207], v[124:127]
v_mfma_f32_16x16x32_bf16 v[188:191], a[120:123], v[208:211], v[188:191]
v_mfma_f32_16x16x32_bf16 v[188:191], a[124:127], v[212:215], v[188:191]
v_mfma_f32_16x16x32_bf16 a[60:63], a[120:123], v[216:219], a[60:63]
v_mfma_f32_16x16x32_bf16 a[60:63], a[124:127], v[220:223], a[60:63]
s_waitcnt lgkmcnt(2)
v_mfma_f32_16x16x32_bf16 v[0:3], a[96:99], a[64:67], v[0:3]
ds_read_b128 a[112:115], v232 offset:4096
v_mfma_f32_16x16x32_bf16 v[0:3], a[100:103], a[68:71], v[0:3]
ds_read_b128 a[116:119], v233 offset:4096
v_mfma_f32_16x16x32_bf16 v[64:67], a[96:99], a[72:75], v[64:67]
v_mfma_f32_16x16x32_bf16 v[64:67], a[100:103], a[76:79], v[64:67]
s_xor_b32 s96, s42, 8192
s_add_u32 m0, s39, 135168
s_waitcnt vmcnt(4)
buffer_load_dwordx4 v224, s[24:27], s96 offen nt lds
v_mfma_f32_16x16x32_bf16 v[128:131], a[96:99], a[80:83], v[128:131]
v_mfma_f32_16x16x32_bf16 v[128:131], a[100:103], a[84:87], v[128:131]
v_mfma_f32_16x16x32_bf16 a[0:3], a[96:99], a[88:91], a[0:3]
v_mfma_f32_16x16x32_bf16 a[0:3], a[100:103], a[92:95], a[0:3]
s_waitcnt lgkmcnt(2)
v_mfma_f32_16x16x32_bf16 v[4:7], a[104:107], a[64:67], v[4:7]
ds_read_b128 a[120:123], v232 offset:6144
v_mfma_f32_16x16x32_bf16 v[4:7], a[108:111], a[68:71], v[4:7]
ds_read_b128 a[124:127], v233 offset:6144
v_max_f32 v231, v0, v1
v_mfma_f32_16x16x32_bf16 v[68:71], a[104:107], a[72:75], v[68:71]
v_max3_f32 v231, v231, v2, v3
v_mfma_f32_16x16x32_bf16 v[68:71], a[108:111], a[76:79], v[68:71]
v_max_f32 v243, v64, v65
v_mfma_f32_16x16x32_bf16 v[132:135], a[104:107], a[80:83], v[132:135]
v_max3_f32 v243, v243, v66, v67
v_mfma_f32_16x16x32_bf16 v[132:135], a[108:111], a[84:87], v[132:135]
v_max_f32 v242, v128, v129
v_mfma_f32_16x16x32_bf16 a[4:7], a[104:107], a[88:91], a[4:7]
s_xor_b32 s96, s42, 16384
s_add_u32 m0, s39, 139264
s_waitcnt vmcnt(4)
buffer_load_dwordx4 v224, s[24:27], s96 offen nt lds
v_max3_f32 v242, v242, v130, v131
v_mfma_f32_16x16x32_bf16 a[4:7], a[108:111], a[92:95], a[4:7]
s_waitcnt lgkmcnt(2)
v_accvgpr_read_b32 v192, a0
v_accvgpr_read_b32 v193, a1
v_mfma_f32_16x16x32_bf16 v[8:11], a[112:115], a[64:67], v[8:11]
ds_read_b128 a[96:99], v232 offset:8192
v_mfma_f32_16x16x32_bf16 v[8:11], a[116:119], a[68:71], v[8:11]
ds_read_b128 a[100:103], v233 offset:8192
v_max3_f32 v231, v231, v4, v5
v_mfma_f32_16x16x32_bf16 v[72:75], a[112:115], a[72:75], v[72:75]
v_accvgpr_read_b32 v194, a2
v_max3_f32 v231, v231, v6, v7
v_mfma_f32_16x16x32_bf16 v[72:75], a[116:119], a[76:79], v[72:75]
v_accvgpr_read_b32 v195, a3
v_max3_f32 v243, v243, v68, v69
v_mfma_f32_16x16x32_bf16 v[136:139], a[112:115], a[80:83], v[136:139]
v_max_f32 v237, v192, v193
v_max3_f32 v243, v243, v70, v71
v_mfma_f32_16x16x32_bf16 v[136:139], a[116:119], a[84:87], v[136:139]
v_max3_f32 v237, v237, v194, v195
v_max3_f32 v242, v242, v132, v133
v_mfma_f32_16x16x32_bf16 a[8:11], a[112:115], a[88:91], a[8:11]
v_max3_f32 v242, v242, v134, v135
v_mfma_f32_16x16x32_bf16 a[8:11], a[116:119], a[92:95], a[8:11]
s_waitcnt lgkmcnt(2)
v_accvgpr_read_b32 v196, a4
v_accvgpr_read_b32 v197, a5
v_mfma_f32_16x16x32_bf16 v[12:15], a[120:123], a[64:67], v[12:15]
ds_read_b128 a[104:107], v232 offset:10240
v_mfma_f32_16x16x32_bf16 v[12:15], a[124:127], a[68:71], v[12:15]
s_xor_b32 s96, s42, 24576
s_add_u32 m0, s39, 143360
s_waitcnt vmcnt(4)
buffer_load_dwordx4 v224, s[24:27], s96 offen nt lds
ds_read_b128 a[108:111], v233 offset:10240
v_max3_f32 v231, v231, v8, v9
v_mfma_f32_16x16x32_bf16 v[76:79], a[120:123], a[72:75], v[76:79]
v_accvgpr_read_b32 v198, a6
v_max3_f32 v231, v231, v10, v11
v_mfma_f32_16x16x32_bf16 v[76:79], a[124:127], a[76:79], v[76:79]
v_accvgpr_read_b32 v199, a7
v_max3_f32 v243, v243, v72, v73
v_mfma_f32_16x16x32_bf16 v[140:143], a[120:123], a[80:83], v[140:143]
v_max3_f32 v237, v237, v196, v197
v_max3_f32 v243, v243, v74, v75
v_mfma_f32_16x16x32_bf16 v[140:143], a[124:127], a[84:87], v[140:143]
v_max3_f32 v237, v237, v198, v199
v_max3_f32 v242, v242, v136, v137
v_mfma_f32_16x16x32_bf16 a[12:15], a[120:123], a[88:91], a[12:15]
v_max3_f32 v242, v242, v138, v139
v_mfma_f32_16x16x32_bf16 a[12:15], a[124:127], a[92:95], a[12:15]
s_waitcnt lgkmcnt(2)
v_accvgpr_read_b32 v200, a8
v_accvgpr_read_b32 v201, a9
v_mfma_f32_16x16x32_bf16 v[16:19], a[96:99], a[64:67], v[16:19]
s_waitcnt vmcnt(4)
s_barrier
ds_read_b128 a[112:115], v232 offset:12288
v_mfma_f32_16x16x32_bf16 v[16:19], a[100:103], a[68:71], v[16:19]
ds_read_b128 a[116:119], v233 offset:12288
v_max3_f32 v231, v231, v12, v13
v_mfma_f32_16x16x32_bf16 v[80:83], a[96:99], a[72:75], v[80:83]
v_accvgpr_read_b32 v202, a10
v_max3_f32 v231, v231, v14, v15
v_mfma_f32_16x16x32_bf16 v[80:83], a[100:103], a[76:79], v[80:83]
v_accvgpr_read_b32 v203, a11
v_max3_f32 v243, v243, v76, v77
v_mfma_f32_16x16x32_bf16 v[144:147], a[96:99], a[80:83], v[144:147]
s_xor_b32 s96, s42, 4096
s_add_u32 m0, s39, 147456
s_nop 0
buffer_load_dwordx4 v224, s[24:27], s96 offen nt lds
v_max3_f32 v237, v237, v200, v201
v_max3_f32 v243, v243, v78, v79
v_mfma_f32_16x16x32_bf16 v[144:147], a[100:103], a[84:87], v[144:147]
v_max3_f32 v237, v237, v202, v203
v_max3_f32 v242, v242, v140, v141
v_mfma_f32_16x16x32_bf16 a[16:19], a[96:99], a[88:91], a[16:19]
v_max3_f32 v242, v242, v142, v143
v_mfma_f32_16x16x32_bf16 a[16:19], a[100:103], a[92:95], a[16:19]
s_waitcnt lgkmcnt(2)
v_accvgpr_read_b32 v204, a12
v_accvgpr_read_b32 v205, a13
v_mfma_f32_16x16x32_bf16 v[20:23], a[104:107], a[64:67], v[20:23]
ds_read_b128 a[120:123], v232 offset:14336
v_mfma_f32_16x16x32_bf16 v[20:23], a[108:111], a[68:71], v[20:23]
ds_read_b128 a[124:127], v233 offset:14336
v_max3_f32 v231, v231, v16, v17
v_mfma_f32_16x16x32_bf16 v[84:87], a[104:107], a[72:75], v[84:87]
v_accvgpr_read_b32 v206, a14
v_max3_f32 v231, v231, v18, v19
v_mfma_f32_16x16x32_bf16 v[84:87], a[108:111], a[76:79], v[84:87]
v_accvgpr_read_b32 v207, a15
v_max3_f32 v243, v243, v80, v81
v_mfma_f32_16x16x32_bf16 v[148:151], a[104:107], a[80:83], v[148:151]
v_max3_f32 v237, v237, v204, v205
v_max3_f32 v243, v243, v82, v83
v_mfma_f32_16x16x32_bf16 v[148:151], a[108:111], a[84:87], v[148:151]
v_max3_f32 v237, v237, v206, v207
v_max3_f32 v242, v242, v144, v145
v_mfma_f32_16x16x32_bf16 a[20:23], a[104:107], a[88:91], a[20:23]
v_max3_f32 v242, v242, v146, v147
v_mfma_f32_16x16x32_bf16 a[20:23], a[108:111], a[92:95], a[20:23]
s_xor_b32 s96, s42, 12288
s_add_u32 m0, s39, 151552
s_waitcnt vmcnt(4)
buffer_load_dwordx4 v224, s[24:27], s96 offen nt lds
s_waitcnt lgkmcnt(2)
v_accvgpr_read_b32 v208, a16
v_accvgpr_read_b32 v209, a17
v_mfma_f32_16x16x32_bf16 v[24:27], a[112:115], a[64:67], v[24:27]
ds_read_b128 a[96:99], v232 offset:16384
v_mfma_f32_16x16x32_bf16 v[24:27], a[116:119], a[68:71], v[24:27]
ds_read_b128 a[100:103], v233 offset:16384
v_max3_f32 v231, v231, v20, v21
v_mfma_f32_16x16x32_bf16 v[88:91], a[112:115], a[72:75], v[88:91]
v_accvgpr_read_b32 v210, a18
v_max3_f32 v231, v231, v22, v23
v_mfma_f32_16x16x32_bf16 v[88:91], a[116:119], a[76:79], v[88:91]
v_accvgpr_read_b32 v211, a19
v_max3_f32 v243, v243, v84, v85
v_mfma_f32_16x16x32_bf16 v[152:155], a[112:115], a[80:83], v[152:155]
v_max3_f32 v237, v237, v208, v209
v_max3_f32 v243, v243, v86, v87
v_mfma_f32_16x16x32_bf16 v[152:155], a[116:119], a[84:87], v[152:155]
v_max3_f32 v237, v237, v210, v211
v_max3_f32 v242, v242, v148, v149
v_mfma_f32_16x16x32_bf16 a[24:27], a[112:115], a[88:91], a[24:27]
v_max3_f32 v242, v242, v150, v151
v_mfma_f32_16x16x32_bf16 a[24:27], a[116:119], a[92:95], a[24:27]
s_waitcnt lgkmcnt(2)
v_accvgpr_read_b32 v212, a20
v_accvgpr_read_b32 v213, a21
v_mfma_f32_16x16x32_bf16 v[28:31], a[120:123], a[64:67], v[28:31]
ds_read_b128 a[104:107], v232 offset:18432
v_mfma_f32_16x16x32_bf16 v[28:31], a[124:127], a[68:71], v[28:31]
ds_read_b128 a[108:111], v233 offset:18432
v_max3_f32 v231, v231, v24, v25
v_mfma_f32_16x16x32_bf16 v[92:95], a[120:123], a[72:75], v[92:95]
s_xor_b32 s96, s42, 20480
s_add_u32 m0, s39, 155648
s_waitcnt vmcnt(4)
buffer_load_dwordx4 v224, s[24:27], s96 offen nt lds
v_accvgpr_read_b32 v214, a22
v_max3_f32 v231, v231, v26, v27
v_mfma_f32_16x16x32_bf16 v[92:95], a[124:127], a[76:79], v[92:95]
v_accvgpr_read_b32 v215, a23
v_max3_f32 v243, v243, v88, v89
v_mfma_f32_16x16x32_bf16 v[156:159], a[120:123], a[80:83], v[156:159]
v_max3_f32 v237, v237, v212, v213
v_max3_f32 v243, v243, v90, v91
v_mfma_f32_16x16x32_bf16 v[156:159], a[124:127], a[84:87], v[156:159]
v_max3_f32 v237, v237, v214, v215
v_max3_f32 v242, v242, v152, v153
v_mfma_f32_16x16x32_bf16 a[28:31], a[120:123], a[88:91], a[28:31]
v_max3_f32 v242, v242, v154, v155
v_mfma_f32_16x16x32_bf16 a[28:31], a[124:127], a[92:95], a[28:31]
s_waitcnt lgkmcnt(2)
v_accvgpr_read_b32 v216, a24
v_accvgpr_read_b32 v217, a25
v_mfma_f32_16x16x32_bf16 v[32:35], a[96:99], a[64:67], v[32:35]
ds_read_b128 a[112:115], v232 offset:20480
v_mfma_f32_16x16x32_bf16 v[32:35], a[100:103], a[68:71], v[32:35]
ds_read_b128 a[116:119], v233 offset:20480
v_max3_f32 v231, v231, v28, v29
v_mfma_f32_16x16x32_bf16 v[96:99], a[96:99], a[72:75], v[96:99]
v_accvgpr_read_b32 v218, a26
v_max3_f32 v231, v231, v30, v31
v_mfma_f32_16x16x32_bf16 v[96:99], a[100:103], a[76:79], v[96:99]
v_accvgpr_read_b32 v219, a27
v_max3_f32 v243, v243, v92, v93
v_mfma_f32_16x16x32_bf16 v[160:163], a[96:99], a[80:83], v[160:163]
v_max3_f32 v237, v237, v216, v217
v_max3_f32 v243, v243, v94, v95
v_mfma_f32_16x16x32_bf16 v[160:163], a[100:103], a[84:87], v[160:163]
s_xor_b32 s96, s42, 28672
s_add_u32 m0, s39, 159744
s_waitcnt vmcnt(4)
buffer_load_dwordx4 v224, s[24:27], s96 offen nt lds
v_max3_f32 v237, v237, v218, v219
v_max3_f32 v242, v242, v156, v157
v_mfma_f32_16x16x32_bf16 a[32:35], a[96:99], a[88:91], a[32:35]
v_max3_f32 v242, v242, v158, v159
v_mfma_f32_16x16x32_bf16 a[32:35], a[100:103], a[92:95], a[32:35]
s_waitcnt lgkmcnt(2)
v_accvgpr_read_b32 v220, a28
v_accvgpr_read_b32 v221, a29
v_mfma_f32_16x16x32_bf16 v[36:39], a[104:107], a[64:67], v[36:39]
ds_read_b128 a[120:123], v232 offset:22528
v_mfma_f32_16x16x32_bf16 v[36:39], a[108:111], a[68:71], v[36:39]
ds_read_b128 a[124:127], v233 offset:22528
v_max3_f32 v231, v231, v32, v33
v_mfma_f32_16x16x32_bf16 v[100:103], a[104:107], a[72:75], v[100:103]
v_accvgpr_read_b32 v222, a30
v_max3_f32 v231, v231, v34, v35
v_mfma_f32_16x16x32_bf16 v[100:103], a[108:111], a[76:79], v[100:103]
v_accvgpr_read_b32 v223, a31
v_max3_f32 v243, v243, v96, v97
v_mfma_f32_16x16x32_bf16 v[164:167], a[104:107], a[80:83], v[164:167]
v_max3_f32 v237, v237, v220, v221
v_max3_f32 v243, v243, v98, v99
v_mfma_f32_16x16x32_bf16 v[164:167], a[108:111], a[84:87], v[164:167]
v_max3_f32 v237, v237, v222, v223
v_max3_f32 v242, v242, v160, v161
v_mfma_f32_16x16x32_bf16 a[36:39], a[104:107], a[88:91], a[36:39]
v_max3_f32 v242, v242, v162, v163
v_mfma_f32_16x16x32_bf16 a[36:39], a[108:111], a[92:95], a[36:39]
s_waitcnt lgkmcnt(2)
v_mfma_f32_16x16x32_bf16 v[40:43], a[112:115], a[64:67], v[40:43]
s_xor_b32 s96, s41, 0
s_add_u32 m0, s39, 98304
s_waitcnt vmcnt(4)
buffer_load_dwordx4 v224, s[16:19], s96 offen nt lds
ds_read_b128 a[96:99], v232 offset:24576
v_mfma_f32_16x16x32_bf16 v[40:43], a[116:119], a[68:71], v[40:43]
ds_read_b128 a[100:103], v233 offset:24576
v_max3_f32 v231, v231, v36, v37
v_mfma_f32_16x16x32_bf16 v[104:107], a[112:115], a[72:75], v[104:107]
v_max3_f32 v231, v231, v38, v39
v_mfma_f32_16x16x32_bf16 v[104:107], a[116:119], a[76:79], v[104:107]
v_max3_f32 v243, v243, v100, v101
v_mfma_f32_16x16x32_bf16 v[168:171], a[112:115], a[80:83], v[168:171]
v_max3_f32 v243, v243, v102, v103
v_mfma_f32_16x16x32_bf16 v[168:171], a[116:119], a[84:87], v[168:171]
v_max3_f32 v242, v242, v164, v165
v_mfma_f32_16x16x32_bf16 a[40:43], a[112:115], a[88:91], a[40:43]
v_max3_f32 v242, v242, v166, v167
v_mfma_f32_16x16x32_bf16 a[40:43], a[116:119], a[92:95], a[40:43]
s_waitcnt lgkmcnt(2)
v_mfma_f32_16x16x32_bf16 v[44:47], a[120:123], a[64:67], v[44:47]
ds_read_b128 a[104:107], v232 offset:26624
v_mfma_f32_16x16x32_bf16 v[44:47], a[124:127], a[68:71], v[44:47]
ds_read_b128 a[108:111], v233 offset:26624
v_max3_f32 v231, v231, v40, v41
v_mfma_f32_16x16x32_bf16 v[108:111], a[120:123], a[72:75], v[108:111]
v_max3_f32 v231, v231, v42, v43
v_mfma_f32_16x16x32_bf16 v[108:111], a[124:127], a[76:79], v[108:111]
s_xor_b32 s96, s41, 8192
s_add_u32 m0, s39, 102400
s_waitcnt vmcnt(4)
buffer_load_dwordx4 v224, s[16:19], s96 offen nt lds
v_max3_f32 v243, v243, v104, v105
v_mfma_f32_16x16x32_bf16 v[172:175], a[120:123], a[80:83], v[172:175]
v_max3_f32 v243, v243, v106, v107
v_mfma_f32_16x16x32_bf16 v[172:175], a[124:127], a[84:87], v[172:175]
v_max3_f32 v242, v242, v168, v169
v_mfma_f32_16x16x32_bf16 a[44:47], a[120:123], a[88:91], a[44:47]
v_max3_f32 v242, v242, v170, v171
v_mfma_f32_16x16x32_bf16 a[44:47], a[124:127], a[92:95], a[44:47]
s_waitcnt lgkmcnt(2)
v_mfma_f32_16x16x32_bf16 v[48:51], a[96:99], a[64:67], v[48:51]
ds_read_b128 a[112:115], v232 offset:28672
v_mfma_f32_16x16x32_bf16 v[48:51], a[100:103], a[68:71], v[48:51]
ds_read_b128 a[116:119], v233 offset:28672
v_max3_f32 v231, v231, v44, v45
v_mfma_f32_16x16x32_bf16 v[112:115], a[96:99], a[72:75], v[112:115]
v_max3_f32 v231, v231, v46, v47
v_mfma_f32_16x16x32_bf16 v[112:115], a[100:103], a[76:79], v[112:115]
v_max3_f32 v243, v243, v108, v109
v_mfma_f32_16x16x32_bf16 v[176:179], a[96:99], a[80:83], v[176:179]
v_max3_f32 v243, v243, v110, v111
v_mfma_f32_16x16x32_bf16 v[176:179], a[100:103], a[84:87], v[176:179]
v_max3_f32 v242, v242, v172, v173
v_mfma_f32_16x16x32_bf16 a[48:51], a[96:99], a[88:91], a[48:51]
s_xor_b32 s96, s41, 16384
s_add_u32 m0, s39, 106496
s_waitcnt vmcnt(4)
buffer_load_dwordx4 v224, s[16:19], s96 offen nt lds
v_max3_f32 v242, v242, v174, v175
v_mfma_f32_16x16x32_bf16 a[48:51], a[100:103], a[92:95], a[48:51]
s_waitcnt lgkmcnt(2)
v_mfma_f32_16x16x32_bf16 v[52:55], a[104:107], a[64:67], v[52:55]
ds_read_b128 a[120:123], v232 offset:30720
v_mfma_f32_16x16x32_bf16 v[52:55], a[108:111], a[68:71], v[52:55]
ds_read_b128 a[124:127], v233 offset:30720
v_max3_f32 v231, v231, v48, v49
v_mfma_f32_16x16x32_bf16 v[116:119], a[104:107], a[72:75], v[116:119]
v_max3_f32 v231, v231, v50, v51
v_mfma_f32_16x16x32_bf16 v[116:119], a[108:111], a[76:79], v[116:119]
v_max3_f32 v243, v243, v112, v113
v_mfma_f32_16x16x32_bf16 v[180:183], a[104:107], a[80:83], v[180:183]
v_max3_f32 v243, v243, v114, v115
v_mfma_f32_16x16x32_bf16 v[180:183], a[108:111], a[84:87], v[180:183]
v_max3_f32 v242, v242, v176, v177
v_mfma_f32_16x16x32_bf16 a[52:55], a[104:107], a[88:91], a[52:55]
v_max3_f32 v242, v242, v178, v179
v_mfma_f32_16x16x32_bf16 a[52:55], a[108:111], a[92:95], a[52:55]
s_waitcnt lgkmcnt(2)
v_mfma_f32_16x16x32_bf16 v[56:59], a[112:115], a[64:67], v[56:59]
v_mfma_f32_16x16x32_bf16 v[56:59], a[116:119], a[68:71], v[56:59]
s_xor_b32 s96, s41, 24576
s_add_u32 m0, s39, 110592
s_waitcnt vmcnt(4)
buffer_load_dwordx4 v224, s[16:19], s96 offen nt lds
v_max3_f32 v231, v231, v52, v53
v_mfma_f32_16x16x32_bf16 v[120:123], a[112:115], a[72:75], v[120:123]
v_max3_f32 v231, v231, v54, v55
v_mfma_f32_16x16x32_bf16 v[120:123], a[116:119], a[76:79], v[120:123]
v_max3_f32 v243, v243, v116, v117
v_mfma_f32_16x16x32_bf16 v[184:187], a[112:115], a[80:83], v[184:187]
v_max3_f32 v243, v243, v118, v119
v_mfma_f32_16x16x32_bf16 v[184:187], a[116:119], a[84:87], v[184:187]
v_max3_f32 v242, v242, v180, v181
v_mfma_f32_16x16x32_bf16 a[56:59], a[112:115], a[88:91], a[56:59]
v_max3_f32 v242, v242, v182, v183
v_mfma_f32_16x16x32_bf16 a[56:59], a[116:119], a[92:95], a[56:59]
s_waitcnt lgkmcnt(0)
v_mfma_f32_16x16x32_bf16 v[60:63], a[120:123], a[64:67], v[60:63]
v_mfma_f32_16x16x32_bf16 v[60:63], a[124:127], a[68:71], v[60:63]
v_max3_f32 v231, v231, v56, v57
v_mfma_f32_16x16x32_bf16 v[124:127], a[120:123], a[72:75], v[124:127]
v_max3_f32 v231, v231, v58, v59
v_mfma_f32_16x16x32_bf16 v[124:127], a[124:127], a[76:79], v[124:127]
v_max3_f32 v243, v243, v120, v121
v_mfma_f32_16x16x32_bf16 v[188:191], a[120:123], a[80:83], v[188:191]
s_xor_b32 s96, s41, 4096
s_add_u32 m0, s39, 114688
s_waitcnt vmcnt(4)
buffer_load_dwordx4 v224, s[16:19], s96 offen nt lds
v_max3_f32 v243, v243, v122, v123
v_mfma_f32_16x16x32_bf16 v[188:191], a[124:127], a[84:87], v[188:191]
v_max3_f32 v242, v242, v184, v185
v_mfma_f32_16x16x32_bf16 a[60:63], a[120:123], a[88:91], a[60:63]
v_max3_f32 v242, v242, v186, v187
v_mfma_f32_16x16x32_bf16 a[60:63], a[124:127], a[92:95], a[60:63]
v_max3_f32 v231, v231, v60, v61
v_max3_f32 v231, v231, v62, v63
v_max3_f32 v243, v243, v124, v125
v_max3_f32 v243, v243, v126, v127
v_max3_f32 v242, v242, v188, v189
v_max3_f32 v242, v242, v190, v191
v_mov_b32 v249, v231
v_mov_b32 v255, v243
v_mov_b32 v253, v242
v_permlane32_swap_b32 v231, v249
v_permlane32_swap_b32 v243, v255
v_permlane32_swap_b32 v242, v253
v_max_f32 v231, v231, v249
v_max_f32 v243, v243, v255
v_max_f32 v242, v242, v253
v_mov_b32 v249, v231
v_mov_b32 v255, v243
v_mov_b32 v253, v242
v_permlane16_swap_b32 v231, v249
v_permlane16_swap_b32 v243, v255
v_permlane16_swap_b32 v242, v253
v_max_f32 v231, v231, v249
v_max_f32 v243, v243, v255
v_max_f32 v242, v242, v253
v_mul_f32 v248, 0xbdb8aa3b, v231
v_mul_f32 v254, 0xbdb8aa3b, v243
v_pk_fma_f32 v[0:1], v[0:1], s[34:35], v[248:249] op_sel_hi:[1,1,0]
v_pk_fma_f32 v[2:3], v[2:3], s[34:35], v[248:249] op_sel_hi:[1,1,0]
v_exp_f32 v0, v0
v_exp_f32 v1, v1
v_pk_fma_f32 v[4:5], v[4:5], s[34:35], v[248:249] op_sel_hi:[1,1,0]
v_exp_f32 v2, v2
v_exp_f32 v3, v3
v_pk_fma_f32 v[6:7], v[6:7], s[34:35], v[248:249] op_sel_hi:[1,1,0]
v_exp_f32 v4, v4
v_pk_add_f32 v[250:251], v[0:1], v[2:3]
v_exp_f32 v5, v5
v_cvt_pk_bf16_f32 v0, v0, v1
v_cvt_pk_bf16_f32 v1, v2, v3
v_pk_fma_f32 v[8:9], v[8:9], s[34:35], v[248:249] op_sel_hi:[1,1,0]
v_exp_f32 v6, v6
v_pk_add_f32 v[250:251], v[250:251], v[4:5]
v_exp_f32 v7, v7
s_xor_b32 s96, s41, 12288
s_add_u32 m0, s39, 118784
s_nop 0
buffer_load_dwordx4 v224, s[16:19], s96 offen nt lds
v_cvt_pk_bf16_f32 v2, v4, v5
v_pk_fma_f32 v[10:11], v[10:11], s[34:35], v[248:249] op_sel_hi:[1,1,0]
v_exp_f32 v8, v8
v_pk_add_f32 v[250:251], v[250:251], v[6:7]
v_exp_f32 v9, v9
v_cvt_pk_bf16_f32 v3, v6, v7
v_pk_fma_f32 v[12:13], v[12:13], s[34:35], v[248:249] op_sel_hi:[1,1,0]
v_exp_f32 v10, v10
v_pk_add_f32 v[250:251], v[250:251], v[8:9]
v_exp_f32 v11, v11
v_cvt_pk_bf16_f32 v4, v8, v9
v_pk_fma_f32 v[14:15], v[14:15], s[34:35], v[248:249] op_sel_hi:[1,1,0]
v_exp_f32 v12, v12
v_pk_add_f32 v[250:251], v[250:251], v[10:11]
v_exp_f32 v13, v13
v_cvt_pk_bf16_f32 v5, v10, v11
v_pk_fma_f32 v[16:17], v[16:17], s[34:35], v[248:249] op_sel_hi:[1,1,0]
v_exp_f32 v14, v14
v_pk_add_f32 v[250:251], v[250:251], v[12:13]
v_exp_f32 v15, v15
v_cvt_pk_bf16_f32 v6, v12, v13
v_pk_fma_f32 v[18:19], v[18:19], s[34:35], v[248:249] op_sel_hi:[1,1,0]
v_exp_f32 v16, v16
v_pk_add_f32 v[250:251], v[250:251], v[14:15]
v_exp_f32 v17, v17
v_cvt_pk_bf16_f32 v7, v14, v15
v_pk_fma_f32 v[20:21], v[20:21], s[34:35], v[248:249] op_sel_hi:[1,1,0]
v_exp_f32 v18, v18
v_pk_add_f32 v[250:251], v[250:251], v[16:17]
v_exp_f32 v19, v19
v_cvt_pk_bf16_f32 v8, v16, v17
v_pk_fma_f32 v[22:23], v[22:23], s[34:35], v[248:249] op_sel_hi:[1,1,0]
v_exp_f32 v20, v20
v_pk_add_f32 v[250:251], v[250:251], v[18:19]
v_exp_f32 v21, v21
v_cvt_pk_bf16_f32 v9, v18, v19
v_pk_fma_f32 v[24:25], v[24:25], s[34:35], v[248:249] op_sel_hi:[1,1,0]
v_exp_f32 v22, v22
v_pk_add_f32 v[250:251], v[250:251], v[20:21]
v_exp_f32 v23, v23
v_cvt_pk_bf16_f32 v10, v20, v21
s_xor_b32 s96, s41, 20480
s_add_u32 m0, s39, 122880
s_waitcnt vmcnt(5)
buffer_load_dwordx4 v224, s[16:19], s96 offen nt lds
v_pk_fma_f32 v[26:27], v[26:27], s[34:35], v[248:249] op_sel_hi:[1,1,0]
v_exp_f32 v24, v24
v_pk_add_f32 v[250:251], v[250:251], v[22:23]
v_exp_f32 v25, v25
v_cvt_pk_bf16_f32 v11, v22, v23
v_pk_fma_f32 v[28:29], v[28:29], s[34:35], v[248:249] op_sel_hi:[1,1,0]
v_exp_f32 v26, v26
v_pk_add_f32 v[250:251], v[250:251], v[24:25]
v_exp_f32 v27, v27
v_cvt_pk_bf16_f32 v12, v24, v25
v_pk_fma_f32 v[30:31], v[30:31], s[34:35], v[248:249] op_sel_hi:[1,1,0]
v_exp_f32 v28, v28
v_pk_add_f32 v[250:251], v[250:251], v[26:27]
v_exp_f32 v29, v29
v_cvt_pk_bf16_f32 v13, v26, v27
v_pk_fma_f32 v[32:33], v[32:33], s[34:35], v[248:249] op_sel_hi:[1,1,0]
v_exp_f32 v30, v30
v_pk_add_f32 v[250:251], v[250:251], v[28:29]
v_exp_f32 v31, v31
v_cvt_pk_bf16_f32 v14, v28, v29
v_pk_fma_f32 v[34:35], v[34:35], s[34:35], v[248:249] op_sel_hi:[1,1,0]
v_exp_f32 v32, v32
v_pk_add_f32 v[250:251], v[250:251], v[30:31]
v_exp_f32 v33, v33
v_cvt_pk_bf16_f32 v15, v30, v31
v_pk_fma_f32 v[36:37], v[36:37], s[34:35], v[248:249] op_sel_hi:[1,1,0]
v_exp_f32 v34, v34
v_pk_add_f32 v[250:251], v[250:251], v[32:33]
v_exp_f32 v35, v35
v_cvt_pk_bf16_f32 v16, v32, v33
v_pk_fma_f32 v[38:39], v[38:39], s[34:35], v[248:249] op_sel_hi:[1,1,0]
v_exp_f32 v36, v36
v_pk_add_f32 v[250:251], v[250:251], v[34:35]
v_exp_f32 v37, v37
v_cvt_pk_bf16_f32 v17, v34, v35
v_pk_fma_f32 v[40:41], v[40:41], s[34:35], v[248:249] op_sel_hi:[1,1,0]
v_exp_f32 v38, v38
v_pk_add_f32 v[250:251], v[250:251], v[36:37]
v_exp_f32 v39, v39
v_cvt_pk_bf16_f32 v18, v36, v37
v_pk_fma_f32 v[42:43], v[42:43], s[34:35], v[248:249] op_sel_hi:[1,1,0]
v_exp_f32 v40, v40
s_xor_b32 s96, s41, 28672
s_add_u32 m0, s39, 126976
s_waitcnt vmcnt(5)
buffer_load_dwordx4 v224, s[16:19], s96 offen nt lds
v_pk_add_f32 v[250:251], v[250:251], v[38:39]
v_exp_f32 v41, v41
v_cvt_pk_bf16_f32 v19, v38, v39
v_pk_fma_f32 v[44:45], v[44:45], s[34:35], v[248:249] op_sel_hi:[1,1,0]
v_exp_f32 v42, v42
v_pk_add_f32 v[250:251], v[250:251], v[40:41]
v_exp_f32 v43, v43
v_cvt_pk_bf16_f32 v20, v40, v41
v_pk_fma_f32 v[46:47], v[46:47], s[34:35], v[248:249] op_sel_hi:[1,1,0]
v_exp_f32 v44, v44
v_pk_add_f32 v[250:251], v[250:251], v[42:43]
v_exp_f32 v45, v45
v_cvt_pk_bf16_f32 v21, v42, v43
v_pk_fma_f32 v[48:49], v[48:49], s[34:35], v[248:249] op_sel_hi:[1,1,0]
v_exp_f32 v46, v46
v_pk_add_f32 v[250:251], v[250:251], v[44:45]
v_exp_f32 v47, v47
v_cvt_pk_bf16_f32 v22, v44, v45
v_pk_fma_f32 v[50:51], v[50:51], s[34:35], v[248:249] op_sel_hi:[1,1,0]
v_exp_f32 v48, v48
v_pk_add_f32 v[250:251], v[250:251], v[46:47]
v_exp_f32 v49, v49
v_cvt_pk_bf16_f32 v23, v46, v47
v_pk_fma_f32 v[52:53], v[52:53], s[34:35], v[248:249] op_sel_hi:[1,1,0]
v_exp_f32 v50, v50
v_pk_add_f32 v[250:251], v[250:251], v[48:49]
v_exp_f32 v51, v51
v_cvt_pk_bf16_f32 v24, v48, v49
v_pk_fma_f32 v[54:55], v[54:55], s[34:35], v[248:249] op_sel_hi:[1,1,0]
v_exp_f32 v52, v52
v_pk_add_f32 v[250:251], v[250:251], v[50:51]
v_exp_f32 v53, v53
v_cvt_pk_bf16_f32 v25, v50, v51
v_pk_fma_f32 v[56:57], v[56:57], s[34:35], v[248:249] op_sel_hi:[1,1,0]
v_exp_f32 v54, v54
v_pk_add_f32 v[250:251], v[250:251], v[52:53]
v_exp_f32 v55, v55
v_cvt_pk_bf16_f32 v26, v52, v53
v_pk_fma_f32 v[58:59], v[58:59], s[34:35], v[248:249] op_sel_hi:[1,1,0]
v_exp_f32 v56, v56
v_pk_add_f32 v[250:251], v[250:251], v[54:55]
v_exp_f32 v57, v57
s_xor_b32 s96, s42, 128
s_add_u32 m0, s39, 65536
s_waitcnt vmcnt(5)
buffer_load_dwordx4 v224, s[24:27], s96 offen nt lds
v_cvt_pk_bf16_f32 v27, v54, v55
v_pk_fma_f32 v[60:61], v[60:61], s[34:35], v[248:249] op_sel_hi:[1,1,0]
v_exp_f32 v58, v58
v_pk_add_f32 v[250:251], v[250:251], v[56:57]
v_exp_f32 v59, v59
v_cvt_pk_bf16_f32 v28, v56, v57
v_pk_fma_f32 v[62:63], v[62:63], s[34:35], v[248:249] op_sel_hi:[1,1,0]
v_exp_f32 v60, v60
v_pk_add_f32 v[250:251], v[250:251], v[58:59]
v_exp_f32 v61, v61
v_cvt_pk_bf16_f32 v29, v58, v59
v_exp_f32 v62, v62
v_pk_add_f32 v[250:251], v[250:251], v[60:61]
v_exp_f32 v63, v63
v_cvt_pk_bf16_f32 v30, v60, v61
v_pk_add_f32 v[250:251], v[250:251], v[62:63]
v_cvt_pk_bf16_f32 v31, v62, v63
v_add_f32 v244, v250, v251
v_mul_f32 v248, 0xbdb8aa3b, v242
v_pk_fma_f32 v[64:65], v[64:65], s[34:35], v[254:255] op_sel_hi:[1,1,0]
v_pk_fma_f32 v[66:67], v[66:67], s[34:35], v[254:255] op_sel_hi:[1,1,0]
v_exp_f32 v64, v64
v_exp_f32 v65, v65
v_pk_fma_f32 v[68:69], v[68:69], s[34:35], v[254:255] op_sel_hi:[1,1,0]
v_exp_f32 v66, v66
v_exp_f32 v67, v67
v_pk_fma_f32 v[70:71], v[70:71], s[34:35], v[254:255] op_sel_hi:[1,1,0]
v_exp_f32 v68, v68
v_pk_add_f32 v[250:251], v[64:65], v[66:67]
v_exp_f32 v69, v69
v_cvt_pk_bf16_f32 v32, v64, v65
v_cvt_pk_bf16_f32 v33, v66, v67
v_pk_fma_f32 v[72:73], v[72:73], s[34:35], v[254:255] op_sel_hi:[1,1,0]
v_exp_f32 v70, v70
v_pk_add_f32 v[250:251], v[250:251], v[68:69]
v_exp_f32 v71, v71
v_cvt_pk_bf16_f32 v34, v68, v69
v_pk_fma_f32 v[74:75], v[74:75], s[34:35], v[254:255] op_sel_hi:[1,1,0]
v_exp_f32 v72, v72
v_mov_b32 v249, v244
v_pk_add_f32 v[250:251], v[250:251], v[70:71]
v_exp_f32 v73, v73
v_cvt_pk_bf16_f32 v35, v70, v71
v_pk_fma_f32 v[76:77], v[76:77], s[34:35], v[254:255] op_sel_hi:[1,1,0]
v_exp_f32 v74, v74
s_xor_b32 s96, s42, 8320
s_add_u32 m0, s39, 69632
s_waitcnt vmcnt(5)
buffer_load_dwordx4 v224, s[24:27], s96 offen nt lds
v_pk_add_f32 v[250:251], v[250:251], v[72:73]
v_exp_f32 v75, v75
v_cvt_pk_bf16_f32 v36, v72, v73
v_pk_fma_f32 v[78:79], v[78:79], s[34:35], v[254:255] op_sel_hi:[1,1,0]
v_exp_f32 v76, v76
v_pk_add_f32 v[250:251], v[250:251], v[74:75]
v_exp_f32 v77, v77
v_cvt_pk_bf16_f32 v37, v74, v75
v_pk_fma_f32 v[80:81], v[80:81], s[34:35], v[254:255] op_sel_hi:[1,1,0]
v_exp_f32 v78, v78
v_pk_add_f32 v[250:251], v[250:251], v[76:77]
v_exp_f32 v79, v79
v_cvt_pk_bf16_f32 v38, v76, v77
v_pk_fma_f32 v[82:83], v[82:83], s[34:35], v[254:255] op_sel_hi:[1,1,0]
v_exp_f32 v80, v80
v_permlane32_swap_b32 v244, v249
v_pk_add_f32 v[250:251], v[250:251], v[78:79]
v_exp_f32 v81, v81
v_cvt_pk_bf16_f32 v39, v78, v79
v_pk_fma_f32 v[84:85], v[84:85], s[34:35], v[254:255] op_sel_hi:[1,1,0]
v_exp_f32 v82, v82
v_pk_add_f32 v[250:251], v[250:251], v[80:81]
v_exp_f32 v83, v83
v_cvt_pk_bf16_f32 v40, v80, v81
v_pk_fma_f32 v[86:87], v[86:87], s[34:35], v[254:255] op_sel_hi:[1,1,0]
v_exp_f32 v84, v84
v_pk_add_f32 v[250:251], v[250:251], v[82:83]
v_exp_f32 v85, v85
v_cvt_pk_bf16_f32 v41, v82, v83
v_pk_fma_f32 v[88:89], v[88:89], s[34:35], v[254:255] op_sel_hi:[1,1,0]
v_exp_f32 v86, v86
v_pk_add_f32 v[250:251], v[250:251], v[84:85]
v_exp_f32 v87, v87
v_cvt_pk_bf16_f32 v42, v84, v85
v_pk_fma_f32 v[90:91], v[90:91], s[34:35], v[254:255] op_sel_hi:[1,1,0]
v_exp_f32 v88, v88
v_add_f32 v244, v244, v249
v_pk_add_f32 v[250:251], v[250:251], v[86:87]
v_exp_f32 v89, v89
v_cvt_pk_bf16_f32 v43, v86, v87
v_pk_fma_f32 v[92:93], v[92:93], s[34:35], v[254:255] op_sel_hi:[1,1,0]
v_exp_f32 v90, v90
v_pk_add_f32 v[250:251], v[250:251], v[88:89]
s_xor_b32 s96, s42, 16512
s_add_u32 m0, s39, 73728
s_waitcnt vmcnt(5)
buffer_load_dwordx4 v224, s[24:27], s96 offen nt lds
v_exp_f32 v91, v91
v_cvt_pk_bf16_f32 v44, v88, v89
v_pk_fma_f32 v[94:95], v[94:95], s[34:35], v[254:255] op_sel_hi:[1,1,0]
v_exp_f32 v92, v92
v_pk_add_f32 v[250:251], v[250:251], v[90:91]
v_exp_f32 v93, v93
v_cvt_pk_bf16_f32 v45, v90, v91
v_pk_fma_f32 v[96:97], v[96:97], s[34:35], v[254:255] op_sel_hi:[1,1,0]
v_exp_f32 v94, v94
v_pk_add_f32 v[250:251], v[250:251], v[92:93]
v_exp_f32 v95, v95
v_cvt_pk_bf16_f32 v46, v92, v93
v_pk_fma_f32 v[98:99], v[98:99], s[34:35], v[254:255] op_sel_hi:[1,1,0]
v_exp_f32 v96, v96
v_mov_b32 v249, v244
v_pk_add_f32 v[250:251], v[250:251], v[94:95]
v_exp_f32 v97, v97
v_cvt_pk_bf16_f32 v47, v94, v95
v_pk_fma_f32 v[100:101], v[100:101], s[34:35], v[254:255] op_sel_hi:[1,1,0]
v_exp_f32 v98, v98
v_pk_add_f32 v[250:251], v[250:251], v[96:97]
v_exp_f32 v99, v99
v_cvt_pk_bf16_f32 v48, v96, v97
v_pk_fma_f32 v[102:103], v[102:103], s[34:35], v[254:255] op_sel_hi:[1,1,0]
v_exp_f32 v100, v100
v_pk_add_f32 v[250:251], v[250:251], v[98:99]
v_exp_f32 v101, v101
v_cvt_pk_bf16_f32 v49, v98, v99
v_pk_fma_f32 v[104:105], v[104:105], s[34:35], v[254:255] op_sel_hi:[1,1,0]
v_exp_f32 v102, v102
v_pk_add_f32 v[250:251], v[250:251], v[100:101]
v_exp_f32 v103, v103
v_cvt_pk_bf16_f32 v50, v100, v101
v_pk_fma_f32 v[106:107], v[106:107], s[34:35], v[254:255] op_sel_hi:[1,1,0]
v_exp_f32 v104, v104
v_permlane16_swap_b32 v244, v249
v_pk_add_f32 v[250:251], v[250:251], v[102:103]
v_exp_f32 v105, v105
v_cvt_pk_bf16_f32 v51, v102, v103
v_pk_fma_f32 v[108:109], v[108:109], s[34:35], v[254:255] op_sel_hi:[1,1,0]
v_exp_f32 v106, v106
v_pk_add_f32 v[250:251], v[250:251], v[104:105]
v_exp_f32 v107, v107
v_cvt_pk_bf16_f32 v52, v104, v105
s_xor_b32 s96, s42, 24704
s_add_u32 m0, s39, 77824
s_waitcnt vmcnt(5)
buffer_load_dwordx4 v224, s[24:27], s96 offen nt lds
v_pk_fma_f32 v[110:111], v[110:111], s[34:35], v[254:255] op_sel_hi:[1,1,0]
v_exp_f32 v108, v108
v_pk_add_f32 v[250:251], v[250:251], v[106:107]
v_exp_f32 v109, v109
v_cvt_pk_bf16_f32 v53, v106, v107
v_pk_fma_f32 v[112:113], v[112:113], s[34:35], v[254:255] op_sel_hi:[1,1,0]
v_exp_f32 v110, v110
v_pk_add_f32 v[250:251], v[250:251], v[108:109]
v_exp_f32 v111, v111
v_cvt_pk_bf16_f32 v54, v108, v109
v_pk_fma_f32 v[114:115], v[114:115], s[34:35], v[254:255] op_sel_hi:[1,1,0]
v_exp_f32 v112, v112
v_add_f32 v244, v244, v249
v_pk_add_f32 v[250:251], v[250:251], v[110:111]
v_exp_f32 v113, v113
v_cvt_pk_bf16_f32 v55, v110, v111
v_pk_fma_f32 v[116:117], v[116:117], s[34:35], v[254:255] op_sel_hi:[1,1,0]
v_exp_f32 v114, v114
v_pk_add_f32 v[250:251], v[250:251], v[112:113]
v_exp_f32 v115, v115
v_cvt_pk_bf16_f32 v56, v112, v113
v_pk_fma_f32 v[118:119], v[118:119], s[34:35], v[254:255] op_sel_hi:[1,1,0]
v_exp_f32 v116, v116
v_pk_add_f32 v[250:251], v[250:251], v[114:115]
v_exp_f32 v117, v117
v_cvt_pk_bf16_f32 v57, v114, v115
v_pk_fma_f32 v[120:121], v[120:121], s[34:35], v[254:255] op_sel_hi:[1,1,0]
v_exp_f32 v118, v118
v_pk_add_f32 v[250:251], v[250:251], v[116:117]
v_exp_f32 v119, v119
v_cvt_pk_bf16_f32 v58, v116, v117
v_pk_fma_f32 v[122:123], v[122:123], s[34:35], v[254:255] op_sel_hi:[1,1,0]
v_exp_f32 v120, v120
v_rcp_f32 v244, v244
v_pk_add_f32 v[250:251], v[250:251], v[118:119]
v_exp_f32 v121, v121
v_cvt_pk_bf16_f32 v59, v118, v119
v_pk_fma_f32 v[124:125], v[124:125], s[34:35], v[254:255] op_sel_hi:[1,1,0]
v_exp_f32 v122, v122
v_pk_add_f32 v[250:251], v[250:251], v[120:121]
v_exp_f32 v123, v123
v_cvt_pk_bf16_f32 v60, v120, v121
v_pk_fma_f32 v[126:127], v[126:127], s[34:35], v[254:255] op_sel_hi:[1,1,0]
v_exp_f32 v124, v124
s_xor_b32 s96, s42, 4224
s_add_u32 m0, s39, 81920
s_waitcnt vmcnt(5)
buffer_load_dwordx4 v224, s[24:27], s96 offen nt lds
v_pk_add_f32 v[250:251], v[250:251], v[122:123]
v_exp_f32 v125, v125
v_cvt_pk_bf16_f32 v61, v122, v123
v_exp_f32 v126, v126
v_pk_add_f32 v[250:251], v[250:251], v[124:125]
v_exp_f32 v127, v127
v_cvt_pk_bf16_f32 v62, v124, v125
v_pk_add_f32 v[250:251], v[250:251], v[126:127]
v_cvt_pk_bf16_f32 v63, v126, v127
v_add_f32 v245, v250, v251
v_mov_b32 v249, v245
v_pk_fma_f32 v[128:129], v[128:129], s[34:35], v[248:249] op_sel_hi:[1,1,0]
v_pk_fma_f32 v[130:131], v[130:131], s[34:35], v[248:249] op_sel_hi:[1,1,0]
v_exp_f32 v128, v128
v_exp_f32 v129, v129
v_pk_fma_f32 v[132:133], v[132:133], s[34:35], v[248:249] op_sel_hi:[1,1,0]
v_exp_f32 v130, v130
v_exp_f32 v131, v131
v_pk_fma_f32 v[134:135], v[134:135], s[34:35], v[248:249] op_sel_hi:[1,1,0]
v_exp_f32 v132, v132
v_pk_add_f32 v[250:251], v[128:129], v[130:131]
v_exp_f32 v133, v133
v_cvt_pk_bf16_f32 v64, v128, v129
v_cvt_pk_bf16_f32 v65, v130, v131
v_pk_fma_f32 v[136:137], v[136:137], s[34:35], v[248:249] op_sel_hi:[1,1,0]
v_exp_f32 v134, v134
v_pk_add_f32 v[250:251], v[250:251], v[132:133]
v_exp_f32 v135, v135
v_cvt_pk_bf16_f32 v66, v132, v133
v_pk_fma_f32 v[138:139], v[138:139], s[34:35], v[248:249] op_sel_hi:[1,1,0]
v_exp_f32 v136, v136
v_pk_add_f32 v[250:251], v[250:251], v[134:135]
v_exp_f32 v137, v137
v_cvt_pk_bf16_f32 v67, v134, v135
v_permlane32_swap_b32 v245, v249
v_pk_fma_f32 v[140:141], v[140:141], s[34:35], v[248:249] op_sel_hi:[1,1,0]
v_exp_f32 v138, v138
v_pk_add_f32 v[250:251], v[250:251], v[136:137]
v_exp_f32 v139, v139
v_cvt_pk_bf16_f32 v68, v136, v137
v_pk_fma_f32 v[142:143], v[142:143], s[34:35], v[248:249] op_sel_hi:[1,1,0]
v_exp_f32 v140, v140
v_pk_add_f32 v[250:251], v[250:251], v[138:139]
v_exp_f32 v141, v141
s_xor_b32 s96, s42, 12416
s_add_u32 m0, s39, 86016
s_waitcnt vmcnt(5)
buffer_load_dwordx4 v224, s[24:27], s96 offen nt lds
v_cvt_pk_bf16_f32 v69, v138, v139
v_pk_fma_f32 v[144:145], v[144:145], s[34:35], v[248:249] op_sel_hi:[1,1,0]
v_exp_f32 v142, v142
v_pk_add_f32 v[250:251], v[250:251], v[140:141]
v_exp_f32 v143, v143
v_cvt_pk_bf16_f32 v70, v140, v141
v_pk_fma_f32 v[146:147], v[146:147], s[34:35], v[248:249] op_sel_hi:[1,1,0]
v_exp_f32 v144, v144
v_pk_add_f32 v[250:251], v[250:251], v[142:143]
v_exp_f32 v145, v145
v_cvt_pk_bf16_f32 v71, v142, v143
v_pk_fma_f32 v[148:149], v[148:149], s[34:35], v[248:249] op_sel_hi:[1,1,0]
v_exp_f32 v146, v146
v_pk_add_f32 v[250:251], v[250:251], v[144:145]
v_add_f32 v245, v245, v249
v_exp_f32 v147, v147
v_cvt_pk_bf16_f32 v72, v144, v145
v_pk_fma_f32 v[150:151], v[150:151], s[34:35], v[248:249] op_sel_hi:[1,1,0]
v_exp_f32 v148, v148
v_pk_add_f32 v[250:251], v[250:251], v[146:147]
v_exp_f32 v149, v149
v_cvt_pk_bf16_f32 v73, v146, v147
v_pk_fma_f32 v[152:153], v[152:153], s[34:35], v[248:249] op_sel_hi:[1,1,0]
v_exp_f32 v150, v150
v_pk_add_f32 v[250:251], v[250:251], v[148:149]
v_exp_f32 v151, v151
v_cvt_pk_bf16_f32 v74, v148, v149
v_pk_fma_f32 v[154:155], v[154:155], s[34:35], v[248:249] op_sel_hi:[1,1,0]
v_exp_f32 v152, v152
v_pk_add_f32 v[250:251], v[250:251], v[150:151]
v_exp_f32 v153, v153
v_cvt_pk_bf16_f32 v75, v150, v151
v_pk_fma_f32 v[156:157], v[156:157], s[34:35], v[248:249] op_sel_hi:[1,1,0]
v_exp_f32 v154, v154
v_pk_add_f32 v[250:251], v[250:251], v[152:153]
v_exp_f32 v155, v155
v_cvt_pk_bf16_f32 v76, v152, v153
v_pk_fma_f32 v[158:159], v[158:159], s[34:35], v[248:249] op_sel_hi:[1,1,0]
v_mov_b32 v249, v245
v_exp_f32 v156, v156
v_pk_add_f32 v[250:251], v[250:251], v[154:155]
v_exp_f32 v157, v157
v_cvt_pk_bf16_f32 v77, v154, v155
v_pk_fma_f32 v[160:161], v[160:161], s[34:35], v[248:249] op_sel_hi:[1,1,0]
s_xor_b32 s96, s42, 20608
s_add_u32 m0, s39, 90112
s_waitcnt vmcnt(5)
buffer_load_dwordx4 v224, s[24:27], s96 offen nt lds
v_exp_f32 v158, v158
v_pk_add_f32 v[250:251], v[250:251], v[156:157]
v_exp_f32 v159, v159
v_cvt_pk_bf16_f32 v78, v156, v157
v_pk_fma_f32 v[162:163], v[162:163], s[34:35], v[248:249] op_sel_hi:[1,1,0]
v_exp_f32 v160, v160
v_pk_add_f32 v[250:251], v[250:251], v[158:159]
v_exp_f32 v161, v161
v_cvt_pk_bf16_f32 v79, v158, v159
v_pk_fma_f32 v[164:165], v[164:165], s[34:35], v[248:249] op_sel_hi:[1,1,0]
v_exp_f32 v162, v162
v_pk_add_f32 v[250:251], v[250:251], v[160:161]
v_exp_f32 v163, v163
v_cvt_pk_bf16_f32 v80, v160, v161
v_pk_fma_f32 v[166:167], v[166:167], s[34:35], v[248:249] op_sel_hi:[1,1,0]
v_exp_f32 v164, v164
v_pk_add_f32 v[250:251], v[250:251], v[162:163]
v_exp_f32 v165, v165
v_permlane16_swap_b32 v245, v249
v_cvt_pk_bf16_f32 v81, v162, v163
v_pk_fma_f32 v[168:169], v[168:169], s[34:35], v[248:249] op_sel_hi:[1,1,0]
v_exp_f32 v166, v166
v_pk_add_f32 v[250:251], v[250:251], v[164:165]
v_exp_f32 v167, v167
v_cvt_pk_bf16_f32 v82, v164, v165
v_pk_fma_f32 v[170:171], v[170:171], s[34:35], v[248:249] op_sel_hi:[1,1,0]
v_exp_f32 v168, v168
v_pk_add_f32 v[250:251], v[250:251], v[166:167]
v_exp_f32 v169, v169
v_cvt_pk_bf16_f32 v83, v166, v167
v_pk_fma_f32 v[172:173], v[172:173], s[34:35], v[248:249] op_sel_hi:[1,1,0]
v_exp_f32 v170, v170
v_pk_add_f32 v[250:251], v[250:251], v[168:169]
v_exp_f32 v171, v171
v_cvt_pk_bf16_f32 v84, v168, v169
v_pk_fma_f32 v[174:175], v[174:175], s[34:35], v[248:249] op_sel_hi:[1,1,0]
v_exp_f32 v172, v172
v_pk_add_f32 v[250:251], v[250:251], v[170:171]
v_exp_f32 v173, v173
v_cvt_pk_bf16_f32 v85, v170, v171
v_pk_fma_f32 v[176:177], v[176:177], s[34:35], v[248:249] op_sel_hi:[1,1,0]
v_exp_f32 v174, v174
v_add_f32 v245, v245, v249
v_pk_add_f32 v[250:251], v[250:251], v[172:173]
s_xor_b32 s96, s42, 28800
s_add_u32 m0, s39, 94208
s_waitcnt vmcnt(5)
buffer_load_dwordx4 v224, s[24:27], s96 offen nt lds
v_exp_f32 v175, v175
v_cvt_pk_bf16_f32 v86, v172, v173
v_pk_fma_f32 v[178:179], v[178:179], s[34:35], v[248:249] op_sel_hi:[1,1,0]
v_exp_f32 v176, v176
v_pk_add_f32 v[250:251], v[250:251], v[174:175]
v_exp_f32 v177, v177
v_cvt_pk_bf16_f32 v87, v174, v175
v_pk_fma_f32 v[180:181], v[180:181], s[34:35], v[248:249] op_sel_hi:[1,1,0]
v_exp_f32 v178, v178
v_pk_add_f32 v[250:251], v[250:251], v[176:177]
v_exp_f32 v179, v179
v_cvt_pk_bf16_f32 v88, v176, v177
v_pk_fma_f32 v[182:183], v[182:183], s[34:35], v[248:249] op_sel_hi:[1,1,0]
v_exp_f32 v180, v180
v_pk_add_f32 v[250:251], v[250:251], v[178:179]
v_exp_f32 v181, v181
v_cvt_pk_bf16_f32 v89, v178, v179
v_pk_fma_f32 v[184:185], v[184:185], s[34:35], v[248:249] op_sel_hi:[1,1,0]
v_exp_f32 v182, v182
v_pk_add_f32 v[250:251], v[250:251], v[180:181]
v_exp_f32 v183, v183
v_cvt_pk_bf16_f32 v90, v180, v181
v_rcp_f32 v245, v245
v_pk_fma_f32 v[186:187], v[186:187], s[34:35], v[248:249] op_sel_hi:[1,1,0]
v_exp_f32 v184, v184
v_pk_add_f32 v[250:251], v[250:251], v[182:183]
v_exp_f32 v185, v185
v_cvt_pk_bf16_f32 v91, v182, v183
v_pk_fma_f32 v[188:189], v[188:189], s[34:35], v[248:249] op_sel_hi:[1,1,0]
v_exp_f32 v186, v186
v_pk_add_f32 v[250:251], v[250:251], v[184:185]
v_exp_f32 v187, v187
v_cvt_pk_bf16_f32 v92, v184, v185
v_pk_fma_f32 v[190:191], v[190:191], s[34:35], v[248:249] op_sel_hi:[1,1,0]
v_exp_f32 v188, v188
v_pk_add_f32 v[250:251], v[250:251], v[186:187]
v_exp_f32 v189, v189
v_cvt_pk_bf16_f32 v93, v186, v187
v_exp_f32 v190, v190
v_pk_add_f32 v[250:251], v[250:251], v[188:189]
v_exp_f32 v191, v191
v_cvt_pk_bf16_f32 v94, v188, v189
v_pk_add_f32 v[250:251], v[250:251], v[190:191]
s_xor_b32 s96, s43, 0
s_add_u32 m0, s39, 0
s_waitcnt vmcnt(5)
buffer_load_dwordx4 v224, s[20:23], s96 offen nt lds
v_cvt_pk_bf16_f32 v95, v190, v191
v_add_f32 v246, v250, v251
v_accvgpr_read_b32 v160, a32
v_accvgpr_read_b32 v161, a33
v_accvgpr_read_b32 v162, a34
v_accvgpr_read_b32 v163, a35
v_accvgpr_read_b32 v164, a36
v_accvgpr_read_b32 v165, a37
v_accvgpr_read_b32 v166, a38
v_accvgpr_read_b32 v167, a39
v_max3_f32 v237, v237, v160, v161
v_max3_f32 v237, v237, v162, v163
v_accvgpr_read_b32 v168, a40
v_accvgpr_read_b32 v169, a41
v_accvgpr_read_b32 v170, a42
v_accvgpr_read_b32 v171, a43
v_max3_f32 v237, v237, v164, v165
v_max3_f32 v237, v237, v166, v167
v_accvgpr_read_b32 v172, a44
v_accvgpr_read_b32 v173, a45
v_accvgpr_read_b32 v174, a46
v_accvgpr_read_b32 v175, a47
v_max3_f32 v237, v237, v168, v169
v_max3_f32 v237, v237, v170, v171
v_accvgpr_read_b32 v176, a48
v_accvgpr_read_b32 v177, a49
v_accvgpr_read_b32 v178, a50
v_accvgpr_read_b32 v179, a51
v_max3_f32 v237, v237, v172, v173
v_max3_f32 v237, v237, v174, v175
v_accvgpr_read_b32 v180, a52
v_accvgpr_read_b32 v181, a53
v_accvgpr_read_b32 v182, a54
v_accvgpr_read_b32 v183, a55
v_max3_f32 v237, v237, v176, v177
v_max3_f32 v237, v237, v178, v179
v_accvgpr_read_b32 v184, a56
v_accvgpr_read_b32 v185, a57
v_accvgpr_read_b32 v186, a58
v_accvgpr_read_b32 v187, a59
v_max3_f32 v237, v237, v180, v181
v_max3_f32 v237, v237, v182, v183
v_accvgpr_read_b32 v188, a60
v_accvgpr_read_b32 v189, a61
v_accvgpr_read_b32 v190, a62
v_accvgpr_read_b32 v191, a63
v_max3_f32 v237, v237, v184, v185
v_max3_f32 v237, v237, v186, v187
v_max3_f32 v237, v237, v188, v189
v_max3_f32 v237, v237, v190, v191
v_mov_b32 v255, v237
v_mov_b32 v249, v246
s_nop 0
v_permlane32_swap_b32 v237, v255
v_permlane32_swap_b32 v246, v249
v_max_f32 v237, v237, v255
v_add_f32 v246, v246, v249
v_mov_b32 v255, v237
v_mov_b32 v249, v246
s_nop 0
v_permlane16_swap_b32 v237, v255
s_xor_b32 s96, s43, 8192
s_add_u32 m0, s39, 4096
s_waitcnt vmcnt(5)
buffer_load_dwordx4 v224, s[20:23], s96 offen nt lds
v_permlane16_swap_b32 v246, v249
v_max_f32 v237, v237, v255
v_add_f32 v246, v246, v249
v_mul_f32 v254, 0xbdb8aa3b, v237
v_rcp_f32 v246, v246
v_pk_fma_f32 v[192:193], v[192:193], s[34:35], v[254:255] op_sel_hi:[1,1,0]
v_pk_fma_f32 v[194:195], v[194:195], s[34:35], v[254:255] op_sel_hi:[1,1,0]
v_exp_f32 v192, v192
v_exp_f32 v193, v193
v_pk_fma_f32 v[196:197], v[196:197], s[34:35], v[254:255] op_sel_hi:[1,1,0]
v_exp_f32 v194, v194
v_exp_f32 v195, v195
v_pk_fma_f32 v[198:199], v[198:199], s[34:35], v[254:255] op_sel_hi:[1,1,0]
v_exp_f32 v196, v196
v_pk_add_f32 v[250:251], v[192:193], v[194:195]
v_exp_f32 v197, v197
v_cvt_pk_bf16_f32 v96, v192, v193
v_cvt_pk_bf16_f32 v97, v194, v195
v_pk_fma_f32 v[200:201], v[200:201], s[34:35], v[254:255] op_sel_hi:[1,1,0]
v_exp_f32 v198, v198
v_pk_add_f32 v[250:251], v[250:251], v[196:197]
v_exp_f32 v199, v199
v_cvt_pk_bf16_f32 v98, v196, v197
v_pk_fma_f32 v[202:203], v[202:203], s[34:35], v[254:255] op_sel_hi:[1,1,0]
v_exp_f32 v200, v200
v_pk_add_f32 v[250:251], v[250:251], v[198:199]
v_exp_f32 v201, v201
v_cvt_pk_bf16_f32 v99, v198, v199
v_pk_fma_f32 v[204:205], v[204:205], s[34:35], v[254:255] op_sel_hi:[1,1,0]
v_exp_f32 v202, v202
v_pk_add_f32 v[250:251], v[250:251], v[200:201]
v_exp_f32 v203, v203
v_cvt_pk_bf16_f32 v100, v200, v201
v_pk_fma_f32 v[206:207], v[206:207], s[34:35], v[254:255] op_sel_hi:[1,1,0]
v_exp_f32 v204, v204
v_pk_add_f32 v[250:251], v[250:251], v[202:203]
v_exp_f32 v205, v205
v_cvt_pk_bf16_f32 v101, v202, v203
v_pk_fma_f32 v[208:209], v[208:209], s[34:35], v[254:255] op_sel_hi:[1,1,0]
v_exp_f32 v206, v206
v_pk_add_f32 v[250:251], v[250:251], v[204:205]
v_exp_f32 v207, v207
s_xor_b32 s96, s43, 16384
s_add_u32 m0, s39, 8192
s_waitcnt vmcnt(5)
buffer_load_dwordx4 v224, s[20:23], s96 offen nt lds
v_cvt_pk_bf16_f32 v102, v204, v205
v_pk_fma_f32 v[210:211], v[210:211], s[34:35], v[254:255] op_sel_hi:[1,1,0]
v_exp_f32 v208, v208
v_pk_add_f32 v[250:251], v[250:251], v[206:207]
v_exp_f32 v209, v209
v_cvt_pk_bf16_f32 v103, v206, v207
v_pk_fma_f32 v[212:213], v[212:213], s[34:35], v[254:255] op_sel_hi:[1,1,0]
v_exp_f32 v210, v210
v_pk_add_f32 v[250:251], v[250:251], v[208:209]
v_exp_f32 v211, v211
v_cvt_pk_bf16_f32 v104, v208, v209
v_pk_fma_f32 v[214:215], v[214:215], s[34:35], v[254:255] op_sel_hi:[1,1,0]
v_exp_f32 v212, v212
v_pk_add_f32 v[250:251], v[250:251], v[210:211]
v_exp_f32 v213, v213
v_cvt_pk_bf16_f32 v105, v210, v211
v_pk_fma_f32 v[216:217], v[216:217], s[34:35], v[254:255] op_sel_hi:[1,1,0]
v_exp_f32 v214, v214
v_pk_add_f32 v[250:251], v[250:251], v[212:213]
v_exp_f32 v215, v215
v_cvt_pk_bf16_f32 v106, v212, v213
v_pk_fma_f32 v[218:219], v[218:219], s[34:35], v[254:255] op_sel_hi:[1,1,0]
v_exp_f32 v216, v216
v_pk_add_f32 v[250:251], v[250:251], v[214:215]
v_exp_f32 v217, v217
v_cvt_pk_bf16_f32 v107, v214, v215
v_pk_fma_f32 v[220:221], v[220:221], s[34:35], v[254:255] op_sel_hi:[1,1,0]
v_exp_f32 v218, v218
v_pk_add_f32 v[250:251], v[250:251], v[216:217]
v_exp_f32 v219, v219
v_cvt_pk_bf16_f32 v108, v216, v217
v_pk_fma_f32 v[222:223], v[222:223], s[34:35], v[254:255] op_sel_hi:[1,1,0]
v_exp_f32 v220, v220
v_pk_add_f32 v[250:251], v[250:251], v[218:219]
v_exp_f32 v221, v221
v_cvt_pk_bf16_f32 v109, v218, v219
v_pk_fma_f32 v[160:161], v[160:161], s[34:35], v[254:255] op_sel_hi:[1,1,0]
v_exp_f32 v222, v222
v_pk_add_f32 v[250:251], v[250:251], v[220:221]
v_exp_f32 v223, v223
v_cvt_pk_bf16_f32 v110, v220, v221
v_pk_fma_f32 v[162:163], v[162:163], s[34:35], v[254:255] op_sel_hi:[1,1,0]
s_xor_b32 s96, s43, 24576
s_add_u32 m0, s39, 12288
s_waitcnt vmcnt(5)
buffer_load_dwordx4 v224, s[20:23], s96 offen nt lds
v_exp_f32 v160, v160
s_barrier
v_add_u32 v232, 131072, v227
v_xor_b32 v233, 32, v232
v_xor_b32 v234, 64, v232
v_xor_b32 v235, 96, v232
ds_read_b64_tr_b16 a[0:1], v232 offset:0
v_pk_add_f32 v[250:251], v[250:251], v[222:223]
v_exp_f32 v161, v161
v_cvt_pk_bf16_f32 v111, v222, v223
v_pk_fma_f32 v[164:165], v[164:165], s[34:35], v[254:255] op_sel_hi:[1,1,0]
ds_read_b64_tr_b16 a[2:3], v232 offset:2048
v_exp_f32 v162, v162
v_pk_add_f32 v[250:251], v[250:251], v[160:161]
v_exp_f32 v163, v163
v_cvt_pk_bf16_f32 v112, v160, v161
ds_read_b64_tr_b16 a[4:5], v232 offset:4096
v_pk_fma_f32 v[166:167], v[166:167], s[34:35], v[254:255] op_sel_hi:[1,1,0]
v_exp_f32 v164, v164
v_pk_add_f32 v[250:251], v[250:251], v[162:163]
v_exp_f32 v165, v165
ds_read_b64_tr_b16 a[6:7], v232 offset:6144
v_cvt_pk_bf16_f32 v113, v162, v163
v_pk_fma_f32 v[168:169], v[168:169], s[34:35], v[254:255] op_sel_hi:[1,1,0]
v_exp_f32 v166, v166
ds_read_b64_tr_b16 a[8:9], v232 offset:8192
v_pk_add_f32 v[250:251], v[250:251], v[164:165]
v_exp_f32 v167, v167
v_cvt_pk_bf16_f32 v114, v164, v165
v_pk_fma_f32 v[170:171], v[170:171], s[34:35], v[254:255] op_sel_hi:[1,1,0]
ds_read_b64_tr_b16 a[10:11], v232 offset:10240
v_exp_f32 v168, v168
v_pk_add_f32 v[250:251], v[250:251], v[166:167]
v_exp_f32 v169, v169
v_cvt_pk_bf16_f32 v115, v166, v167
ds_read_b64_tr_b16 a[12:13], v232 offset:12288
v_pk_fma_f32 v[172:173], v[172:173], s[34:35], v[254:255] op_sel_hi:[1,1,0]
v_exp_f32 v170, v170
v_pk_add_f32 v[250:251], v[250:251], v[168:169]
v_exp_f32 v171, v171
ds_read_b64_tr_b16 a[14:15], v232 offset:14336
v_cvt_pk_bf16_f32 v116, v168, v169
v_pk_fma_f32 v[174:175], v[174:175], s[34:35], v[254:255] op_sel_hi:[1,1,0]
v_exp_f32 v172, v172
ds_read_b64_tr_b16 a[16:17], v232 offset:16384
v_pk_add_f32 v[250:251], v[250:251], v[170:171]
v_exp_f32 v173, v173
v_cvt_pk_bf16_f32 v117, v170, v171
v_pk_fma_f32 v[176:177], v[176:177], s[34:35], v[254:255] op_sel_hi:[1,1,0]
ds_read_b64_tr_b16 a[18:19], v232 offset:18432
v_exp_f32 v174, v174
v_pk_add_f32 v[250:251], v[250:251], v[172:173]
v_exp_f32 v175, v175
v_cvt_pk_bf16_f32 v118, v172, v173
ds_read_b64_tr_b16 a[20:21], v232 offset:20480
v_pk_fma_f32 v[178:179], v[178:179], s[34:35], v[254:255] op_sel_hi:[1,1,0]
v_exp_f32 v176, v176
v_pk_add_f32 v[250:251], v[250:251], v[174:175]
s_xor_b32 s96, s43, 4096
s_add_u32 m0, s39, 16384
s_waitcnt vmcnt(5)
buffer_load_dwordx4 v224, s[20:23], s96 offen nt lds
v_exp_f32 v177, v177
ds_read_b64_tr_b16 a[22:23], v232 offset:22528
v_cvt_pk_bf16_f32 v119, v174, v175
v_pk_fma_f32 v[180:181], v[180:181], s[34:35], v[254:255] op_sel_hi:[1,1,0]
v_exp_f32 v178, v178
ds_read_b64_tr_b16 a[24:25], v232 offset:24576
v_pk_add_f32 v[250:251], v[250:251], v[176:177]
v_exp_f32 v179, v179
v_cvt_pk_bf16_f32 v120, v176, v177
v_pk_fma_f32 v[182:183], v[182:183], s[34:35], v[254:255] op_sel_hi:[1,1,0]
ds_read_b64_tr_b16 a[26:27], v232 offset:26624
v_exp_f32 v180, v180
v_pk_add_f32 v[250:251], v[250:251], v[178:179]
v_exp_f32 v181, v181
v_cvt_pk_bf16_f32 v121, v178, v179
ds_read_b64_tr_b16 a[28:29], v232 offset:28672
v_pk_fma_f32 v[184:185], v[184:185], s[34:35], v[254:255] op_sel_hi:[1,1,0]
v_exp_f32 v182, v182
v_pk_add_f32 v[250:251], v[250:251], v[180:181]
v_exp_f32 v183, v183
s_waitcnt lgkmcnt(8)
ds_read_b64_tr_b16 a[30:31], v232 offset:30720
v_cvt_pk_bf16_f32 v122, v180, v181
v_pk_fma_f32 v[186:187], v[186:187], s[34:35], v[254:255] op_sel_hi:[1,1,0]
v_exp_f32 v184, v184
v_pk_add_f32 v[250:251], v[250:251], v[182:183]
v_exp_f32 v185, v185
v_cvt_pk_bf16_f32 v123, v182, v183
v_pk_fma_f32 v[188:189], v[188:189], s[34:35], v[254:255] op_sel_hi:[1,1,0]
v_exp_f32 v186, v186
v_pk_add_f32 v[250:251], v[250:251], v[184:185]
v_exp_f32 v187, v187
v_cvt_pk_bf16_f32 v124, v184, v185
v_pk_fma_f32 v[190:191], v[190:191], s[34:35], v[254:255] op_sel_hi:[1,1,0]
v_exp_f32 v188, v188
v_pk_add_f32 v[250:251], v[250:251], v[186:187]
v_exp_f32 v189, v189
v_cvt_pk_bf16_f32 v125, v186, v187
v_exp_f32 v190, v190
v_pk_add_f32 v[250:251], v[250:251], v[188:189]
v_exp_f32 v191, v191
v_cvt_pk_bf16_f32 v126, v188, v189
v_pk_add_f32 v[250:251], v[250:251], v[190:191]
v_cvt_pk_bf16_f32 v127, v190, v191
v_add_f32 v247, v250, v251
s_waitcnt lgkmcnt(0)
v_mfma_f32_16x16x32_bf16 v[176:179], a[0:3], v[0:3], 0
v_add_u32 v236, 98304, v226
v_xor_b32 v237, 64, v236
ds_read_b128 v[192:195], v236 offset:0
ds_read_b128 v[196:199], v237 offset:0
ds_read_b128 v[200:203], v236 offset:8192
ds_read_b128 v[204:207], v237 offset:8192
ds_read_b128 v[208:211], v236 offset:16384
ds_read_b128 v[212:215], v237 offset:16384
ds_read_b128 v[216:219], v236 offset:24576
ds_read_b128 v[220:223], v237 offset:24576
s_xor_b32 s96, s43, 12288
s_add_u32 m0, s39, 20480
s_waitcnt vmcnt(4)
buffer_load_dwordx4 v224, s[20:23], s96 offen nt lds
v_mov_b32 v249, v247
v_mfma_f32_16x16x32_bf16 v[176:179], a[4:7], v[4:7], v[176:179]
ds_read_b64_tr_b16 a[32:33], v233 offset:0
v_permlane32_swap_b32 v247, v249
v_mfma_f32_16x16x32_bf16 v[176:179], a[8:11], v[8:11], v[176:179]
ds_read_b64_tr_b16 a[34:35], v233 offset:2048
v_add_f32 v247, v247, v249
v_mfma_f32_16x16x32_bf16 v[176:179], a[12:15], v[12:15], v[176:179]
v_mfma_f32_16x16x32_bf16 v[176:179], a[16:19], v[16:19], v[176:179]
ds_read_b64_tr_b16 a[36:37], v233 offset:4096
v_mov_b32 v249, v247
v_mfma_f32_16x16x32_bf16 v[176:179], a[20:23], v[20:23], v[176:179]
s_xor_b32 s96, s43, 20480
s_add_u32 m0, s39, 24576
s_waitcnt vmcnt(4)
buffer_load_dwordx4 v224, s[20:23], s96 offen nt lds
ds_read_b64_tr_b16 a[38:39], v233 offset:6144
v_permlane16_swap_b32 v247, v249
v_mfma_f32_16x16x32_bf16 v[176:179], a[24:27], v[24:27], v[176:179]
v_mfma_f32_16x16x32_bf16 v[176:179], a[28:31], v[28:31], v[176:179]
ds_read_b64_tr_b16 a[40:41], v233 offset:8192
v_add_f32 v247, v247, v249
v_mfma_f32_16x16x32_bf16 v[180:183], a[0:3], v[32:35], 0
ds_read_b64_tr_b16 a[42:43], v233 offset:10240
v_rcp_f32 v247, v247
v_mfma_f32_16x16x32_bf16 v[180:183], a[4:7], v[36:39], v[180:183]
v_mfma_f32_16x16x32_bf16 v[180:183], a[8:11], v[40:43], v[180:183]
ds_read_b64_tr_b16 a[44:45], v233 offset:12288
v_mfma_f32_16x16x32_bf16 v[180:183], a[12:15], v[44:47], v[180:183]
s_waitcnt lgkmcnt(8)
ds_read_b64_tr_b16 a[46:47], v233 offset:14336
v_mul_f32 v176, v244, v176
v_mfma_f32_16x16x32_bf16 v[180:183], a[16:19], v[48:51], v[180:183]
v_mul_f32 v177, v244, v177
v_mfma_f32_16x16x32_bf16 v[180:183], a[20:23], v[52:55], v[180:183]
ds_read_b64_tr_b16 a[48:49], v233 offset:16384
v_mul_f32 v178, v244, v178
v_mfma_f32_16x16x32_bf16 v[180:183], a[24:27], v[56:59], v[180:183]
ds_read_b64_tr_b16 a[50:51], v233 offset:18432
v_mul_f32 v179, v244, v179
v_mfma_f32_16x16x32_bf16 v[180:183], a[28:31], v[60:63], v[180:183]
s_xor_b32 s96, s43, 28672
s_add_u32 m0, s39, 28672
s_waitcnt vmcnt(4)
buffer_load_dwordx4 v224, s[20:23], s96 offen nt lds
v_cvt_pk_bf16_f32 v152, v176, v177
v_mfma_f32_16x16x32_bf16 v[184:187], a[0:3], v[64:67], 0
ds_read_b64_tr_b16 a[52:53], v233 offset:20480
v_cvt_pk_bf16_f32 v153, v178, v179
v_mfma_f32_16x16x32_bf16 v[184:187], a[4:7], v[68:71], v[184:187]
ds_read_b64_tr_b16 a[54:55], v233 offset:22528
v_mfma_f32_16x16x32_bf16 v[184:187], a[8:11], v[72:75], v[184:187]
v_mfma_f32_16x16x32_bf16 v[184:187], a[12:15], v[76:79], v[184:187]
ds_read_b64_tr_b16 a[56:57], v233 offset:24576
v_mul_f32 v180, v245, v180
v_mfma_f32_16x16x32_bf16 v[184:187], a[16:19], v[80:83], v[184:187]
ds_read_b64_tr_b16 a[58:59], v233 offset:26624
v_mul_f32 v181, v245, v181
v_mfma_f32_16x16x32_bf16 v[184:187], a[20:23], v[84:87], v[184:187]
v_mul_f32 v182, v245, v182
v_mfma_f32_16x16x32_bf16 v[184:187], a[24:27], v[88:91], v[184:187]
s_waitcnt lgkmcnt(8)
ds_read_b64_tr_b16 a[60:61], v233 offset:28672
v_mul_f32 v183, v245, v183
v_mfma_f32_16x16x32_bf16 v[184:187], a[28:31], v[92:95], v[184:187]
ds_read_b64_tr_b16 a[62:63], v233 offset:30720
v_cvt_pk_bf16_f32 v158, v180, v181
v_mfma_f32_16x16x32_bf16 v[188:191], a[0:3], v[96:99], 0
v_cvt_pk_bf16_f32 v159, v182, v183
v_mfma_f32_16x16x32_bf16 v[188:191], a[4:7], v[100:103], v[188:191]
s_xor_b32 s96, s42, 256
s_add_u32 m0, s39, 32768
s_waitcnt vmcnt(4)
buffer_load_dwordx4 v224, s[24:27], s96 offen nt lds
v_mfma_f32_16x16x32_bf16 v[188:191], a[8:11], v[104:107], v[188:191]
v_mfma_f32_16x16x32_bf16 v[188:191], a[12:15], v[108:111], v[188:191]
v_mul_f32 v184, v246, v184
v_mfma_f32_16x16x32_bf16 v[188:191], a[16:19], v[112:115], v[188:191]
v_mul_f32 v185, v246, v185
v_mfma_f32_16x16x32_bf16 v[188:191], a[20:23], v[116:119], v[188:191]
v_mul_f32 v186, v246, v186
v_mfma_f32_16x16x32_bf16 v[188:191], a[24:27], v[120:123], v[188:191]
v_mul_f32 v187, v246, v187
v_mfma_f32_16x16x32_bf16 v[188:191], a[28:31], v[124:127], v[188:191]
v_cvt_pk_bf16_f32 v164, v184, v185
s_waitcnt lgkmcnt(0)
v_mfma_f32_16x16x32_bf16 v[176:179], a[32:35], v[0:3], 0
v_cvt_pk_bf16_f32 v165, v186, v187
v_mfma_f32_16x16x32_bf16 v[176:179], a[36:39], v[4:7], v[176:179]
ds_read_b64_tr_b16 a[0:1], v234 offset:0
v_mfma_f32_16x16x32_bf16 v[176:179], a[40:43], v[8:11], v[176:179]
ds_read_b64_tr_b16 a[2:3], v234 offset:2048
v_mfma_f32_16x16x32_bf16 v[176:179], a[44:47], v[12:15], v[176:179]
s_xor_b32 s96, s42, 8448
s_add_u32 m0, s39, 36864
s_waitcnt vmcnt(4)
buffer_load_dwordx4 v224, s[24:27], s96 offen nt lds
v_mul_f32 v188, v247, v188
v_mfma_f32_16x16x32_bf16 v[176:179], a[48:51], v[16:19], v[176:179]
ds_read_b64_tr_b16 a[4:5], v234 offset:4096
v_mul_f32 v189, v247, v189
v_mfma_f32_16x16x32_bf16 v[176:179], a[52:55], v[20:23], v[176:179]
ds_read_b64_tr_b16 a[6:7], v234 offset:6144
v_mul_f32 v190, v247, v190
v_mfma_f32_16x16x32_bf16 v[176:179], a[56:59], v[24:27], v[176:179]
v_mul_f32 v191, v247, v191
v_mfma_f32_16x16x32_bf16 v[176:179], a[60:63], v[28:31], v[176:179]
ds_read_b64_tr_b16 a[8:9], v234 offset:8192
v_cvt_pk_bf16_f32 v170, v188, v189
v_mfma_f32_16x16x32_bf16 v[180:183], a[32:35], v[32:35], 0
ds_read_b64_tr_b16 a[10:11], v234 offset:10240
v_cvt_pk_bf16_f32 v171, v190, v191
v_mfma_f32_16x16x32_bf16 v[180:183], a[36:39], v[36:39], v[180:183]
v_mfma_f32_16x16x32_bf16 v[180:183], a[40:43], v[40:43], v[180:183]
ds_read_b64_tr_b16 a[12:13], v234 offset:12288
v_mfma_f32_16x16x32_bf16 v[180:183], a[44:47], v[44:47], v[180:183]
ds_read_b64_tr_b16 a[14:15], v234 offset:14336
v_mul_f32 v176, v244, v176
v_mfma_f32_16x16x32_bf16 v[180:183], a[48:51], v[48:51], v[180:183]
s_xor_b32 s96, s42, 16640
s_add_u32 m0, s39, 40960
s_waitcnt vmcnt(4)
buffer_load_dwordx4 v224, s[24:27], s96 offen nt lds
v_mul_f32 v177, v244, v177
v_mfma_f32_16x16x32_bf16 v[180:183], a[52:55], v[52:55], v[180:183]
ds_read_b64_tr_b16 a[16:17], v234 offset:16384
v_mul_f32 v178, v244, v178
v_mfma_f32_16x16x32_bf16 v[180:183], a[56:59], v[56:59], v[180:183]
ds_read_b64_tr_b16 a[18:19], v234 offset:18432
v_mul_f32 v179, v244, v179
v_mfma_f32_16x16x32_bf16 v[180:183], a[60:63], v[60:63], v[180:183]
v_cvt_pk_bf16_f32 v154, v176, v177
v_mfma_f32_16x16x32_bf16 v[184:187], a[32:35], v[64:67], 0
ds_read_b64_tr_b16 a[20:21], v234 offset:20480
v_cvt_pk_bf16_f32 v155, v178, v179
v_mfma_f32_16x16x32_bf16 v[184:187], a[36:39], v[68:71], v[184:187]
ds_read_b64_tr_b16 a[22:23], v234 offset:22528
v_mfma_f32_16x16x32_bf16 v[184:187], a[40:43], v[72:75], v[184:187]
v_mfma_f32_16x16x32_bf16 v[184:187], a[44:47], v[76:79], v[184:187]
ds_read_b64_tr_b16 a[24:25], v234 offset:24576
v_mul_f32 v180, v245, v180
v_mfma_f32_16x16x32_bf16 v[184:187], a[48:51], v[80:83], v[184:187]
ds_read_b64_tr_b16 a[26:27], v234 offset:26624
v_mul_f32 v181, v245, v181
v_mfma_f32_16x16x32_bf16 v[184:187], a[52:55], v[84:87], v[184:187]
v_mul_f32 v182, v245, v182
v_mfma_f32_16x16x32_bf16 v[184:187], a[56:59], v[88:91], v[184:187]
s_xor_b32 s96, s42, 24832
s_add_u32 m0, s39, 45056
s_waitcnt vmcnt(4)
buffer_load_dwordx4 v224, s[24:27], s96 offen nt lds
ds_read_b64_tr_b16 a[28:29], v234 offset:28672
v_mul_f32 v183, v245, v183
v_mfma_f32_16x16x32_bf16 v[184:187], a[60:63], v[92:95], v[184:187]
s_waitcnt lgkmcnt(8)
ds_read_b64_tr_b16 a[30:31], v234 offset:30720
v_cvt_pk_bf16_f32 v160, v180, v181
v_mfma_f32_16x16x32_bf16 v[188:191], a[32:35], v[96:99], 0
v_cvt_pk_bf16_f32 v161, v182, v183
v_mfma_f32_16x16x32_bf16 v[188:191], a[36:39], v[100:103], v[188:191]
v_mfma_f32_16x16x32_bf16 v[188:191], a[40:43], v[104:107], v[188:191]
v_mfma_f32_16x16x32_bf16 v[188:191], a[44:47], v[108:111], v[188:191]
v_mul_f32 v184, v246, v184
v_mfma_f32_16x16x32_bf16 v[188:191], a[48:51], v[112:115], v[188:191]
v_mul_f32 v185, v246, v185
v_mfma_f32_16x16x32_bf16 v[188:191], a[52:55], v[116:119], v[188:191]
v_mul_f32 v186, v246, v186
v_mfma_f32_16x16x32_bf16 v[188:191], a[56:59], v[120:123], v[188:191]
v_mul_f32 v187, v246, v187
v_mfma_f32_16x16x32_bf16 v[188:191], a[60:63], v[124:127], v[188:191]
v_cvt_pk_bf16_f32 v166, v184, v185
s_waitcnt lgkmcnt(0)
v_mfma_f32_16x16x32_bf16 v[176:179], a[0:3], v[0:3], 0
s_xor_b32 s96, s42, 4352
s_add_u32 m0, s39, 49152
s_waitcnt vmcnt(4)
buffer_load_dwordx4 v224, s[24:27], s96 offen nt lds
v_cvt_pk_bf16_f32 v167, v186, v187
v_mfma_f32_16x16x32_bf16 v[176:179], a[4:7], v[4:7], v[176:179]
ds_read_b64_tr_b16 a[32:33], v235 offset:0
v_mfma_f32_16x16x32_bf16 v[176:179], a[8:11], v[8:11], v[176:179]
ds_read_b64_tr_b16 a[34:35], v235 offset:2048
v_mfma_f32_16x16x32_bf16 v[176:179], a[12:15], v[12:15], v[176:179]
ds_read_b64_tr_b16 a[36:37], v235 offset:4096
v_mul_f32 v188, v247, v188
v_mfma_f32_16x16x32_bf16 v[176:179], a[16:19], v[16:19], v[176:179]
v_mul_f32 v189, v247, v189
v_mfma_f32_16x16x32_bf16 v[176:179], a[20:23], v[20:23], v[176:179]
ds_read_b64_tr_b16 a[38:39], v235 offset:6144
v_mul_f32 v190, v247, v190
v_mfma_f32_16x16x32_bf16 v[176:179], a[24:27], v[24:27], v[176:179]
ds_read_b64_tr_b16 a[40:41], v235 offset:8192
v_mul_f32 v191, v247, v191
v_mfma_f32_16x16x32_bf16 v[176:179], a[28:31], v[28:31], v[176:179]
v_cvt_pk_bf16_f32 v172, v188, v189
v_mfma_f32_16x16x32_bf16 v[180:183], a[0:3], v[32:35], 0
ds_read_b64_tr_b16 a[42:43], v235 offset:10240
v_cvt_pk_bf16_f32 v173, v190, v191
v_mfma_f32_16x16x32_bf16 v[180:183], a[4:7], v[36:39], v[180:183]
ds_read_b64_tr_b16 a[44:45], v235 offset:12288
v_mfma_f32_16x16x32_bf16 v[180:183], a[8:11], v[40:43], v[180:183]
s_xor_b32 s96, s42, 12544
s_add_u32 m0, s39, 53248
s_waitcnt vmcnt(4)
buffer_load_dwordx4 v224, s[24:27], s96 offen nt lds
ds_read_b64_tr_b16 a[46:47], v235 offset:14336
v_mfma_f32_16x16x32_bf16 v[180:183], a[12:15], v[44:47], v[180:183]
v_mul_f32 v176, v244, v176
v_mfma_f32_16x16x32_bf16 v[180:183], a[16:19], v[48:51], v[180:183]
ds_read_b64_tr_b16 a[48:49], v235 offset:16384
v_mul_f32 v177, v244, v177
v_mfma_f32_16x16x32_bf16 v[180:183], a[20:23], v[52:55], v[180:183]
ds_read_b64_tr_b16 a[50:51], v235 offset:18432
v_mul_f32 v178, v244, v178
v_mfma_f32_16x16x32_bf16 v[180:183], a[24:27], v[56:59], v[180:183]
v_mul_f32 v179, v244, v179
v_mfma_f32_16x16x32_bf16 v[180:183], a[28:31], v[60:63], v[180:183]
ds_read_b64_tr_b16 a[52:53], v235 offset:20480
v_cvt_pk_bf16_f32 v156, v176, v177
v_mfma_f32_16x16x32_bf16 v[184:187], a[0:3], v[64:67], 0
ds_read_b64_tr_b16 a[54:55], v235 offset:22528
v_cvt_pk_bf16_f32 v157, v178, v179
v_mfma_f32_16x16x32_bf16 v[184:187], a[4:7], v[68:71], v[184:187]
ds_read_b64_tr_b16 a[56:57], v235 offset:24576
v_mfma_f32_16x16x32_bf16 v[184:187], a[8:11], v[72:75], v[184:187]
v_mfma_f32_16x16x32_bf16 v[184:187], a[12:15], v[76:79], v[184:187]
s_xor_b32 s96, s42, 20736
s_add_u32 m0, s39, 57344
s_waitcnt vmcnt(4)
buffer_load_dwordx4 v224, s[24:27], s96 offen nt lds
ds_read_b64_tr_b16 a[58:59], v235 offset:26624
v_mul_f32 v180, v245, v180
v_mfma_f32_16x16x32_bf16 v[184:187], a[16:19], v[80:83], v[184:187]
ds_read_b64_tr_b16 a[60:61], v235 offset:28672
v_mul_f32 v181, v245, v181
v_mfma_f32_16x16x32_bf16 v[184:187], a[20:23], v[84:87], v[184:187]
v_mul_f32 v182, v245, v182
v_mfma_f32_16x16x32_bf16 v[184:187], a[24:27], v[88:91], v[184:187]
s_waitcnt lgkmcnt(8)
ds_read_b64_tr_b16 a[62:63], v235 offset:30720
v_mul_f32 v183, v245, v183
v_mfma_f32_16x16x32_bf16 v[184:187], a[28:31], v[92:95], v[184:187]
v_cvt_pk_bf16_f32 v162, v180, v181
v_mfma_f32_16x16x32_bf16 v[188:191], a[0:3], v[96:99], 0
v_cvt_pk_bf16_f32 v163, v182, v183
v_mfma_f32_16x16x32_bf16 v[188:191], a[4:7], v[100:103], v[188:191]
v_mfma_f32_16x16x32_bf16 v[188:191], a[8:11], v[104:107], v[188:191]
v_mfma_f32_16x16x32_bf16 v[188:191], a[12:15], v[108:111], v[188:191]
s_nop 1
v_mul_f32 v184, v246, v184
v_mfma_f32_16x16x32_bf16 v[188:191], a[16:19], v[112:115], v[188:191]
v_mul_f32 v185, v246, v185
v_mfma_f32_16x16x32_bf16 v[188:191], a[20:23], v[116:119], v[188:191]
s_xor_b32 s96, s42, 28928
s_add_u32 m0, s39, 61440
s_waitcnt vmcnt(4)
buffer_load_dwordx4 v224, s[24:27], s96 offen nt lds
v_mul_f32 v186, v246, v186
v_mfma_f32_16x16x32_bf16 v[188:191], a[24:27], v[120:123], v[188:191]
v_mul_f32 v187, v246, v187
v_mfma_f32_16x16x32_bf16 v[188:191], a[28:31], v[124:127], v[188:191]
v_cvt_pk_bf16_f32 v168, v184, v185
s_waitcnt lgkmcnt(0)
v_mfma_f32_16x16x32_bf16 v[176:179], a[32:35], v[0:3], 0
v_cvt_pk_bf16_f32 v169, v186, v187
s_barrier
v_add_u32 v232, 65536, v227
v_xor_b32 v233, 32, v232
v_xor_b32 v234, 64, v232
v_xor_b32 v235, 96, v232
v_mfma_f32_16x16x32_bf16 v[176:179], a[36:39], v[4:7], v[176:179]
ds_read_b64_tr_b16 a[0:1], v232 offset:0
v_mfma_f32_16x16x32_bf16 v[176:179], a[40:43], v[8:11], v[176:179]
ds_read_b64_tr_b16 a[2:3], v232 offset:2048
v_mfma_f32_16x16x32_bf16 v[176:179], a[44:47], v[12:15], v[176:179]
v_mul_f32 v188, v247, v188
v_mfma_f32_16x16x32_bf16 v[176:179], a[48:51], v[16:19], v[176:179]
ds_read_b64_tr_b16 a[4:5], v232 offset:4096
v_mul_f32 v189, v247, v189
v_mfma_f32_16x16x32_bf16 v[176:179], a[52:55], v[20:23], v[176:179]
ds_read_b64_tr_b16 a[6:7], v232 offset:6144
v_mul_f32 v190, v247, v190
v_mfma_f32_16x16x32_bf16 v[176:179], a[56:59], v[24:27], v[176:179]
v_mul_f32 v191, v247, v191
v_add_u32 v238, 131072, v228
v_xor_b32 v239, 32, v238
v_xor_b32 v240, 64, v238
v_xor_b32 v241, 96, v238
v_add_u32 v242, 131072, v229
v_mfma_f32_16x16x32_bf16 v[176:179], a[60:63], v[28:31], v[176:179]
s_xor_b32 s96, s41, 128
s_add_u32 m0, s39, 98304
s_waitcnt vmcnt(4)
buffer_load_dwordx4 v224, s[16:19], s96 offen nt lds
ds_read_b64_tr_b16 a[8:9], v232 offset:8192
v_cvt_pk_bf16_f32 v174, v188, v189
v_mfma_f32_16x16x32_bf16 v[180:183], a[32:35], v[32:35], 0
ds_read_b64_tr_b16 a[10:11], v232 offset:10240
v_cvt_pk_bf16_f32 v175, v190, v191
v_mfma_f32_16x16x32_bf16 v[180:183], a[36:39], v[36:39], v[180:183]
v_mfma_f32_16x16x32_bf16 v[180:183], a[40:43], v[40:43], v[180:183]
ds_read_b64_tr_b16 a[12:13], v232 offset:12288
v_mfma_f32_16x16x32_bf16 v[180:183], a[44:47], v[44:47], v[180:183]
ds_read_b64_tr_b16 a[14:15], v232 offset:14336
v_mul_f32 v176, v244, v176
v_mfma_f32_16x16x32_bf16 v[180:183], a[48:51], v[48:51], v[180:183]
ds_write_b64 v238, v[152:153] offset:24576
v_mul_f32 v177, v244, v177
v_mfma_f32_16x16x32_bf16 v[180:183], a[52:55], v[52:55], v[180:183]
ds_write_b64 v239, v[154:155] offset:24576
ds_read_b64_tr_b16 a[16:17], v232 offset:16384
v_mul_f32 v178, v244, v178
v_mfma_f32_16x16x32_bf16 v[180:183], a[56:59], v[56:59], v[180:183]
ds_read_b64_tr_b16 a[18:19], v232 offset:18432
v_mul_f32 v179, v244, v179
v_mfma_f32_16x16x32_bf16 v[180:183], a[60:63], v[60:63], v[180:183]
ds_write_b64 v240, v[156:157] offset:24576
v_cvt_pk_bf16_f32 v176, v176, v177
v_mfma_f32_16x16x32_bf16 v[184:187], a[32:35], v[64:67], 0
ds_read_b64_tr_b16 a[20:21], v232 offset:20480
v_cvt_pk_bf16_f32 v177, v178, v179
v_mfma_f32_16x16x32_bf16 v[184:187], a[36:39], v[68:71], v[184:187]
s_xor_b32 s96, s41, 8320
s_add_u32 m0, s39, 102400
s_waitcnt vmcnt(4)
buffer_load_dwordx4 v224, s[16:19], s96 offen nt lds
ds_write_b64 v241, v[176:177] offset:24576
s_waitcnt lgkmcnt(8)
ds_read_b64_tr_b16 a[22:23], v232 offset:22528
v_mfma_f32_16x16x32_bf16 v[184:187], a[40:43], v[72:75], v[184:187]
ds_read_b128 a[128:131], v242 offset:24576
v_mfma_f32_16x16x32_bf16 v[184:187], a[44:47], v[76:79], v[184:187]
ds_read_b128 a[132:135], v242 offset:28672
ds_read_b64_tr_b16 a[24:25], v232 offset:24576
v_mul_f32 v180, v245, v180
v_mfma_f32_16x16x32_bf16 v[184:187], a[48:51], v[80:83], v[184:187]
ds_write_b64 v238, v[158:159] offset:24576
ds_read_b64_tr_b16 a[26:27], v232 offset:26624
v_mul_f32 v181, v245, v181
v_mfma_f32_16x16x32_bf16 v[184:187], a[52:55], v[84:87], v[184:187]
ds_write_b64 v239, v[160:161] offset:24576
v_mul_f32 v182, v245, v182
v_mfma_f32_16x16x32_bf16 v[184:187], a[56:59], v[88:91], v[184:187]
s_waitcnt lgkmcnt(8)
ds_read_b64_tr_b16 a[28:29], v232 offset:28672
v_mul_f32 v183, v245, v183
v_mfma_f32_16x16x32_bf16 v[184:187], a[60:63], v[92:95], v[184:187]
ds_write_b64 v240, v[162:163] offset:24576
ds_read_b64_tr_b16 a[30:31], v232 offset:30720
v_cvt_pk_bf16_f32 v180, v180, v181
v_mfma_f32_16x16x32_bf16 v[188:191], a[32:35], v[96:99], 0
v_cvt_pk_bf16_f32 v181, v182, v183
v_mfma_f32_16x16x32_bf16 v[188:191], a[36:39], v[100:103], v[188:191]
ds_write_b64 v241, v[180:181] offset:24576
v_mfma_f32_16x16x32_bf16 v[188:191], a[40:43], v[104:107], v[188:191]
s_xor_b32 s96, s41, 16512
s_add_u32 m0, s39, 106496
s_waitcnt vmcnt(4)
buffer_load_dwordx4 v224, s[16:19], s96 offen nt lds
ds_read_b128 a[136:139], v242 offset:24576
v_mfma_f32_16x16x32_bf16 v[188:191], a[44:47], v[108:111], v[188:191]
ds_read_b128 a[140:143], v242 offset:28672
v_mul_f32 v184, v246, v184
v_mfma_f32_16x16x32_bf16 v[188:191], a[48:51], v[112:115], v[188:191]
ds_write_b64 v238, v[164:165] offset:24576
v_mul_f32 v185, v246, v185
v_mfma_f32_16x16x32_bf16 v[188:191], a[52:55], v[116:119], v[188:191]
s_waitcnt lgkmcnt(8)
ds_write_b64 v239, v[166:167] offset:24576
v_mul_f32 v186, v246, v186
v_mfma_f32_16x16x32_bf16 v[188:191], a[56:59], v[120:123], v[188:191]
v_mul_f32 v187, v246, v187
v_mfma_f32_16x16x32_bf16 v[188:191], a[60:63], v[124:127], v[188:191]
ds_write_b64 v240, v[168:169] offset:24576
v_cvt_pk_bf16_f32 v184, v184, v185
s_waitcnt lgkmcnt(6)
v_mfma_f32_16x16x32_bf16 v[176:179], a[0:3], v[0:3], 0
v_cvt_pk_bf16_f32 v185, v186, v187
v_mfma_f32_16x16x32_bf16 v[176:179], a[4:7], v[4:7], v[176:179]
ds_write_b64 v241, v[184:185] offset:24576
ds_read_b64_tr_b16 a[32:33], v233 offset:0
v_mfma_f32_16x16x32_bf16 v[176:179], a[8:11], v[8:11], v[176:179]
ds_read_b128 a[144:147], v242 offset:24576
ds_read_b64_tr_b16 a[34:35], v233 offset:2048
v_mfma_f32_16x16x32_bf16 v[176:179], a[12:15], v[12:15], v[176:179]
ds_read_b128 a[148:151], v242 offset:28672
v_mul_f32 v188, v247, v188
v_mfma_f32_16x16x32_bf16 v[176:179], a[16:19], v[16:19], v[176:179]
s_xor_b32 s96, s41, 24704
s_add_u32 m0, s39, 110592
s_waitcnt vmcnt(4)
buffer_load_dwordx4 v224, s[16:19], s96 offen nt lds
ds_write_b64 v238, v[170:171] offset:24576
ds_read_b64_tr_b16 a[36:37], v233 offset:4096
v_mul_f32 v189, v247, v189
v_mfma_f32_16x16x32_bf16 v[176:179], a[20:23], v[20:23], v[176:179]
ds_write_b64 v239, v[172:173] offset:24576
ds_read_b64_tr_b16 a[38:39], v233 offset:6144
v_mul_f32 v190, v247, v190
v_mfma_f32_16x16x32_bf16 v[176:179], a[24:27], v[24:27], v[176:179]
v_mul_f32 v191, v247, v191
v_mfma_f32_16x16x32_bf16 v[176:179], a[28:31], v[28:31], v[176:179]
s_waitcnt lgkmcnt(8)
ds_write_b64 v240, v[174:175] offset:24576
ds_read_b64_tr_b16 a[40:41], v233 offset:8192
v_cvt_pk_bf16_f32 v188, v188, v189
v_mfma_f32_16x16x32_bf16 v[180:183], a[0:3], v[32:35], 0
ds_read_b64_tr_b16 a[42:43], v233 offset:10240
v_cvt_pk_bf16_f32 v189, v190, v191
v_mfma_f32_16x16x32_bf16 v[180:183], a[4:7], v[36:39], v[180:183]
ds_write_b64 v241, v[188:189] offset:24576
v_mfma_f32_16x16x32_bf16 v[180:183], a[8:11], v[40:43], v[180:183]
ds_read_b128 a[152:155], v242 offset:24576
ds_read_b64_tr_b16 a[44:45], v233 offset:12288
v_mfma_f32_16x16x32_bf16 v[180:183], a[12:15], v[44:47], v[180:183]
ds_read_b128 a[156:159], v242 offset:28672
s_waitcnt lgkmcnt(8)
ds_read_b64_tr_b16 a[46:47], v233 offset:14336
v_mul_f32 v176, v244, v176
v_mfma_f32_16x16x32_bf16 v[180:183], a[16:19], v[48:51], v[180:183]
v_mul_f32 v177, v244, v177
v_mfma_f32_16x16x32_bf16 v[180:183], a[20:23], v[52:55], v[180:183]
ds_read_b64_tr_b16 a[48:49], v233 offset:16384
v_mul_f32 v178, v244, v178
v_mfma_f32_16x16x32_bf16 v[180:183], a[24:27], v[56:59], v[180:183]
s_xor_b32 s96, s41, 4224
s_add_u32 m0, s39, 114688
s_waitcnt vmcnt(4)
buffer_load_dwordx4 v224, s[16:19], s96 offen nt lds
ds_read_b64_tr_b16 a[50:51], v233 offset:18432
v_mul_f32 v179, v244, v179
v_mfma_f32_16x16x32_bf16 v[180:183], a[28:31], v[60:63], v[180:183]
v_cvt_pk_bf16_f32 v152, v176, v177
v_mfma_f32_16x16x32_bf16 v[184:187], a[0:3], v[64:67], 0
ds_read_b64_tr_b16 a[52:53], v233 offset:20480
v_cvt_pk_bf16_f32 v153, v178, v179
v_mfma_f32_16x16x32_bf16 v[184:187], a[4:7], v[68:71], v[184:187]
ds_read_b64_tr_b16 a[54:55], v233 offset:22528
v_mfma_f32_16x16x32_bf16 v[184:187], a[8:11], v[72:75], v[184:187]
v_mfma_f32_16x16x32_bf16 v[184:187], a[12:15], v[76:79], v[184:187]
ds_read_b64_tr_b16 a[56:57], v233 offset:24576
v_mul_f32 v180, v245, v180
v_mfma_f32_16x16x32_bf16 v[184:187], a[16:19], v[80:83], v[184:187]
ds_read_b64_tr_b16 a[58:59], v233 offset:26624
v_mul_f32 v181, v245, v181
v_mfma_f32_16x16x32_bf16 v[184:187], a[20:23], v[84:87], v[184:187]
v_mul_f32 v182, v245, v182
v_mfma_f32_16x16x32_bf16 v[184:187], a[24:27], v[88:91], v[184:187]
s_waitcnt lgkmcnt(8)
ds_read_b64_tr_b16 a[60:61], v233 offset:28672
v_mul_f32 v183, v245, v183
v_mfma_f32_16x16x32_bf16 v[184:187], a[28:31], v[92:95], v[184:187]
ds_read_b64_tr_b16 a[62:63], v233 offset:30720
v_cvt_pk_bf16_f32 v158, v180, v181
v_mfma_f32_16x16x32_bf16 v[188:191], a[0:3], v[96:99], 0
s_xor_b32 s96, s41, 12416
s_add_u32 m0, s39, 118784
s_waitcnt vmcnt(4)
buffer_load_dwordx4 v224, s[16:19], s96 offen nt lds
v_cvt_pk_bf16_f32 v159, v182, v183
v_mfma_f32_16x16x32_bf16 v[188:191], a[4:7], v[100:103], v[188:191]
v_mfma_f32_16x16x32_bf16 v[188:191], a[8:11], v[104:107], v[188:191]
v_mfma_f32_16x16x32_bf16 v[188:191], a[12:15], v[108:111], v[188:191]
v_mul_f32 v184, v246, v184
v_mfma_f32_16x16x32_bf16 v[188:191], a[16:19], v[112:115], v[188:191]
v_mul_f32 v185, v246, v185
v_mfma_f32_16x16x32_bf16 v[188:191], a[20:23], v[116:119], v[188:191]
v_mul_f32 v186, v246, v186
v_mfma_f32_16x16x32_bf16 v[188:191], a[24:27], v[120:123], v[188:191]
v_mul_f32 v187, v246, v187
v_mfma_f32_16x16x32_bf16 v[188:191], a[28:31], v[124:127], v[188:191]
v_cvt_pk_bf16_f32 v164, v184, v185
s_waitcnt lgkmcnt(0)
v_mfma_f32_16x16x32_bf16 v[176:179], a[32:35], v[0:3], 0
v_cvt_pk_bf16_f32 v165, v186, v187
v_mfma_f32_16x16x32_bf16 v[176:179], a[36:39], v[4:7], v[176:179]
s_xor_b32 s96, s41, 20608
s_add_u32 m0, s39, 122880
s_waitcnt vmcnt(4)
buffer_load_dwordx4 v224, s[16:19], s96 offen nt lds
ds_read_b64_tr_b16 a[0:1], v234 offset:0
v_mfma_f32_16x16x32_bf16 v[176:179], a[40:43], v[8:11], v[176:179]
ds_read_b64_tr_b16 a[2:3], v234 offset:2048
v_mfma_f32_16x16x32_bf16 v[176:179], a[44:47], v[12:15], v[176:179]
v_mul_f32 v188, v247, v188
v_mfma_f32_16x16x32_bf16 v[176:179], a[48:51], v[16:19], v[176:179]
ds_read_b64_tr_b16 a[4:5], v234 offset:4096
v_mul_f32 v189, v247, v189
v_mfma_f32_16x16x32_bf16 v[176:179], a[52:55], v[20:23], v[176:179]
ds_read_b64_tr_b16 a[6:7], v234 offset:6144
v_mul_f32 v190, v247, v190
v_mfma_f32_16x16x32_bf16 v[176:179], a[56:59], v[24:27], v[176:179]
v_mul_f32 v191, v247, v191
v_mfma_f32_16x16x32_bf16 v[176:179], a[60:63], v[28:31], v[176:179]
ds_read_b64_tr_b16 a[8:9], v234 offset:8192
v_cvt_pk_bf16_f32 v170, v188, v189
v_mfma_f32_16x16x32_bf16 v[180:183], a[32:35], v[32:35], 0
ds_read_b64_tr_b16 a[10:11], v234 offset:10240
v_cvt_pk_bf16_f32 v171, v190, v191
v_mfma_f32_16x16x32_bf16 v[180:183], a[36:39], v[36:39], v[180:183]
v_mfma_f32_16x16x32_bf16 v[180:183], a[40:43], v[40:43], v[180:183]
ds_read_b64_tr_b16 a[12:13], v234 offset:12288
v_mfma_f32_16x16x32_bf16 v[180:183], a[44:47], v[44:47], v[180:183]
s_xor_b32 s96, s41, 28800
s_add_u32 m0, s39, 126976
s_waitcnt vmcnt(4)
buffer_load_dwordx4 v224, s[16:19], s96 offen nt lds
ds_read_b64_tr_b16 a[14:15], v234 offset:14336
v_mul_f32 v176, v244, v176
v_mfma_f32_16x16x32_bf16 v[180:183], a[48:51], v[48:51], v[180:183]
v_mul_f32 v177, v244, v177
v_mfma_f32_16x16x32_bf16 v[180:183], a[52:55], v[52:55], v[180:183]
ds_read_b64_tr_b16 a[16:17], v234 offset:16384
v_mul_f32 v178, v244, v178
v_mfma_f32_16x16x32_bf16 v[180:183], a[56:59], v[56:59], v[180:183]
ds_read_b64_tr_b16 a[18:19], v234 offset:18432
v_mul_f32 v179, v244, v179
v_mfma_f32_16x16x32_bf16 v[180:183], a[60:63], v[60:63], v[180:183]
v_cvt_pk_bf16_f32 v154, v176, v177
v_mfma_f32_16x16x32_bf16 v[184:187], a[32:35], v[64:67], 0
ds_read_b64_tr_b16 a[20:21], v234 offset:20480
v_cvt_pk_bf16_f32 v155, v178, v179
v_mfma_f32_16x16x32_bf16 v[184:187], a[36:39], v[68:71], v[184:187]
ds_read_b64_tr_b16 a[22:23], v234 offset:22528
v_mfma_f32_16x16x32_bf16 v[184:187], a[40:43], v[72:75], v[184:187]
v_mfma_f32_16x16x32_bf16 v[184:187], a[44:47], v[76:79], v[184:187]
ds_read_b64_tr_b16 a[24:25], v234 offset:24576
v_mul_f32 v180, v245, v180
v_mfma_f32_16x16x32_bf16 v[184:187], a[48:51], v[80:83], v[184:187]
ds_read_b64_tr_b16 a[26:27], v234 offset:26624
v_mul_f32 v181, v245, v181
v_mfma_f32_16x16x32_bf16 v[184:187], a[52:55], v[84:87], v[184:187]
s_xor_b32 s96, s42, 384
s_add_u32 m0, s39, 131072
s_waitcnt vmcnt(4)
buffer_load_dwordx4 v224, s[24:27], s96 offen nt lds
v_mul_f32 v182, v245, v182
v_mfma_f32_16x16x32_bf16 v[184:187], a[56:59], v[88:91], v[184:187]
ds_read_b64_tr_b16 a[28:29], v234 offset:28672
v_mul_f32 v183, v245, v183
v_mfma_f32_16x16x32_bf16 v[184:187], a[60:63], v[92:95], v[184:187]
s_waitcnt lgkmcnt(8)
ds_read_b64_tr_b16 a[30:31], v234 offset:30720
v_cvt_pk_bf16_f32 v160, v180, v181
v_mfma_f32_16x16x32_bf16 v[188:191], a[32:35], v[96:99], 0
v_cvt_pk_bf16_f32 v161, v182, v183
v_mfma_f32_16x16x32_bf16 v[188:191], a[36:39], v[100:103], v[188:191]
v_mfma_f32_16x16x32_bf16 v[188:191], a[40:43], v[104:107], v[188:191]
v_mfma_f32_16x16x32_bf16 v[188:191], a[44:47], v[108:111], v[188:191]
v_mul_f32 v184, v246, v184
v_mfma_f32_16x16x32_bf16 v[188:191], a[48:51], v[112:115], v[188:191]
v_mul_f32 v185, v246, v185
v_mfma_f32_16x16x32_bf16 v[188:191], a[52:55], v[116:119], v[188:191]
v_mul_f32 v186, v246, v186
v_mfma_f32_16x16x32_bf16 v[188:191], a[56:59], v[120:123], v[188:191]
v_mul_f32 v187, v246, v187
v_mfma_f32_16x16x32_bf16 v[188:191], a[60:63], v[124:127], v[188:191]
s_xor_b32 s96, s42, 8576
s_add_u32 m0, s39, 135168
s_waitcnt vmcnt(4)
buffer_load_dwordx4 v224, s[24:27], s96 offen nt lds
v_cvt_pk_bf16_f32 v166, v184, v185
s_waitcnt lgkmcnt(0)
v_mfma_f32_16x16x32_bf16 v[176:179], a[0:3], v[0:3], 0
v_cvt_pk_bf16_f32 v167, v186, v187
v_mfma_f32_16x16x32_bf16 v[176:179], a[4:7], v[4:7], v[176:179]
ds_read_b64_tr_b16 a[32:33], v235 offset:0
v_mfma_f32_16x16x32_bf16 v[176:179], a[8:11], v[8:11], v[176:179]
ds_read_b64_tr_b16 a[34:35], v235 offset:2048
v_mfma_f32_16x16x32_bf16 v[176:179], a[12:15], v[12:15], v[176:179]
ds_read_b64_tr_b16 a[36:37], v235 offset:4096
v_mul_f32 v188, v247, v188
v_mfma_f32_16x16x32_bf16 v[176:179], a[16:19], v[16:19], v[176:179]
v_mul_f32 v189, v247, v189
v_mfma_f32_16x16x32_bf16 v[176:179], a[20:23], v[20:23], v[176:179]
ds_read_b64_tr_b16 a[38:39], v235 offset:6144
v_mul_f32 v190, v247, v190
v_mfma_f32_16x16x32_bf16 v[176:179], a[24:27], v[24:27], v[176:179]
ds_read_b64_tr_b16 a[40:41], v235 offset:8192
v_mul_f32 v191, v247, v191
v_mfma_f32_16x16x32_bf16 v[176:179], a[28:31], v[28:31], v[176:179]
v_cvt_pk_bf16_f32 v172, v188, v189
v_mfma_f32_16x16x32_bf16 v[180:183], a[0:3], v[32:35], 0
s_xor_b32 s96, s42, 16768
s_add_u32 m0, s39, 139264
s_waitcnt vmcnt(4)
buffer_load_dwordx4 v224, s[24:27], s96 offen nt lds
ds_read_b64_tr_b16 a[42:43], v235 offset:10240
v_cvt_pk_bf16_f32 v173, v190, v191
v_mfma_f32_16x16x32_bf16 v[180:183], a[4:7], v[36:39], v[180:183]
ds_read_b64_tr_b16 a[44:45], v235 offset:12288
v_mfma_f32_16x16x32_bf16 v[180:183], a[8:11], v[40:43], v[180:183]
ds_read_b64_tr_b16 a[46:47], v235 offset:14336
v_mfma_f32_16x16x32_bf16 v[180:183], a[12:15], v[44:47], v[180:183]
v_mul_f32 v176, v244, v176
v_mfma_f32_16x16x32_bf16 v[180:183], a[16:19], v[48:51], v[180:183]
ds_read_b64_tr_b16 a[48:49], v235 offset:16384
v_mul_f32 v177, v244, v177
v_mfma_f32_16x16x32_bf16 v[180:183], a[20:23], v[52:55], v[180:183]
ds_read_b64_tr_b16 a[50:51], v235 offset:18432
v_mul_f32 v178, v244, v178
v_mfma_f32_16x16x32_bf16 v[180:183], a[24:27], v[56:59], v[180:183]
v_mul_f32 v179, v244, v179
v_mfma_f32_16x16x32_bf16 v[180:183], a[28:31], v[60:63], v[180:183]
ds_read_b64_tr_b16 a[52:53], v235 offset:20480
v_cvt_pk_bf16_f32 v156, v176, v177
v_mfma_f32_16x16x32_bf16 v[184:187], a[0:3], v[64:67], 0
ds_read_b64_tr_b16 a[54:55], v235 offset:22528
v_cvt_pk_bf16_f32 v157, v178, v179
v_mfma_f32_16x16x32_bf16 v[184:187], a[4:7], v[68:71], v[184:187]
ds_read_b64_tr_b16 a[56:57], v235 offset:24576
v_mfma_f32_16x16x32_bf16 v[184:187], a[8:11], v[72:75], v[184:187]
s_xor_b32 s96, s42, 24960
s_add_u32 m0, s39, 143360
s_waitcnt vmcnt(4)
buffer_load_dwordx4 v224, s[24:27], s96 offen nt lds
v_mfma_f32_16x16x32_bf16 v[184:187], a[12:15], v[76:79], v[184:187]
ds_read_b64_tr_b16 a[58:59], v235 offset:26624
v_mul_f32 v180, v245, v180
v_mfma_f32_16x16x32_bf16 v[184:187], a[16:19], v[80:83], v[184:187]
ds_read_b64_tr_b16 a[60:61], v235 offset:28672
v_mul_f32 v181, v245, v181
v_mfma_f32_16x16x32_bf16 v[184:187], a[20:23], v[84:87], v[184:187]
v_mul_f32 v182, v245, v182
v_mfma_f32_16x16x32_bf16 v[184:187], a[24:27], v[88:91], v[184:187]
s_waitcnt lgkmcnt(8)
ds_read_b64_tr_b16 a[62:63], v235 offset:30720
v_mul_f32 v183, v245, v183
v_mfma_f32_16x16x32_bf16 v[184:187], a[28:31], v[92:95], v[184:187]
v_cvt_pk_bf16_f32 v162, v180, v181
v_mfma_f32_16x16x32_bf16 v[188:191], a[0:3], v[96:99], 0
v_cvt_pk_bf16_f32 v163, v182, v183
v_mfma_f32_16x16x32_bf16 v[188:191], a[4:7], v[100:103], v[188:191]
v_mfma_f32_16x16x32_bf16 v[188:191], a[8:11], v[104:107], v[188:191]
v_mfma_f32_16x16x32_bf16 v[188:191], a[12:15], v[108:111], v[188:191]
s_nop 1
v_mul_f32 v184, v246, v184
v_mfma_f32_16x16x32_bf16 v[188:191], a[16:19], v[112:115], v[188:191]
s_xor_b32 s96, s42, 4480
s_add_u32 m0, s39, 147456
s_waitcnt vmcnt(4)
buffer_load_dwordx4 v224, s[24:27], s96 offen nt lds
v_mul_f32 v185, v246, v185
v_mfma_f32_16x16x32_bf16 v[188:191], a[20:23], v[116:119], v[188:191]
v_add_u32 v236, 98304, v226
v_xor_b32 v237, 64, v236
ds_read_b128 a[64:67], v236 offset:0
ds_read_b128 a[68:71], v237 offset:0
ds_read_b128 a[72:75], v236 offset:8192
ds_read_b128 a[76:79], v237 offset:8192
ds_read_b128 a[80:83], v236 offset:16384
ds_read_b128 a[84:87], v237 offset:16384
s_waitcnt lgkmcnt(8)
ds_read_b128 a[88:91], v236 offset:24576
ds_read_b128 a[92:95], v237 offset:24576
v_mul_f32 v186, v246, v186
v_mfma_f32_16x16x32_bf16 v[188:191], a[24:27], v[120:123], v[188:191]
v_mul_f32 v187, v246, v187
v_mfma_f32_16x16x32_bf16 v[188:191], a[28:31], v[124:127], v[188:191]
v_cvt_pk_bf16_f32 v168, v184, v185
s_waitcnt lgkmcnt(8)
v_mfma_f32_16x16x32_bf16 v[176:179], a[32:35], v[0:3], 0
v_cvt_pk_bf16_f32 v169, v186, v187
s_waitcnt lgkmcnt(0)
s_barrier
v_add_u32 v232, 32768, v227
v_xor_b32 v233, 32, v232
v_xor_b32 v234, 64, v232
v_xor_b32 v235, 96, v232
v_mfma_f32_16x16x32_bf16 v[176:179], a[36:39], v[4:7], v[176:179]
ds_read_b64_tr_b16 a[0:1], v232 offset:0
v_mfma_f32_16x16x32_bf16 v[176:179], a[40:43], v[8:11], v[176:179]
ds_read_b64_tr_b16 a[2:3], v232 offset:2048
v_mfma_f32_16x16x32_bf16 v[176:179], a[44:47], v[12:15], v[176:179]
v_mul_f32 v188, v247, v188
v_mfma_f32_16x16x32_bf16 v[176:179], a[48:51], v[16:19], v[176:179]
ds_read_b64_tr_b16 a[4:5], v232 offset:4096
v_mul_f32 v189, v247, v189
v_mfma_f32_16x16x32_bf16 v[176:179], a[52:55], v[20:23], v[176:179]
ds_read_b64_tr_b16 a[6:7], v232 offset:6144
v_mul_f32 v190, v247, v190
v_mfma_f32_16x16x32_bf16 v[176:179], a[56:59], v[24:27], v[176:179]
s_xor_b32 s96, s42, 12672
s_add_u32 m0, s39, 151552
s_waitcnt vmcnt(4)
buffer_load_dwordx4 v224, s[24:27], s96 offen nt lds
v_mul_f32 v191, v247, v191
v_add_u32 v238, 65536, v228
v_xor_b32 v239, 32, v238
v_xor_b32 v240, 64, v238
v_xor_b32 v241, 96, v238
v_add_u32 v242, 65536, v229
v_mfma_f32_16x16x32_bf16 v[176:179], a[60:63], v[28:31], v[176:179]
ds_read_b64_tr_b16 a[8:9], v232 offset:8192
v_cvt_pk_bf16_f32 v174, v188, v189
v_mfma_f32_16x16x32_bf16 v[180:183], a[32:35], v[32:35], 0
ds_read_b64_tr_b16 a[10:11], v232 offset:10240
v_cvt_pk_bf16_f32 v175, v190, v191
v_mfma_f32_16x16x32_bf16 v[180:183], a[36:39], v[36:39], v[180:183]
v_mfma_f32_16x16x32_bf16 v[180:183], a[40:43], v[40:43], v[180:183]
ds_read_b64_tr_b16 a[12:13], v232 offset:12288
v_mfma_f32_16x16x32_bf16 v[180:183], a[44:47], v[44:47], v[180:183]
ds_read_b64_tr_b16 a[14:15], v232 offset:14336
v_mul_f32 v176, v244, v176
v_mfma_f32_16x16x32_bf16 v[180:183], a[48:51], v[48:51], v[180:183]
ds_write_b64 v238, v[152:153] offset:24576
v_mul_f32 v177, v244, v177
v_mfma_f32_16x16x32_bf16 v[180:183], a[52:55], v[52:55], v[180:183]
ds_write_b64 v239, v[154:155] offset:24576
ds_read_b64_tr_b16 a[16:17], v232 offset:16384
v_mul_f32 v178, v244, v178
v_mfma_f32_16x16x32_bf16 v[180:183], a[56:59], v[56:59], v[180:183]
ds_read_b64_tr_b16 a[18:19], v232 offset:18432
v_mul_f32 v179, v244, v179
v_mfma_f32_16x16x32_bf16 v[180:183], a[60:63], v[60:63], v[180:183]
s_xor_b32 s96, s42, 20864
s_add_u32 m0, s39, 155648
s_waitcnt vmcnt(4)
buffer_load_dwordx4 v224, s[24:27], s96 offen nt lds
ds_write_b64 v240, v[156:157] offset:24576
v_cvt_pk_bf16_f32 v176, v176, v177
v_mfma_f32_16x16x32_bf16 v[184:187], a[32:35], v[64:67], 0
ds_read_b64_tr_b16 a[20:21], v232 offset:20480
v_cvt_pk_bf16_f32 v177, v178, v179
v_mfma_f32_16x16x32_bf16 v[184:187], a[36:39], v[68:71], v[184:187]
ds_write_b64 v241, v[176:177] offset:24576
s_waitcnt lgkmcnt(8)
ds_read_b64_tr_b16 a[22:23], v232 offset:22528
v_mfma_f32_16x16x32_bf16 v[184:187], a[40:43], v[72:75], v[184:187]
ds_read_b128 a[160:163], v242 offset:24576
v_mfma_f32_16x16x32_bf16 v[184:187], a[44:47], v[76:79], v[184:187]
ds_read_b128 a[164:167], v242 offset:28672
ds_read_b64_tr_b16 a[24:25], v232 offset:24576
v_mul_f32 v180, v245, v180
v_mfma_f32_16x16x32_bf16 v[184:187], a[48:51], v[80:83], v[184:187]
ds_write_b64 v238, v[158:159] offset:24576
ds_read_b64_tr_b16 a[26:27], v232 offset:26624
v_mul_f32 v181, v245, v181
v_mfma_f32_16x16x32_bf16 v[184:187], a[52:55], v[84:87], v[184:187]
ds_write_b64 v239, v[160:161] offset:24576
v_mul_f32 v182, v245, v182
v_mfma_f32_16x16x32_bf16 v[184:187], a[56:59], v[88:91], v[184:187]
s_waitcnt lgkmcnt(8)
ds_read_b64_tr_b16 a[28:29], v232 offset:28672
v_mul_f32 v183, v245, v183
v_mfma_f32_16x16x32_bf16 v[184:187], a[60:63], v[92:95], v[184:187]
ds_write_b64 v240, v[162:163] offset:24576
ds_read_b64_tr_b16 a[30:31], v232 offset:30720
v_cvt_pk_bf16_f32 v180, v180, v181
v_mfma_f32_16x16x32_bf16 v[188:191], a[32:35], v[96:99], 0
v_cvt_pk_bf16_f32 v181, v182, v183
v_mfma_f32_16x16x32_bf16 v[188:191], a[36:39], v[100:103], v[188:191]
s_xor_b32 s96, s42, 29056
s_add_u32 m0, s39, 159744
s_waitcnt vmcnt(4)
buffer_load_dwordx4 v224, s[24:27], s96 offen nt lds
ds_write_b64 v241, v[180:181] offset:24576
v_mfma_f32_16x16x32_bf16 v[188:191], a[40:43], v[104:107], v[188:191]
ds_read_b128 a[168:171], v242 offset:24576
v_mfma_f32_16x16x32_bf16 v[188:191], a[44:47], v[108:111], v[188:191]
ds_read_b128 a[172:175], v242 offset:28672
v_mul_f32 v184, v246, v184
v_mfma_f32_16x16x32_bf16 v[188:191], a[48:51], v[112:115], v[188:191]
ds_write_b64 v238, v[164:165] offset:24576
v_mul_f32 v185, v246, v185
v_mfma_f32_16x16x32_bf16 v[188:191], a[52:55], v[116:119], v[188:191]
s_waitcnt lgkmcnt(8)
ds_write_b64 v239, v[166:167] offset:24576
v_mul_f32 v186, v246, v186
v_mfma_f32_16x16x32_bf16 v[188:191], a[56:59], v[120:123], v[188:191]
v_mul_f32 v187, v246, v187
v_mfma_f32_16x16x32_bf16 v[188:191], a[60:63], v[124:127], v[188:191]
ds_write_b64 v240, v[168:169] offset:24576
v_cvt_pk_bf16_f32 v184, v184, v185
s_waitcnt lgkmcnt(6)
v_mfma_f32_16x16x32_bf16 v[176:179], a[0:3], v[0:3], 0
v_cvt_pk_bf16_f32 v185, v186, v187
v_mfma_f32_16x16x32_bf16 v[176:179], a[4:7], v[4:7], v[176:179]
ds_write_b64 v241, v[184:185] offset:24576
ds_read_b64_tr_b16 a[32:33], v233 offset:0
v_mfma_f32_16x16x32_bf16 v[176:179], a[8:11], v[8:11], v[176:179]
ds_read_b128 a[176:179], v242 offset:24576
ds_read_b64_tr_b16 a[34:35], v233 offset:2048
v_mfma_f32_16x16x32_bf16 v[176:179], a[12:15], v[12:15], v[176:179]
s_xor_b32 s96, s43, 128
s_add_u32 m0, s39, 65536
s_waitcnt vmcnt(4)
buffer_load_dwordx4 v224, s[20:23], s96 offen nt lds
ds_read_b128 a[180:183], v242 offset:28672
v_mul_f32 v188, v247, v188
v_mfma_f32_16x16x32_bf16 v[176:179], a[16:19], v[16:19], v[176:179]
ds_write_b64 v238, v[170:171] offset:24576
ds_read_b64_tr_b16 a[36:37], v233 offset:4096
v_mul_f32 v189, v247, v189
v_mfma_f32_16x16x32_bf16 v[176:179], a[20:23], v[20:23], v[176:179]
ds_write_b64 v239, v[172:173] offset:24576
ds_read_b64_tr_b16 a[38:39], v233 offset:6144
v_mul_f32 v190, v247, v190
v_mfma_f32_16x16x32_bf16 v[176:179], a[24:27], v[24:27], v[176:179]
v_mul_f32 v191, v247, v191
v_mfma_f32_16x16x32_bf16 v[176:179], a[28:31], v[28:31], v[176:179]
s_waitcnt lgkmcnt(8)
ds_write_b64 v240, v[174:175] offset:24576
ds_read_b64_tr_b16 a[40:41], v233 offset:8192
v_cvt_pk_bf16_f32 v188, v188, v189
v_mfma_f32_16x16x32_bf16 v[180:183], a[0:3], v[32:35], 0
ds_read_b64_tr_b16 a[42:43], v233 offset:10240
v_cvt_pk_bf16_f32 v189, v190, v191
v_mfma_f32_16x16x32_bf16 v[180:183], a[4:7], v[36:39], v[180:183]
ds_write_b64 v241, v[188:189] offset:24576
v_mfma_f32_16x16x32_bf16 v[180:183], a[8:11], v[40:43], v[180:183]
ds_read_b128 a[184:187], v242 offset:24576
ds_read_b64_tr_b16 a[44:45], v233 offset:12288
v_mfma_f32_16x16x32_bf16 v[180:183], a[12:15], v[44:47], v[180:183]
ds_read_b128 a[188:191], v242 offset:28672
s_waitcnt lgkmcnt(8)
ds_read_b64_tr_b16 a[46:47], v233 offset:14336
v_mul_f32 v176, v244, v176
v_mfma_f32_16x16x32_bf16 v[180:183], a[16:19], v[48:51], v[180:183]
v_mul_f32 v177, v244, v177
v_mfma_f32_16x16x32_bf16 v[180:183], a[20:23], v[52:55], v[180:183]
s_xor_b32 s96, s43, 8320
s_add_u32 m0, s39, 69632
s_waitcnt vmcnt(4)
buffer_load_dwordx4 v224, s[20:23], s96 offen nt lds
ds_read_b64_tr_b16 a[48:49], v233 offset:16384
v_mul_f32 v178, v244, v178
v_mfma_f32_16x16x32_bf16 v[180:183], a[24:27], v[56:59], v[180:183]
ds_read_b64_tr_b16 a[50:51], v233 offset:18432
v_mul_f32 v179, v244, v179
v_mfma_f32_16x16x32_bf16 v[180:183], a[28:31], v[60:63], v[180:183]
v_cvt_pk_bf16_f32 v152, v176, v177
v_mfma_f32_16x16x32_bf16 v[184:187], a[0:3], v[64:67], 0
ds_read_b64_tr_b16 a[52:53], v233 offset:20480
v_cvt_pk_bf16_f32 v153, v178, v179
v_mfma_f32_16x16x32_bf16 v[184:187], a[4:7], v[68:71], v[184:187]
ds_read_b64_tr_b16 a[54:55], v233 offset:22528
v_mfma_f32_16x16x32_bf16 v[184:187], a[8:11], v[72:75], v[184:187]
v_mfma_f32_16x16x32_bf16 v[184:187], a[12:15], v[76:79], v[184:187]
ds_read_b64_tr_b16 a[56:57], v233 offset:24576
v_mul_f32 v180, v245, v180
v_mfma_f32_16x16x32_bf16 v[184:187], a[16:19], v[80:83], v[184:187]
ds_read_b64_tr_b16 a[58:59], v233 offset:26624
v_mul_f32 v181, v245, v181
v_mfma_f32_16x16x32_bf16 v[184:187], a[20:23], v[84:87], v[184:187]
v_mul_f32 v182, v245, v182
v_mfma_f32_16x16x32_bf16 v[184:187], a[24:27], v[88:91], v[184:187]
s_xor_b32 s96, s43, 16512
s_add_u32 m0, s39, 73728
s_waitcnt vmcnt(4)
buffer_load_dwordx4 v224, s[20:23], s96 offen nt lds
s_waitcnt lgkmcnt(8)
ds_read_b64_tr_b16 a[60:61], v233 offset:28672
v_mul_f32 v183, v245, v183
v_mfma_f32_16x16x32_bf16 v[184:187], a[28:31], v[92:95], v[184:187]
ds_read_b64_tr_b16 a[62:63], v233 offset:30720
v_cvt_pk_bf16_f32 v158, v180, v181
v_mfma_f32_16x16x32_bf16 v[188:191], a[0:3], v[96:99], 0
v_cvt_pk_bf16_f32 v159, v182, v183
v_mfma_f32_16x16x32_bf16 v[188:191], a[4:7], v[100:103], v[188:191]
v_mfma_f32_16x16x32_bf16 v[188:191], a[8:11], v[104:107], v[188:191]
v_mfma_f32_16x16x32_bf16 v[188:191], a[12:15], v[108:111], v[188:191]
s_nop 0
v_mul_f32 v184, v246, v184
v_mfma_f32_16x16x32_bf16 v[188:191], a[16:19], v[112:115], v[188:191]
v_mul_f32 v185, v246, v185
v_mfma_f32_16x16x32_bf16 v[188:191], a[20:23], v[116:119], v[188:191]
v_mul_f32 v186, v246, v186
v_mfma_f32_16x16x32_bf16 v[188:191], a[24:27], v[120:123], v[188:191]
v_mul_f32 v187, v246, v187
v_mfma_f32_16x16x32_bf16 v[188:191], a[28:31], v[124:127], v[188:191]
v_cvt_pk_bf16_f32 v164, v184, v185
s_waitcnt lgkmcnt(0)
v_mfma_f32_16x16x32_bf16 v[176:179], a[32:35], v[0:3], 0
s_xor_b32 s96, s43, 24704
s_add_u32 m0, s39, 77824
s_waitcnt vmcnt(4)
buffer_load_dwordx4 v224, s[20:23], s96 offen nt lds
v_cvt_pk_bf16_f32 v165, v186, v187
v_mfma_f32_16x16x32_bf16 v[176:179], a[36:39], v[4:7], v[176:179]
ds_read_b64_tr_b16 a[0:1], v234 offset:0
v_mfma_f32_16x16x32_bf16 v[176:179], a[40:43], v[8:11], v[176:179]
ds_read_b64_tr_b16 a[2:3], v234 offset:2048
v_mfma_f32_16x16x32_bf16 v[176:179], a[44:47], v[12:15], v[176:179]
v_mul_f32 v188, v247, v188
v_mfma_f32_16x16x32_bf16 v[176:179], a[48:51], v[16:19], v[176:179]
ds_read_b64_tr_b16 a[4:5], v234 offset:4096
v_mul_f32 v189, v247, v189
v_mfma_f32_16x16x32_bf16 v[176:179], a[52:55], v[20:23], v[176:179]
ds_read_b64_tr_b16 a[6:7], v234 offset:6144
v_mul_f32 v190, v247, v190
v_mfma_f32_16x16x32_bf16 v[176:179], a[56:59], v[24:27], v[176:179]
v_mul_f32 v191, v247, v191
v_mfma_f32_16x16x32_bf16 v[176:179], a[60:63], v[28:31], v[176:179]
ds_read_b64_tr_b16 a[8:9], v234 offset:8192
v_cvt_pk_bf16_f32 v170, v188, v189
v_mfma_f32_16x16x32_bf16 v[180:183], a[32:35], v[32:35], 0
ds_read_b64_tr_b16 a[10:11], v234 offset:10240
v_cvt_pk_bf16_f32 v171, v190, v191
v_mfma_f32_16x16x32_bf16 v[180:183], a[36:39], v[36:39], v[180:183]
v_mfma_f32_16x16x32_bf16 v[180:183], a[40:43], v[40:43], v[180:183]
s_xor_b32 s96, s43, 4224
s_add_u32 m0, s39, 81920
s_waitcnt vmcnt(4)
buffer_load_dwordx4 v224, s[20:23], s96 offen nt lds
ds_read_b64_tr_b16 a[12:13], v234 offset:12288
v_mfma_f32_16x16x32_bf16 v[180:183], a[44:47], v[44:47], v[180:183]
ds_read_b64_tr_b16 a[14:15], v234 offset:14336
v_mul_f32 v176, v244, v176
v_mfma_f32_16x16x32_bf16 v[180:183], a[48:51], v[48:51], v[180:183]
v_mul_f32 v177, v244, v177
v_mfma_f32_16x16x32_bf16 v[180:183], a[52:55], v[52:55], v[180:183]
ds_read_b64_tr_b16 a[16:17], v234 offset:16384
v_mul_f32 v178, v244, v178
v_mfma_f32_16x16x32_bf16 v[180:183], a[56:59], v[56:59], v[180:183]
ds_read_b64_tr_b16 a[18:19], v234 offset:18432
v_mul_f32 v179, v244, v179
v_mfma_f32_16x16x32_bf16 v[180:183], a[60:63], v[60:63], v[180:183]
v_cvt_pk_bf16_f32 v154, v176, v177
v_mfma_f32_16x16x32_bf16 v[184:187], a[32:35], v[64:67], 0
ds_read_b64_tr_b16 a[20:21], v234 offset:20480
v_cvt_pk_bf16_f32 v155, v178, v179
v_mfma_f32_16x16x32_bf16 v[184:187], a[36:39], v[68:71], v[184:187]
ds_read_b64_tr_b16 a[22:23], v234 offset:22528
v_mfma_f32_16x16x32_bf16 v[184:187], a[40:43], v[72:75], v[184:187]
v_mfma_f32_16x16x32_bf16 v[184:187], a[44:47], v[76:79], v[184:187]
ds_read_b64_tr_b16 a[24:25], v234 offset:24576
v_mul_f32 v180, v245, v180
v_mfma_f32_16x16x32_bf16 v[184:187], a[48:51], v[80:83], v[184:187]
s_xor_b32 s96, s43, 12416
s_add_u32 m0, s39, 86016
s_waitcnt vmcnt(4)
buffer_load_dwordx4 v224, s[20:23], s96 offen nt lds
ds_read_b64_tr_b16 a[26:27], v234 offset:26624
v_mul_f32 v181, v245, v181
v_mfma_f32_16x16x32_bf16 v[184:187], a[52:55], v[84:87], v[184:187]
v_mul_f32 v182, v245, v182
v_mfma_f32_16x16x32_bf16 v[184:187], a[56:59], v[88:91], v[184:187]
ds_read_b64_tr_b16 a[28:29], v234 offset:28672
v_mul_f32 v183, v245, v183
v_mfma_f32_16x16x32_bf16 v[184:187], a[60:63], v[92:95], v[184:187]
s_waitcnt lgkmcnt(8)
ds_read_b64_tr_b16 a[30:31], v234 offset:30720
v_cvt_pk_bf16_f32 v160, v180, v181
v_mfma_f32_16x16x32_bf16 v[188:191], a[32:35], v[96:99], 0
v_cvt_pk_bf16_f32 v161, v182, v183
v_mfma_f32_16x16x32_bf16 v[188:191], a[36:39], v[100:103], v[188:191]
v_mfma_f32_16x16x32_bf16 v[188:191], a[40:43], v[104:107], v[188:191]
v_mfma_f32_16x16x32_bf16 v[188:191], a[44:47], v[108:111], v[188:191]
v_mul_f32 v184, v246, v184
v_mfma_f32_16x16x32_bf16 v[188:191], a[48:51], v[112:115], v[188:191]
v_mul_f32 v185, v246, v185
v_mfma_f32_16x16x32_bf16 v[188:191], a[52:55], v[116:119], v[188:191]
s_xor_b32 s96, s43, 20608
s_add_u32 m0, s39, 90112
s_waitcnt vmcnt(4)
buffer_load_dwordx4 v224, s[20:23], s96 offen nt lds
v_mul_f32 v186, v246, v186
v_mfma_f32_16x16x32_bf16 v[188:191], a[56:59], v[120:123], v[188:191]
v_mul_f32 v187, v246, v187
v_mfma_f32_16x16x32_bf16 v[188:191], a[60:63], v[124:127], v[188:191]
v_cvt_pk_bf16_f32 v166, v184, v185
s_waitcnt lgkmcnt(0)
v_mfma_f32_16x16x32_bf16 v[176:179], a[0:3], v[0:3], 0
v_cvt_pk_bf16_f32 v167, v186, v187
v_mfma_f32_16x16x32_bf16 v[176:179], a[4:7], v[4:7], v[176:179]
ds_read_b64_tr_b16 a[32:33], v235 offset:0
v_mfma_f32_16x16x32_bf16 v[176:179], a[8:11], v[8:11], v[176:179]
ds_read_b64_tr_b16 a[34:35], v235 offset:2048
v_mfma_f32_16x16x32_bf16 v[176:179], a[12:15], v[12:15], v[176:179]
ds_read_b64_tr_b16 a[36:37], v235 offset:4096
v_mul_f32 v188, v247, v188
v_mfma_f32_16x16x32_bf16 v[176:179], a[16:19], v[16:19], v[176:179]
v_mul_f32 v189, v247, v189
v_mfma_f32_16x16x32_bf16 v[176:179], a[20:23], v[20:23], v[176:179]
ds_read_b64_tr_b16 a[38:39], v235 offset:6144
v_mul_f32 v190, v247, v190
v_mfma_f32_16x16x32_bf16 v[176:179], a[24:27], v[24:27], v[176:179]
ds_read_b64_tr_b16 a[40:41], v235 offset:8192
v_mul_f32 v191, v247, v191
v_mfma_f32_16x16x32_bf16 v[176:179], a[28:31], v[28:31], v[176:179]
s_xor_b32 s96, s43, 28800
s_add_u32 m0, s39, 94208
s_waitcnt vmcnt(4)
buffer_load_dwordx4 v224, s[20:23], s96 offen nt lds
v_cvt_pk_bf16_f32 v172, v188, v189
v_mfma_f32_16x16x32_bf16 v[180:183], a[0:3], v[32:35], 0
ds_read_b64_tr_b16 a[42:43], v235 offset:10240
v_cvt_pk_bf16_f32 v173, v190, v191
v_mfma_f32_16x16x32_bf16 v[180:183], a[4:7], v[36:39], v[180:183]
ds_read_b64_tr_b16 a[44:45], v235 offset:12288
v_mfma_f32_16x16x32_bf16 v[180:183], a[8:11], v[40:43], v[180:183]
ds_read_b64_tr_b16 a[46:47], v235 offset:14336
v_mfma_f32_16x16x32_bf16 v[180:183], a[12:15], v[44:47], v[180:183]
v_mul_f32 v176, v244, v176
v_mfma_f32_16x16x32_bf16 v[180:183], a[16:19], v[48:51], v[180:183]
ds_read_b64_tr_b16 a[48:49], v235 offset:16384
v_mul_f32 v177, v244, v177
v_mfma_f32_16x16x32_bf16 v[180:183], a[20:23], v[52:55], v[180:183]
ds_read_b64_tr_b16 a[50:51], v235 offset:18432
v_mul_f32 v178, v244, v178
v_mfma_f32_16x16x32_bf16 v[180:183], a[24:27], v[56:59], v[180:183]
v_mul_f32 v179, v244, v179
v_mfma_f32_16x16x32_bf16 v[180:183], a[28:31], v[60:63], v[180:183]
ds_read_b64_tr_b16 a[52:53], v235 offset:20480
v_cvt_pk_bf16_f32 v156, v176, v177
v_mfma_f32_16x16x32_bf16 v[184:187], a[0:3], v[64:67], 0
ds_read_b64_tr_b16 a[54:55], v235 offset:22528
v_cvt_pk_bf16_f32 v157, v178, v179
v_mfma_f32_16x16x32_bf16 v[184:187], a[4:7], v[68:71], v[184:187]
s_xor_b32 s96, s43, 0
s_add_u32 m0, s39, 98304
s_waitcnt vmcnt(4)
buffer_load_dwordx4 v224, s[24:27], s96 offen nt lds
ds_read_b64_tr_b16 a[56:57], v235 offset:24576
v_mfma_f32_16x16x32_bf16 v[184:187], a[8:11], v[72:75], v[184:187]
v_mfma_f32_16x16x32_bf16 v[184:187], a[12:15], v[76:79], v[184:187]
ds_read_b64_tr_b16 a[58:59], v235 offset:26624
v_mul_f32 v180, v245, v180
v_mfma_f32_16x16x32_bf16 v[184:187], a[16:19], v[80:83], v[184:187]
ds_read_b64_tr_b16 a[60:61], v235 offset:28672
v_mul_f32 v181, v245, v181
v_mfma_f32_16x16x32_bf16 v[184:187], a[20:23], v[84:87], v[184:187]
v_mul_f32 v182, v245, v182
v_mfma_f32_16x16x32_bf16 v[184:187], a[24:27], v[88:91], v[184:187]
s_waitcnt lgkmcnt(8)
ds_read_b64_tr_b16 a[62:63], v235 offset:30720
v_mul_f32 v183, v245, v183
v_mfma_f32_16x16x32_bf16 v[184:187], a[28:31], v[92:95], v[184:187]
v_cvt_pk_bf16_f32 v162, v180, v181
v_mfma_f32_16x16x32_bf16 v[188:191], a[0:3], v[96:99], 0
v_cvt_pk_bf16_f32 v163, v182, v183
v_mfma_f32_16x16x32_bf16 v[188:191], a[4:7], v[100:103], v[188:191]
v_mfma_f32_16x16x32_bf16 v[188:191], a[8:11], v[104:107], v[188:191]
v_mfma_f32_16x16x32_bf16 v[188:191], a[12:15], v[108:111], v[188:191]
s_xor_b32 s96, s43, 8192
s_add_u32 m0, s39, 102400
s_waitcnt vmcnt(4)
buffer_load_dwordx4 v224, s[24:27], s96 offen nt lds
v_mul_f32 v184, v246, v184
v_mfma_f32_16x16x32_bf16 v[188:191], a[16:19], v[112:115], v[188:191]
v_mul_f32 v185, v246, v185
v_mfma_f32_16x16x32_bf16 v[188:191], a[20:23], v[116:119], v[188:191]
v_mul_f32 v186, v246, v186
v_mfma_f32_16x16x32_bf16 v[188:191], a[24:27], v[120:123], v[188:191]
v_mul_f32 v187, v246, v187
v_mfma_f32_16x16x32_bf16 v[188:191], a[28:31], v[124:127], v[188:191]
v_cvt_pk_bf16_f32 v168, v184, v185
s_waitcnt lgkmcnt(0)
v_mfma_f32_16x16x32_bf16 v[176:179], a[32:35], v[0:3], 0
v_cvt_pk_bf16_f32 v169, v186, v187
s_barrier
v_add_u32 v232, 131072, v227
v_xor_b32 v233, 32, v232
v_xor_b32 v234, 64, v232
v_xor_b32 v235, 96, v232
v_mfma_f32_16x16x32_bf16 v[176:179], a[36:39], v[4:7], v[176:179]
ds_read_b64_tr_b16 a[0:1], v232 offset:0
v_mfma_f32_16x16x32_bf16 v[176:179], a[40:43], v[8:11], v[176:179]
ds_read_b64_tr_b16 a[2:3], v232 offset:2048
v_mfma_f32_16x16x32_bf16 v[176:179], a[44:47], v[12:15], v[176:179]
v_mul_f32 v188, v247, v188
v_mfma_f32_16x16x32_bf16 v[176:179], a[48:51], v[16:19], v[176:179]
s_xor_b32 s96, s43, 16384
s_add_u32 m0, s39, 106496
s_waitcnt vmcnt(4)
buffer_load_dwordx4 v224, s[24:27], s96 offen nt lds
ds_read_b64_tr_b16 a[4:5], v232 offset:4096
v_mul_f32 v189, v247, v189
v_mfma_f32_16x16x32_bf16 v[176:179], a[52:55], v[20:23], v[176:179]
ds_read_b64_tr_b16 a[6:7], v232 offset:6144
v_mul_f32 v190, v247, v190
v_mfma_f32_16x16x32_bf16 v[176:179], a[56:59], v[24:27], v[176:179]
v_mul_f32 v191, v247, v191
v_add_u32 v238, 32768, v228
v_xor_b32 v239, 32, v238
v_xor_b32 v240, 64, v238
v_xor_b32 v241, 96, v238
v_add_u32 v242, 32768, v229
v_mfma_f32_16x16x32_bf16 v[176:179], a[60:63], v[28:31], v[176:179]
ds_read_b64_tr_b16 a[8:9], v232 offset:8192
v_cvt_pk_bf16_f32 v174, v188, v189
v_mfma_f32_16x16x32_bf16 v[180:183], a[32:35], v[32:35], 0
ds_read_b64_tr_b16 a[10:11], v232 offset:10240
v_cvt_pk_bf16_f32 v175, v190, v191
v_mfma_f32_16x16x32_bf16 v[180:183], a[36:39], v[36:39], v[180:183]
v_mfma_f32_16x16x32_bf16 v[180:183], a[40:43], v[40:43], v[180:183]
ds_read_b64_tr_b16 a[12:13], v232 offset:12288
v_mfma_f32_16x16x32_bf16 v[180:183], a[44:47], v[44:47], v[180:183]
ds_read_b64_tr_b16 a[14:15], v232 offset:14336
v_mul_f32 v176, v244, v176
v_mfma_f32_16x16x32_bf16 v[180:183], a[48:51], v[48:51], v[180:183]
ds_write_b64 v238, v[152:153] offset:24576
v_mul_f32 v177, v244, v177
v_mfma_f32_16x16x32_bf16 v[180:183], a[52:55], v[52:55], v[180:183]
ds_write_b64 v239, v[154:155] offset:24576
ds_read_b64_tr_b16 a[16:17], v232 offset:16384
v_mul_f32 v178, v244, v178
v_mfma_f32_16x16x32_bf16 v[180:183], a[56:59], v[56:59], v[180:183]
s_xor_b32 s96, s43, 24576
s_add_u32 m0, s39, 110592
s_waitcnt vmcnt(4)
buffer_load_dwordx4 v224, s[24:27], s96 offen nt lds
ds_read_b64_tr_b16 a[18:19], v232 offset:18432
v_mul_f32 v179, v244, v179
v_mfma_f32_16x16x32_bf16 v[180:183], a[60:63], v[60:63], v[180:183]
ds_write_b64 v240, v[156:157] offset:24576
v_cvt_pk_bf16_f32 v176, v176, v177
v_mfma_f32_16x16x32_bf16 v[184:187], a[32:35], v[64:67], 0
ds_read_b64_tr_b16 a[20:21], v232 offset:20480
v_cvt_pk_bf16_f32 v177, v178, v179
v_mfma_f32_16x16x32_bf16 v[184:187], a[36:39], v[68:71], v[184:187]
ds_write_b64 v241, v[176:177] offset:24576
s_waitcnt lgkmcnt(8)
ds_read_b64_tr_b16 a[22:23], v232 offset:22528
v_mfma_f32_16x16x32_bf16 v[184:187], a[40:43], v[72:75], v[184:187]
ds_read_b128 a[192:195], v242 offset:24576
v_mfma_f32_16x16x32_bf16 v[184:187], a[44:47], v[76:79], v[184:187]
ds_read_b128 a[196:199], v242 offset:28672
ds_read_b64_tr_b16 a[24:25], v232 offset:24576
v_mul_f32 v180, v245, v180
v_mfma_f32_16x16x32_bf16 v[184:187], a[48:51], v[80:83], v[184:187]
ds_write_b64 v238, v[158:159] offset:24576
ds_read_b64_tr_b16 a[26:27], v232 offset:26624
v_mul_f32 v181, v245, v181
v_mfma_f32_16x16x32_bf16 v[184:187], a[52:55], v[84:87], v[184:187]
ds_write_b64 v239, v[160:161] offset:24576
v_mul_f32 v182, v245, v182
v_mfma_f32_16x16x32_bf16 v[184:187], a[56:59], v[88:91], v[184:187]
s_waitcnt lgkmcnt(8)
ds_read_b64_tr_b16 a[28:29], v232 offset:28672
v_mul_f32 v183, v245, v183
v_mfma_f32_16x16x32_bf16 v[184:187], a[60:63], v[92:95], v[184:187]
ds_write_b64 v240, v[162:163] offset:24576
ds_read_b64_tr_b16 a[30:31], v232 offset:30720
v_cvt_pk_bf16_f32 v180, v180, v181
v_mfma_f32_16x16x32_bf16 v[188:191], a[32:35], v[96:99], 0
s_xor_b32 s96, s43, 4096
s_add_u32 m0, s39, 114688
s_waitcnt vmcnt(4)
buffer_load_dwordx4 v224, s[24:27], s96 offen nt lds
v_cvt_pk_bf16_f32 v181, v182, v183
v_mfma_f32_16x16x32_bf16 v[188:191], a[36:39], v[100:103], v[188:191]
ds_write_b64 v241, v[180:181] offset:24576
v_mfma_f32_16x16x32_bf16 v[188:191], a[40:43], v[104:107], v[188:191]
ds_read_b128 a[200:203], v242 offset:24576
v_mfma_f32_16x16x32_bf16 v[188:191], a[44:47], v[108:111], v[188:191]
ds_read_b128 a[204:207], v242 offset:28672
v_mul_f32 v184, v246, v184
v_mfma_f32_16x16x32_bf16 v[188:191], a[48:51], v[112:115], v[188:191]
ds_write_b64 v238, v[164:165] offset:24576
v_mul_f32 v185, v246, v185
v_mfma_f32_16x16x32_bf16 v[188:191], a[52:55], v[116:119], v[188:191]
s_waitcnt lgkmcnt(8)
ds_write_b64 v239, v[166:167] offset:24576
v_mul_f32 v186, v246, v186
v_mfma_f32_16x16x32_bf16 v[188:191], a[56:59], v[120:123], v[188:191]
v_mul_f32 v187, v246, v187
v_mfma_f32_16x16x32_bf16 v[188:191], a[60:63], v[124:127], v[188:191]
ds_write_b64 v240, v[168:169] offset:24576
v_cvt_pk_bf16_f32 v184, v184, v185
s_waitcnt lgkmcnt(6)
v_mfma_f32_16x16x32_bf16 v[176:179], a[0:3], v[0:3], 0
v_cvt_pk_bf16_f32 v185, v186, v187
v_mfma_f32_16x16x32_bf16 v[176:179], a[4:7], v[4:7], v[176:179]
ds_write_b64 v241, v[184:185] offset:24576
ds_read_b64_tr_b16 a[32:33], v233 offset:0
v_mfma_f32_16x16x32_bf16 v[176:179], a[8:11], v[8:11], v[176:179]
s_xor_b32 s96, s43, 12288
s_add_u32 m0, s39, 118784
s_waitcnt vmcnt(4)
buffer_load_dwordx4 v224, s[24:27], s96 offen nt lds
ds_read_b128 a[208:211], v242 offset:24576
ds_read_b64_tr_b16 a[34:35], v233 offset:2048
v_mfma_f32_16x16x32_bf16 v[176:179], a[12:15], v[12:15], v[176:179]
ds_read_b128 a[212:215], v242 offset:28672
v_mul_f32 v188, v247, v188
v_mfma_f32_16x16x32_bf16 v[176:179], a[16:19], v[16:19], v[176:179]
ds_write_b64 v238, v[170:171] offset:24576
ds_read_b64_tr_b16 a[36:37], v233 offset:4096
v_mul_f32 v189, v247, v189
v_mfma_f32_16x16x32_bf16 v[176:179], a[20:23], v[20:23], v[176:179]
ds_write_b64 v239, v[172:173] offset:24576
ds_read_b64_tr_b16 a[38:39], v233 offset:6144
v_mul_f32 v190, v247, v190
v_mfma_f32_16x16x32_bf16 v[176:179], a[24:27], v[24:27], v[176:179]
v_mul_f32 v191, v247, v191
v_mfma_f32_16x16x32_bf16 v[176:179], a[28:31], v[28:31], v[176:179]
s_waitcnt lgkmcnt(8)
ds_write_b64 v240, v[174:175] offset:24576
ds_read_b64_tr_b16 a[40:41], v233 offset:8192
v_cvt_pk_bf16_f32 v188, v188, v189
v_mfma_f32_16x16x32_bf16 v[180:183], a[0:3], v[32:35], 0
ds_read_b64_tr_b16 a[42:43], v233 offset:10240
v_cvt_pk_bf16_f32 v189, v190, v191
v_mfma_f32_16x16x32_bf16 v[180:183], a[4:7], v[36:39], v[180:183]
ds_write_b64 v241, v[188:189] offset:24576
v_mfma_f32_16x16x32_bf16 v[180:183], a[8:11], v[40:43], v[180:183]
ds_read_b128 a[216:219], v242 offset:24576
ds_read_b64_tr_b16 a[44:45], v233 offset:12288
v_mfma_f32_16x16x32_bf16 v[180:183], a[12:15], v[44:47], v[180:183]
s_xor_b32 s96, s43, 20480
s_add_u32 m0, s39, 122880
s_waitcnt vmcnt(4)
buffer_load_dwordx4 v224, s[24:27], s96 offen nt lds
ds_read_b128 a[220:223], v242 offset:28672
s_waitcnt lgkmcnt(8)
ds_read_b64_tr_b16 a[46:47], v233 offset:14336
v_mul_f32 v176, v244, v176
v_mfma_f32_16x16x32_bf16 v[180:183], a[16:19], v[48:51], v[180:183]
v_mul_f32 v177, v244, v177
v_mfma_f32_16x16x32_bf16 v[180:183], a[20:23], v[52:55], v[180:183]
ds_read_b64_tr_b16 a[48:49], v233 offset:16384
v_mul_f32 v178, v244, v178
v_mfma_f32_16x16x32_bf16 v[180:183], a[24:27], v[56:59], v[180:183]
ds_read_b64_tr_b16 a[50:51], v233 offset:18432
v_mul_f32 v179, v244, v179
v_mfma_f32_16x16x32_bf16 v[180:183], a[28:31], v[60:63], v[180:183]
v_cvt_pk_bf16_f32 v152, v176, v177
v_mfma_f32_16x16x32_bf16 v[184:187], a[0:3], v[64:67], 0
ds_read_b64_tr_b16 a[52:53], v233 offset:20480
v_cvt_pk_bf16_f32 v153, v178, v179
v_mfma_f32_16x16x32_bf16 v[184:187], a[4:7], v[68:71], v[184:187]
ds_read_b64_tr_b16 a[54:55], v233 offset:22528
v_mfma_f32_16x16x32_bf16 v[184:187], a[8:11], v[72:75], v[184:187]
v_mfma_f32_16x16x32_bf16 v[184:187], a[12:15], v[76:79], v[184:187]
ds_read_b64_tr_b16 a[56:57], v233 offset:24576
v_mul_f32 v180, v245, v180
v_mfma_f32_16x16x32_bf16 v[184:187], a[16:19], v[80:83], v[184:187]
ds_read_b64_tr_b16 a[58:59], v233 offset:26624
v_mul_f32 v181, v245, v181
v_mfma_f32_16x16x32_bf16 v[184:187], a[20:23], v[84:87], v[184:187]
s_xor_b32 s96, s43, 28672
s_add_u32 m0, s39, 126976
s_waitcnt vmcnt(4)
buffer_load_dwordx4 v224, s[24:27], s96 offen nt lds
v_mul_f32 v182, v245, v182
v_mfma_f32_16x16x32_bf16 v[184:187], a[24:27], v[88:91], v[184:187]
s_waitcnt lgkmcnt(8)
ds_read_b64_tr_b16 a[60:61], v233 offset:28672
v_mul_f32 v183, v245, v183
v_mfma_f32_16x16x32_bf16 v[184:187], a[28:31], v[92:95], v[184:187]
ds_read_b64_tr_b16 a[62:63], v233 offset:30720
v_cvt_pk_bf16_f32 v158, v180, v181
v_mfma_f32_16x16x32_bf16 v[188:191], a[0:3], v[96:99], 0
v_cvt_pk_bf16_f32 v159, v182, v183
v_mfma_f32_16x16x32_bf16 v[188:191], a[4:7], v[100:103], v[188:191]
v_mfma_f32_16x16x32_bf16 v[188:191], a[8:11], v[104:107], v[188:191]
v_mfma_f32_16x16x32_bf16 v[188:191], a[12:15], v[108:111], v[188:191]
s_nop 0
v_mul_f32 v184, v246, v184
v_mfma_f32_16x16x32_bf16 v[188:191], a[16:19], v[112:115], v[188:191]
v_mul_f32 v185, v246, v185
v_mfma_f32_16x16x32_bf16 v[188:191], a[20:23], v[116:119], v[188:191]
v_mul_f32 v186, v246, v186
v_mfma_f32_16x16x32_bf16 v[188:191], a[24:27], v[120:123], v[188:191]
v_mul_f32 v187, v246, v187
v_mfma_f32_16x16x32_bf16 v[188:191], a[28:31], v[124:127], v[188:191]
s_xor_b32 s96, s41, 256
s_add_u32 m0, s39, 32768
s_waitcnt vmcnt(4)
buffer_load_dwordx4 v224, s[16:19], s96 offen nt lds
v_cvt_pk_bf16_f32 v164, v184, v185
s_waitcnt lgkmcnt(0)
v_mfma_f32_16x16x32_bf16 v[176:179], a[32:35], v[0:3], 0
v_cvt_pk_bf16_f32 v165, v186, v187
v_mfma_f32_16x16x32_bf16 v[176:179], a[36:39], v[4:7], v[176:179]
ds_read_b64_tr_b16 a[0:1], v234 offset:0
v_mfma_f32_16x16x32_bf16 v[176:179], a[40:43], v[8:11], v[176:179]
ds_read_b64_tr_b16 a[2:3], v234 offset:2048
v_mfma_f32_16x16x32_bf16 v[176:179], a[44:47], v[12:15], v[176:179]
v_mul_f32 v188, v247, v188
v_mfma_f32_16x16x32_bf16 v[176:179], a[48:51], v[16:19], v[176:179]
ds_read_b64_tr_b16 a[4:5], v234 offset:4096
v_mul_f32 v189, v247, v189
v_mfma_f32_16x16x32_bf16 v[176:179], a[52:55], v[20:23], v[176:179]
ds_read_b64_tr_b16 a[6:7], v234 offset:6144
v_mul_f32 v190, v247, v190
v_mfma_f32_16x16x32_bf16 v[176:179], a[56:59], v[24:27], v[176:179]
v_mul_f32 v191, v247, v191
v_mfma_f32_16x16x32_bf16 v[176:179], a[60:63], v[28:31], v[176:179]
ds_read_b64_tr_b16 a[8:9], v234 offset:8192
v_cvt_pk_bf16_f32 v170, v188, v189
v_mfma_f32_16x16x32_bf16 v[180:183], a[32:35], v[32:35], 0
ds_read_b64_tr_b16 a[10:11], v234 offset:10240
v_cvt_pk_bf16_f32 v171, v190, v191
v_mfma_f32_16x16x32_bf16 v[180:183], a[36:39], v[36:39], v[180:183]
s_xor_b32 s96, s41, 8448
s_add_u32 m0, s39, 36864
s_waitcnt vmcnt(4)
buffer_load_dwordx4 v224, s[16:19], s96 offen nt lds
v_mfma_f32_16x16x32_bf16 v[180:183], a[40:43], v[40:43], v[180:183]
ds_read_b64_tr_b16 a[12:13], v234 offset:12288
v_mfma_f32_16x16x32_bf16 v[180:183], a[44:47], v[44:47], v[180:183]
ds_read_b64_tr_b16 a[14:15], v234 offset:14336
v_mul_f32 v176, v244, v176
v_mfma_f32_16x16x32_bf16 v[180:183], a[48:51], v[48:51], v[180:183]
v_mul_f32 v177, v244, v177
v_mfma_f32_16x16x32_bf16 v[180:183], a[52:55], v[52:55], v[180:183]
ds_read_b64_tr_b16 a[16:17], v234 offset:16384
v_mul_f32 v178, v244, v178
v_mfma_f32_16x16x32_bf16 v[180:183], a[56:59], v[56:59], v[180:183]
ds_read_b64_tr_b16 a[18:19], v234 offset:18432
v_mul_f32 v179, v244, v179
v_mfma_f32_16x16x32_bf16 v[180:183], a[60:63], v[60:63], v[180:183]
v_cvt_pk_bf16_f32 v154, v176, v177
v_mfma_f32_16x16x32_bf16 v[184:187], a[32:35], v[64:67], 0
ds_read_b64_tr_b16 a[20:21], v234 offset:20480
v_cvt_pk_bf16_f32 v155, v178, v179
v_mfma_f32_16x16x32_bf16 v[184:187], a[36:39], v[68:71], v[184:187]
ds_read_b64_tr_b16 a[22:23], v234 offset:22528
v_mfma_f32_16x16x32_bf16 v[184:187], a[40:43], v[72:75], v[184:187]
s_xor_b32 s96, s41, 16640
s_add_u32 m0, s39, 40960
s_waitcnt vmcnt(4)
buffer_load_dwordx4 v224, s[16:19], s96 offen nt lds
v_mfma_f32_16x16x32_bf16 v[184:187], a[44:47], v[76:79], v[184:187]
ds_read_b64_tr_b16 a[24:25], v234 offset:24576
v_mul_f32 v180, v245, v180
v_mfma_f32_16x16x32_bf16 v[184:187], a[48:51], v[80:83], v[184:187]
ds_read_b64_tr_b16 a[26:27], v234 offset:26624
v_mul_f32 v181, v245, v181
v_mfma_f32_16x16x32_bf16 v[184:187], a[52:55], v[84:87], v[184:187]
v_mul_f32 v182, v245, v182
v_mfma_f32_16x16x32_bf16 v[184:187], a[56:59], v[88:91], v[184:187]
ds_read_b64_tr_b16 a[28:29], v234 offset:28672
v_mul_f32 v183, v245, v183
v_mfma_f32_16x16x32_bf16 v[184:187], a[60:63], v[92:95], v[184:187]
s_waitcnt lgkmcnt(8)
ds_read_b64_tr_b16 a[30:31], v234 offset:30720
v_cvt_pk_bf16_f32 v160, v180, v181
v_mfma_f32_16x16x32_bf16 v[188:191], a[32:35], v[96:99], 0
v_cvt_pk_bf16_f32 v161, v182, v183
v_mfma_f32_16x16x32_bf16 v[188:191], a[36:39], v[100:103], v[188:191]
v_mfma_f32_16x16x32_bf16 v[188:191], a[40:43], v[104:107], v[188:191]
v_mfma_f32_16x16x32_bf16 v[188:191], a[44:47], v[108:111], v[188:191]
v_mul_f32 v184, v246, v184
v_mfma_f32_16x16x32_bf16 v[188:191], a[48:51], v[112:115], v[188:191]
s_xor_b32 s96, s41, 24832
s_add_u32 m0, s39, 45056
s_waitcnt vmcnt(4)
buffer_load_dwordx4 v224, s[16:19], s96 offen nt lds
v_mul_f32 v185, v246, v185
v_mfma_f32_16x16x32_bf16 v[188:191], a[52:55], v[116:119], v[188:191]
v_mul_f32 v186, v246, v186
v_mfma_f32_16x16x32_bf16 v[188:191], a[56:59], v[120:123], v[188:191]
v_mul_f32 v187, v246, v187
v_mfma_f32_16x16x32_bf16 v[188:191], a[60:63], v[124:127], v[188:191]
v_cvt_pk_bf16_f32 v166, v184, v185
s_waitcnt lgkmcnt(0)
v_mfma_f32_16x16x32_bf16 v[176:179], a[0:3], v[0:3], 0
v_cvt_pk_bf16_f32 v167, v186, v187
v_mfma_f32_16x16x32_bf16 v[176:179], a[4:7], v[4:7], v[176:179]
ds_read_b64_tr_b16 a[32:33], v235 offset:0
v_mfma_f32_16x16x32_bf16 v[176:179], a[8:11], v[8:11], v[176:179]
ds_read_b64_tr_b16 a[34:35], v235 offset:2048
v_mfma_f32_16x16x32_bf16 v[176:179], a[12:15], v[12:15], v[176:179]
ds_read_b64_tr_b16 a[36:37], v235 offset:4096
v_mul_f32 v188, v247, v188
v_mfma_f32_16x16x32_bf16 v[176:179], a[16:19], v[16:19], v[176:179]
v_mul_f32 v189, v247, v189
v_mfma_f32_16x16x32_bf16 v[176:179], a[20:23], v[20:23], v[176:179]
ds_read_b64_tr_b16 a[38:39], v235 offset:6144
v_mul_f32 v190, v247, v190
v_mfma_f32_16x16x32_bf16 v[176:179], a[24:27], v[24:27], v[176:179]
s_xor_b32 s96, s41, 4352
s_add_u32 m0, s39, 49152
s_waitcnt vmcnt(4)
buffer_load_dwordx4 v224, s[16:19], s96 offen nt lds
ds_read_b64_tr_b16 a[40:41], v235 offset:8192
v_mul_f32 v191, v247, v191
v_mfma_f32_16x16x32_bf16 v[176:179], a[28:31], v[28:31], v[176:179]
v_cvt_pk_bf16_f32 v172, v188, v189
v_mfma_f32_16x16x32_bf16 v[180:183], a[0:3], v[32:35], 0
ds_read_b64_tr_b16 a[42:43], v235 offset:10240
v_cvt_pk_bf16_f32 v173, v190, v191
v_mfma_f32_16x16x32_bf16 v[180:183], a[4:7], v[36:39], v[180:183]
ds_read_b64_tr_b16 a[44:45], v235 offset:12288
v_mfma_f32_16x16x32_bf16 v[180:183], a[8:11], v[40:43], v[180:183]
ds_read_b64_tr_b16 a[46:47], v235 offset:14336
v_mfma_f32_16x16x32_bf16 v[180:183], a[12:15], v[44:47], v[180:183]
v_mul_f32 v176, v244, v176
v_mfma_f32_16x16x32_bf16 v[180:183], a[16:19], v[48:51], v[180:183]
ds_read_b64_tr_b16 a[48:49], v235 offset:16384
v_mul_f32 v177, v244, v177
v_mfma_f32_16x16x32_bf16 v[180:183], a[20:23], v[52:55], v[180:183]
ds_read_b64_tr_b16 a[50:51], v235 offset:18432
v_mul_f32 v178, v244, v178
v_mfma_f32_16x16x32_bf16 v[180:183], a[24:27], v[56:59], v[180:183]
v_mul_f32 v179, v244, v179
v_mfma_f32_16x16x32_bf16 v[180:183], a[28:31], v[60:63], v[180:183]
ds_read_b64_tr_b16 a[52:53], v235 offset:20480
v_cvt_pk_bf16_f32 v156, v176, v177
v_mfma_f32_16x16x32_bf16 v[184:187], a[0:3], v[64:67], 0
s_xor_b32 s96, s41, 12544
s_add_u32 m0, s39, 53248
s_waitcnt vmcnt(4)
buffer_load_dwordx4 v224, s[16:19], s96 offen nt lds
ds_read_b64_tr_b16 a[54:55], v235 offset:22528
v_cvt_pk_bf16_f32 v157, v178, v179
v_mfma_f32_16x16x32_bf16 v[184:187], a[4:7], v[68:71], v[184:187]
ds_read_b64_tr_b16 a[56:57], v235 offset:24576
v_mfma_f32_16x16x32_bf16 v[184:187], a[8:11], v[72:75], v[184:187]
v_mfma_f32_16x16x32_bf16 v[184:187], a[12:15], v[76:79], v[184:187]
ds_read_b64_tr_b16 a[58:59], v235 offset:26624
v_mul_f32 v180, v245, v180
v_mfma_f32_16x16x32_bf16 v[184:187], a[16:19], v[80:83], v[184:187]
ds_read_b64_tr_b16 a[60:61], v235 offset:28672
v_mul_f32 v181, v245, v181
v_mfma_f32_16x16x32_bf16 v[184:187], a[20:23], v[84:87], v[184:187]
v_mul_f32 v182, v245, v182
v_mfma_f32_16x16x32_bf16 v[184:187], a[24:27], v[88:91], v[184:187]
s_waitcnt lgkmcnt(8)
ds_read_b64_tr_b16 a[62:63], v235 offset:30720
v_mul_f32 v183, v245, v183
v_mfma_f32_16x16x32_bf16 v[184:187], a[28:31], v[92:95], v[184:187]
v_cvt_pk_bf16_f32 v162, v180, v181
v_mfma_f32_16x16x32_bf16 v[188:191], a[0:3], v[96:99], 0
v_cvt_pk_bf16_f32 v163, v182, v183
v_mfma_f32_16x16x32_bf16 v[188:191], a[4:7], v[100:103], v[188:191]
s_xor_b32 s96, s41, 20736
s_add_u32 m0, s39, 57344
s_waitcnt vmcnt(4)
buffer_load_dwordx4 v224, s[16:19], s96 offen nt lds
v_mfma_f32_16x16x32_bf16 v[188:191], a[8:11], v[104:107], v[188:191]
v_mfma_f32_16x16x32_bf16 v[188:191], a[12:15], v[108:111], v[188:191]
v_mul_f32 v184, v246, v184
v_mfma_f32_16x16x32_bf16 v[188:191], a[16:19], v[112:115], v[188:191]
v_mul_f32 v185, v246, v185
v_mfma_f32_16x16x32_bf16 v[188:191], a[20:23], v[116:119], v[188:191]
v_mul_f32 v186, v246, v186
v_mfma_f32_16x16x32_bf16 v[188:191], a[24:27], v[120:123], v[188:191]
v_mul_f32 v187, v246, v187
v_mfma_f32_16x16x32_bf16 v[188:191], a[28:31], v[124:127], v[188:191]
v_cvt_pk_bf16_f32 v168, v184, v185
s_waitcnt lgkmcnt(0)
v_mfma_f32_16x16x32_bf16 v[176:179], a[32:35], v[0:3], 0
v_cvt_pk_bf16_f32 v169, v186, v187
s_barrier
v_add_u32 v232, 0, v225
v_xor_b32 v233, 64, v232
v_mfma_f32_16x16x32_bf16 v[176:179], a[36:39], v[4:7], v[176:179]
v_mfma_f32_16x16x32_bf16 v[176:179], a[40:43], v[8:11], v[176:179]
v_mfma_f32_16x16x32_bf16 v[176:179], a[44:47], v[12:15], v[176:179]
s_xor_b32 s96, s41, 28928
s_add_u32 m0, s39, 61440
s_waitcnt vmcnt(4)
buffer_load_dwordx4 v224, s[16:19], s96 offen nt lds
v_mul_f32 v188, v247, v188
v_mfma_f32_16x16x32_bf16 v[176:179], a[48:51], v[16:19], v[176:179]
v_mul_f32 v189, v247, v189
v_mfma_f32_16x16x32_bf16 v[176:179], a[52:55], v[20:23], v[176:179]
v_mul_f32 v190, v247, v190
v_mfma_f32_16x16x32_bf16 v[176:179], a[56:59], v[24:27], v[176:179]
v_mul_f32 v191, v247, v191
v_add_u32 v238, 131072, v228
v_xor_b32 v239, 32, v238
v_xor_b32 v240, 64, v238
v_xor_b32 v241, 96, v238
v_add_u32 v242, 131072, v229
v_mfma_f32_16x16x32_bf16 v[176:179], a[60:63], v[28:31], v[176:179]
v_cvt_pk_bf16_f32 v174, v188, v189
v_mfma_f32_16x16x32_bf16 v[180:183], a[32:35], v[32:35], 0
v_cvt_pk_bf16_f32 v175, v190, v191
v_mfma_f32_16x16x32_bf16 v[180:183], a[36:39], v[36:39], v[180:183]
v_mfma_f32_16x16x32_bf16 v[180:183], a[40:43], v[40:43], v[180:183]
v_mfma_f32_16x16x32_bf16 v[180:183], a[44:47], v[44:47], v[180:183]
s_nop 1
v_mul_f32 v176, v244, v176
v_mfma_f32_16x16x32_bf16 v[180:183], a[48:51], v[48:51], v[180:183]
ds_write_b64 v238, v[152:153] offset:24576
v_mul_f32 v177, v244, v177
v_mfma_f32_16x16x32_bf16 v[180:183], a[52:55], v[52:55], v[180:183]
s_xor_b32 s96, s43, 256
s_add_u32 m0, s39, 131072
s_waitcnt vmcnt(4)
buffer_load_dwordx4 v224, s[20:23], s96 offen nt lds
ds_write_b64 v239, v[154:155] offset:24576
v_mul_f32 v178, v244, v178
v_mfma_f32_16x16x32_bf16 v[180:183], a[56:59], v[56:59], v[180:183]
v_mul_f32 v179, v244, v179
v_mfma_f32_16x16x32_bf16 v[180:183], a[60:63], v[60:63], v[180:183]
ds_write_b64 v240, v[156:157] offset:24576
v_cvt_pk_bf16_f32 v176, v176, v177
v_mfma_f32_16x16x32_bf16 v[184:187], a[32:35], v[64:67], 0
ds_read_b128 a[96:99], v232 offset:0
v_cvt_pk_bf16_f32 v177, v178, v179
v_mfma_f32_16x16x32_bf16 v[184:187], a[36:39], v[68:71], v[184:187]
ds_write_b64 v241, v[176:177] offset:24576
ds_read_b128 a[100:103], v233 offset:0
v_mfma_f32_16x16x32_bf16 v[184:187], a[40:43], v[72:75], v[184:187]
ds_read_b128 a[224:227], v242 offset:24576
v_mfma_f32_16x16x32_bf16 v[184:187], a[44:47], v[76:79], v[184:187]
ds_read_b128 a[228:231], v242 offset:28672
v_mul_f32 v180, v245, v180
v_mfma_f32_16x16x32_bf16 v[184:187], a[48:51], v[80:83], v[184:187]
ds_write_b64 v238, v[158:159] offset:24576
v_mul_f32 v181, v245, v181
v_mfma_f32_16x16x32_bf16 v[184:187], a[52:55], v[84:87], v[184:187]
ds_write_b64 v239, v[160:161] offset:24576
v_mul_f32 v182, v245, v182
v_mfma_f32_16x16x32_bf16 v[184:187], a[56:59], v[88:91], v[184:187]
v_mul_f32 v183, v245, v183
v_mfma_f32_16x16x32_bf16 v[184:187], a[60:63], v[92:95], v[184:187]
s_xor_b32 s96, s43, 8448
s_add_u32 m0, s39, 135168
s_waitcnt vmcnt(4)
buffer_load_dwordx4 v224, s[20:23], s96 offen nt lds
ds_write_b64 v240, v[162:163] offset:24576
v_cvt_pk_bf16_f32 v180, v180, v181
v_mfma_f32_16x16x32_bf16 v[188:191], a[32:35], v[96:99], 0
ds_read_b128 a[104:107], v232 offset:2048
v_cvt_pk_bf16_f32 v181, v182, v183
v_mfma_f32_16x16x32_bf16 v[188:191], a[36:39], v[100:103], v[188:191]
ds_write_b64 v241, v[180:181] offset:24576
ds_read_b128 a[108:111], v233 offset:2048
v_mfma_f32_16x16x32_bf16 v[188:191], a[40:43], v[104:107], v[188:191]
ds_read_b128 a[232:235], v242 offset:24576
v_mfma_f32_16x16x32_bf16 v[188:191], a[44:47], v[108:111], v[188:191]
s_waitcnt lgkmcnt(8)
ds_read_b128 a[236:239], v242 offset:28672
v_mul_f32 v184, v246, v184
v_mfma_f32_16x16x32_bf16 v[188:191], a[48:51], v[112:115], v[188:191]
ds_write_b64 v238, v[164:165] offset:24576
v_mul_f32 v185, v246, v185
v_mfma_f32_16x16x32_bf16 v[188:191], a[52:55], v[116:119], v[188:191]
ds_write_b64 v239, v[166:167] offset:24576
v_mul_f32 v186, v246, v186
v_mfma_f32_16x16x32_bf16 v[188:191], a[56:59], v[120:123], v[188:191]
v_mul_f32 v187, v246, v187
v_mfma_f32_16x16x32_bf16 v[188:191], a[60:63], v[124:127], v[188:191]
ds_write_b64 v240, v[168:169] offset:24576
v_cvt_pk_bf16_f32 v184, v184, v185
v_mfma_f32_16x16x32_bf16 v[0:3], a[96:99], v[192:195], 0
ds_read_b128 a[112:115], v232 offset:4096
v_cvt_pk_bf16_f32 v185, v186, v187
v_mfma_f32_16x16x32_bf16 v[0:3], a[100:103], v[196:199], v[0:3]
s_xor_b32 s96, s43, 16640
s_add_u32 m0, s39, 139264
s_waitcnt vmcnt(4)
buffer_load_dwordx4 v224, s[20:23], s96 offen nt lds
ds_write_b64 v241, v[184:185] offset:24576
ds_read_b128 a[116:119], v233 offset:4096
v_mfma_f32_16x16x32_bf16 v[64:67], a[96:99], v[200:203], 0
s_waitcnt lgkmcnt(8)
ds_read_b128 a[240:243], v242 offset:24576
v_mfma_f32_16x16x32_bf16 v[64:67], a[100:103], v[204:207], v[64:67]
ds_read_b128 a[244:247], v242 offset:28672
v_mul_f32 v188, v247, v188
v_mfma_f32_16x16x32_bf16 v[128:131], a[96:99], v[208:211], 0
ds_write_b64 v238, v[170:171] offset:24576
v_mul_f32 v189, v247, v189
v_mfma_f32_16x16x32_bf16 v[128:131], a[100:103], v[212:215], v[128:131]
ds_write_b64 v239, v[172:173] offset:24576
v_mul_f32 v190, v247, v190
v_mfma_f32_16x16x32_bf16 a[0:3], a[96:99], v[216:219], 0
v_mul_f32 v191, v247, v191
v_mfma_f32_16x16x32_bf16 a[0:3], a[100:103], v[220:223], a[0:3]
ds_write_b64 v240, v[174:175] offset:24576
v_cvt_pk_bf16_f32 v188, v188, v189
v_mfma_f32_16x16x32_bf16 v[4:7], a[104:107], v[192:195], 0
ds_read_b128 a[120:123], v232 offset:6144
v_cvt_pk_bf16_f32 v189, v190, v191
v_mfma_f32_16x16x32_bf16 v[4:7], a[108:111], v[196:199], v[4:7]
ds_write_b64 v241, v[188:189] offset:24576
s_waitcnt lgkmcnt(8)
ds_read_b128 a[124:127], v233 offset:6144
v_mfma_f32_16x16x32_bf16 v[68:71], a[104:107], v[200:203], 0
ds_read_b128 a[248:251], v242 offset:24576
v_mfma_f32_16x16x32_bf16 v[68:71], a[108:111], v[204:207], v[68:71]
s_xor_b32 s96, s43, 24832
s_add_u32 m0, s39, 143360
s_waitcnt vmcnt(4)
buffer_load_dwordx4 v224, s[20:23], s96 offen nt lds
ds_read_b128 a[252:255], v242 offset:28672
v_mfma_f32_16x16x32_bf16 v[132:135], a[104:107], v[208:211], 0
v_mfma_f32_16x16x32_bf16 v[132:135], a[108:111], v[212:215], v[132:135]
v_mfma_f32_16x16x32_bf16 a[4:7], a[104:107], v[216:219], 0
v_mfma_f32_16x16x32_bf16 a[4:7], a[108:111], v[220:223], a[4:7]
s_waitcnt lgkmcnt(10)
v_mfma_f32_16x16x32_bf16 v[8:11], a[112:115], v[192:195], 0
ds_read_b128 a[96:99], v232 offset:8192
v_mfma_f32_16x16x32_bf16 v[8:11], a[116:119], v[196:199], v[8:11]
ds_read_b128 a[100:103], v233 offset:8192
v_mfma_f32_16x16x32_bf16 v[72:75], a[112:115], v[200:203], 0
v_mfma_f32_16x16x32_bf16 v[72:75], a[116:119], v[204:207], v[72:75]
v_mfma_f32_16x16x32_bf16 v[136:139], a[112:115], v[208:211], 0
v_mfma_f32_16x16x32_bf16 v[136:139], a[116:119], v[212:215], v[136:139]
s_xor_b32 s96, s43, 4352
s_add_u32 m0, s39, 147456
s_waitcnt vmcnt(4)
buffer_load_dwordx4 v224, s[20:23], s96 offen nt lds
v_mfma_f32_16x16x32_bf16 a[8:11], a[112:115], v[216:219], 0
v_mfma_f32_16x16x32_bf16 a[8:11], a[116:119], v[220:223], a[8:11]
s_waitcnt lgkmcnt(4)
v_mfma_f32_16x16x32_bf16 v[12:15], a[120:123], v[192:195], 0
ds_read_b128 a[104:107], v232 offset:10240
v_mfma_f32_16x16x32_bf16 v[12:15], a[124:127], v[196:199], v[12:15]
ds_read_b128 a[108:111], v233 offset:10240
v_mfma_f32_16x16x32_bf16 v[76:79], a[120:123], v[200:203], 0
v_mfma_f32_16x16x32_bf16 v[76:79], a[124:127], v[204:207], v[76:79]
v_mfma_f32_16x16x32_bf16 v[140:143], a[120:123], v[208:211], 0
v_mfma_f32_16x16x32_bf16 v[140:143], a[124:127], v[212:215], v[140:143]
v_mfma_f32_16x16x32_bf16 a[12:15], a[120:123], v[216:219], 0
v_mfma_f32_16x16x32_bf16 a[12:15], a[124:127], v[220:223], a[12:15]
s_waitcnt lgkmcnt(2)
v_mfma_f32_16x16x32_bf16 v[16:19], a[96:99], v[192:195], 0
s_xor_b32 s96, s43, 12544
s_add_u32 m0, s39, 151552
s_waitcnt vmcnt(4)
buffer_load_dwordx4 v224, s[20:23], s96 offen nt lds
ds_read_b128 a[112:115], v232 offset:12288
v_mfma_f32_16x16x32_bf16 v[16:19], a[100:103], v[196:199], v[16:19]
ds_read_b128 a[116:119], v233 offset:12288
v_mfma_f32_16x16x32_bf16 v[80:83], a[96:99], v[200:203], 0
v_mfma_f32_16x16x32_bf16 v[80:83], a[100:103], v[204:207], v[80:83]
v_mfma_f32_16x16x32_bf16 v[144:147], a[96:99], v[208:211], 0
v_mfma_f32_16x16x32_bf16 v[144:147], a[100:103], v[212:215], v[144:147]
v_mfma_f32_16x16x32_bf16 a[16:19], a[96:99], v[216:219], 0
v_mfma_f32_16x16x32_bf16 a[16:19], a[100:103], v[220:223], a[16:19]
s_waitcnt lgkmcnt(2)
v_mfma_f32_16x16x32_bf16 v[20:23], a[104:107], v[192:195], 0
ds_read_b128 a[120:123], v232 offset:14336
v_mfma_f32_16x16x32_bf16 v[20:23], a[108:111], v[196:199], v[20:23]
ds_read_b128 a[124:127], v233 offset:14336
v_mfma_f32_16x16x32_bf16 v[84:87], a[104:107], v[200:203], 0
s_xor_b32 s96, s43, 20736
s_add_u32 m0, s39, 155648
s_waitcnt vmcnt(4)
buffer_load_dwordx4 v224, s[20:23], s96 offen nt lds
v_mfma_f32_16x16x32_bf16 v[84:87], a[108:111], v[204:207], v[84:87]
v_mfma_f32_16x16x32_bf16 v[148:151], a[104:107], v[208:211], 0
v_mfma_f32_16x16x32_bf16 v[148:151], a[108:111], v[212:215], v[148:151]
v_mfma_f32_16x16x32_bf16 a[20:23], a[104:107], v[216:219], 0
v_mfma_f32_16x16x32_bf16 a[20:23], a[108:111], v[220:223], a[20:23]
s_waitcnt lgkmcnt(2)
v_mfma_f32_16x16x32_bf16 v[24:27], a[112:115], v[192:195], 0
s_waitcnt lgkmcnt(0)
s_barrier
ds_read_b128 a[96:99], v232 offset:16384
v_mfma_f32_16x16x32_bf16 v[24:27], a[116:119], v[196:199], v[24:27]
ds_read_b128 a[100:103], v233 offset:16384
v_mfma_f32_16x16x32_bf16 v[88:91], a[112:115], v[200:203], 0
v_mfma_f32_16x16x32_bf16 v[88:91], a[116:119], v[204:207], v[88:91]
v_mfma_f32_16x16x32_bf16 v[152:155], a[112:115], v[208:211], 0
s_xor_b32 s96, s43, 28928
s_add_u32 m0, s39, 159744
s_waitcnt vmcnt(4)
buffer_load_dwordx4 v224, s[20:23], s96 offen nt lds
v_mfma_f32_16x16x32_bf16 v[152:155], a[116:119], v[212:215], v[152:155]
v_mfma_f32_16x16x32_bf16 a[24:27], a[112:115], v[216:219], 0
v_mfma_f32_16x16x32_bf16 a[24:27], a[116:119], v[220:223], a[24:27]
v_mfma_f32_16x16x32_bf16 v[28:31], a[120:123], v[192:195], 0
ds_read_b128 a[104:107], v232 offset:18432
v_mfma_f32_16x16x32_bf16 v[28:31], a[124:127], v[196:199], v[28:31]
ds_read_b128 a[108:111], v233 offset:18432
v_mfma_f32_16x16x32_bf16 v[92:95], a[120:123], v[200:203], 0
v_mfma_f32_16x16x32_bf16 v[92:95], a[124:127], v[204:207], v[92:95]
v_mfma_f32_16x16x32_bf16 v[156:159], a[120:123], v[208:211], 0
v_mfma_f32_16x16x32_bf16 v[156:159], a[124:127], v[212:215], v[156:159]
v_mfma_f32_16x16x32_bf16 a[28:31], a[120:123], v[216:219], 0
s_xor_b32 s96, s43, 128
s_add_u32 m0, s39, 0
s_waitcnt vmcnt(4)
buffer_load_dwordx4 v224, s[24:27], s96 offen nt lds
v_mfma_f32_16x16x32_bf16 a[28:31], a[124:127], v[220:223], a[28:31]
s_waitcnt lgkmcnt(2)
v_mfma_f32_16x16x32_bf16 v[32:35], a[96:99], v[192:195], 0
ds_read_b128 a[112:115], v232 offset:20480
v_mfma_f32_16x16x32_bf16 v[32:35], a[100:103], v[196:199], v[32:35]
ds_read_b128 a[116:119], v233 offset:20480
v_mfma_f32_16x16x32_bf16 v[96:99], a[96:99], v[200:203], 0
v_mfma_f32_16x16x32_bf16 v[96:99], a[100:103], v[204:207], v[96:99]
v_mfma_f32_16x16x32_bf16 v[160:163], a[96:99], v[208:211], 0
v_mfma_f32_16x16x32_bf16 v[160:163], a[100:103], v[212:215], v[160:163]
v_mfma_f32_16x16x32_bf16 a[32:35], a[96:99], v[216:219], 0
v_mfma_f32_16x16x32_bf16 a[32:35], a[100:103], v[220:223], a[32:35]
s_waitcnt lgkmcnt(2)
v_mfma_f32_16x16x32_bf16 v[36:39], a[104:107], v[192:195], 0
ds_read_b128 a[120:123], v232 offset:22528
v_mfma_f32_16x16x32_bf16 v[36:39], a[108:111], v[196:199], v[36:39]
s_xor_b32 s96, s43, 8320
s_add_u32 m0, s39, 4096
s_waitcnt vmcnt(4)
buffer_load_dwordx4 v224, s[24:27], s96 offen nt lds
ds_read_b128 a[124:127], v233 offset:22528
v_mfma_f32_16x16x32_bf16 v[100:103], a[104:107], v[200:203], 0
v_mfma_f32_16x16x32_bf16 v[100:103], a[108:111], v[204:207], v[100:103]
v_mfma_f32_16x16x32_bf16 v[164:167], a[104:107], v[208:211], 0
v_mfma_f32_16x16x32_bf16 v[164:167], a[108:111], v[212:215], v[164:167]
v_mfma_f32_16x16x32_bf16 a[36:39], a[104:107], v[216:219], 0
v_mfma_f32_16x16x32_bf16 a[36:39], a[108:111], v[220:223], a[36:39]
s_waitcnt lgkmcnt(2)
v_mfma_f32_16x16x32_bf16 v[40:43], a[112:115], v[192:195], 0
s_waitcnt lgkmcnt(0)
s_barrier
ds_read_b128 a[96:99], v232 offset:24576
v_mfma_f32_16x16x32_bf16 v[40:43], a[116:119], v[196:199], v[40:43]
ds_read_b128 a[100:103], v233 offset:24576
v_mfma_f32_16x16x32_bf16 v[104:107], a[112:115], v[200:203], 0
v_mfma_f32_16x16x32_bf16 v[104:107], a[116:119], v[204:207], v[104:107]
s_xor_b32 s96, s43, 16512
s_add_u32 m0, s39, 8192
s_waitcnt vmcnt(4)
buffer_load_dwordx4 v224, s[24:27], s96 offen nt lds
v_mfma_f32_16x16x32_bf16 v[168:171], a[112:115], v[208:211], 0
v_mfma_f32_16x16x32_bf16 v[168:171], a[116:119], v[212:215], v[168:171]
v_mfma_f32_16x16x32_bf16 a[40:43], a[112:115], v[216:219], 0
v_mfma_f32_16x16x32_bf16 a[40:43], a[116:119], v[220:223], a[40:43]
v_mfma_f32_16x16x32_bf16 v[44:47], a[120:123], v[192:195], 0
ds_read_b128 a[104:107], v232 offset:26624
v_mfma_f32_16x16x32_bf16 v[44:47], a[124:127], v[196:199], v[44:47]
ds_read_b128 a[108:111], v233 offset:26624
v_mfma_f32_16x16x32_bf16 v[108:111], a[120:123], v[200:203], 0
v_mfma_f32_16x16x32_bf16 v[108:111], a[124:127], v[204:207], v[108:111]
v_mfma_f32_16x16x32_bf16 v[172:175], a[120:123], v[208:211], 0
v_mfma_f32_16x16x32_bf16 v[172:175], a[124:127], v[212:215], v[172:175]
s_xor_b32 s96, s43, 24704
s_add_u32 m0, s39, 12288
s_waitcnt vmcnt(4)
buffer_load_dwordx4 v224, s[24:27], s96 offen nt lds
v_mfma_f32_16x16x32_bf16 a[44:47], a[120:123], v[216:219], 0
v_mfma_f32_16x16x32_bf16 a[44:47], a[124:127], v[220:223], a[44:47]
s_waitcnt lgkmcnt(2)
v_mfma_f32_16x16x32_bf16 v[48:51], a[96:99], v[192:195], 0
ds_read_b128 a[112:115], v232 offset:28672
v_mfma_f32_16x16x32_bf16 v[48:51], a[100:103], v[196:199], v[48:51]
ds_read_b128 a[116:119], v233 offset:28672
v_mfma_f32_16x16x32_bf16 v[112:115], a[96:99], v[200:203], 0
v_mfma_f32_16x16x32_bf16 v[112:115], a[100:103], v[204:207], v[112:115]
v_mfma_f32_16x16x32_bf16 v[176:179], a[96:99], v[208:211], 0
v_mfma_f32_16x16x32_bf16 v[176:179], a[100:103], v[212:215], v[176:179]
v_mfma_f32_16x16x32_bf16 a[48:51], a[96:99], v[216:219], 0
v_mfma_f32_16x16x32_bf16 a[48:51], a[100:103], v[220:223], a[48:51]
s_xor_b32 s96, s43, 4224
s_add_u32 m0, s39, 16384
s_waitcnt vmcnt(4)
buffer_load_dwordx4 v224, s[24:27], s96 offen nt lds
s_waitcnt lgkmcnt(2)
v_mfma_f32_16x16x32_bf16 v[52:55], a[104:107], v[192:195], 0
ds_read_b128 a[120:123], v232 offset:30720
v_mfma_f32_16x16x32_bf16 v[52:55], a[108:111], v[196:199], v[52:55]
ds_read_b128 a[124:127], v233 offset:30720
v_mfma_f32_16x16x32_bf16 v[116:119], a[104:107], v[200:203], 0
v_mfma_f32_16x16x32_bf16 v[116:119], a[108:111], v[204:207], v[116:119]
v_mfma_f32_16x16x32_bf16 v[180:183], a[104:107], v[208:211], 0
v_mfma_f32_16x16x32_bf16 v[180:183], a[108:111], v[212:215], v[180:183]
v_mfma_f32_16x16x32_bf16 a[52:55], a[104:107], v[216:219], 0
v_mfma_f32_16x16x32_bf16 a[52:55], a[108:111], v[220:223], a[52:55]
s_waitcnt lgkmcnt(2)
v_mfma_f32_16x16x32_bf16 v[56:59], a[112:115], v[192:195], 0
s_waitcnt lgkmcnt(0)
s_barrier
v_add_u32 v232, 65536, v225
v_xor_b32 v233, 64, v232
ds_read_b128 a[96:99], v232 offset:0
v_mfma_f32_16x16x32_bf16 v[56:59], a[116:119], v[196:199], v[56:59]
ds_read_b128 a[100:103], v233 offset:0
v_mfma_f32_16x16x32_bf16 v[120:123], a[112:115], v[200:203], 0
s_xor_b32 s96, s43, 12416
s_add_u32 m0, s39, 20480
s_waitcnt vmcnt(4)
buffer_load_dwordx4 v224, s[24:27], s96 offen nt lds
v_mfma_f32_16x16x32_bf16 v[120:123], a[116:119], v[204:207], v[120:123]
v_mfma_f32_16x16x32_bf16 v[184:187], a[112:115], v[208:211], 0
v_mfma_f32_16x16x32_bf16 v[184:187], a[116:119], v[212:215], v[184:187]
v_mfma_f32_16x16x32_bf16 a[56:59], a[112:115], v[216:219], 0
v_mfma_f32_16x16x32_bf16 a[56:59], a[116:119], v[220:223], a[56:59]
v_mfma_f32_16x16x32_bf16 v[60:63], a[120:123], v[192:195], 0
ds_read_b128 a[104:107], v232 offset:2048
v_mfma_f32_16x16x32_bf16 v[60:63], a[124:127], v[196:199], v[60:63]
ds_read_b128 a[108:111], v233 offset:2048
v_mfma_f32_16x16x32_bf16 v[124:127], a[120:123], v[200:203], 0
v_mfma_f32_16x16x32_bf16 v[124:127], a[124:127], v[204:207], v[124:127]
v_mfma_f32_16x16x32_bf16 v[188:191], a[120:123], v[208:211], 0
s_xor_b32 s96, s43, 20608
s_add_u32 m0, s39, 24576
s_waitcnt vmcnt(4)
buffer_load_dwordx4 v224, s[24:27], s96 offen nt lds
v_mfma_f32_16x16x32_bf16 v[188:191], a[124:127], v[212:215], v[188:191]
v_mfma_f32_16x16x32_bf16 a[60:63], a[120:123], v[216:219], 0
v_mfma_f32_16x16x32_bf16 a[60:63], a[124:127], v[220:223], a[60:63]
s_waitcnt lgkmcnt(2)
v_mfma_f32_16x16x32_bf16 v[0:3], a[96:99], a[64:67], v[0:3]
v_add_u32 v236, 32768, v226
v_xor_b32 v237, 64, v236
ds_read_b128 v[192:195], v236 offset:0
ds_read_b128 v[196:199], v237 offset:0
ds_read_b128 v[200:203], v236 offset:8192
ds_read_b128 v[204:207], v237 offset:8192
ds_read_b128 v[208:211], v236 offset:16384
ds_read_b128 v[212:215], v237 offset:16384
ds_read_b128 v[216:219], v236 offset:24576
ds_read_b128 v[220:223], v237 offset:24576
ds_read_b128 a[112:115], v232 offset:4096
v_mfma_f32_16x16x32_bf16 v[0:3], a[100:103], a[68:71], v[0:3]
ds_read_b128 a[116:119], v233 offset:4096
v_mfma_f32_16x16x32_bf16 v[64:67], a[96:99], a[72:75], v[64:67]
v_mfma_f32_16x16x32_bf16 v[64:67], a[100:103], a[76:79], v[64:67]
v_mfma_f32_16x16x32_bf16 v[128:131], a[96:99], a[80:83], v[128:131]
v_mfma_f32_16x16x32_bf16 v[128:131], a[100:103], a[84:87], v[128:131]
v_mfma_f32_16x16x32_bf16 a[0:3], a[96:99], a[88:91], a[0:3]
s_xor_b32 s96, s43, 28800
s_add_u32 m0, s39, 28672
s_waitcnt vmcnt(4)
buffer_load_dwordx4 v224, s[24:27], s96 offen nt lds
v_mfma_f32_16x16x32_bf16 a[0:3], a[100:103], a[92:95], a[0:3]
s_waitcnt lgkmcnt(10)
v_mfma_f32_16x16x32_bf16 v[4:7], a[104:107], a[64:67], v[4:7]
ds_read_b128 a[120:123], v232 offset:6144
v_mfma_f32_16x16x32_bf16 v[4:7], a[108:111], a[68:71], v[4:7]
ds_read_b128 a[124:127], v233 offset:6144
v_mfma_f32_16x16x32_bf16 v[68:71], a[104:107], a[72:75], v[68:71]
v_mfma_f32_16x16x32_bf16 v[68:71], a[108:111], a[76:79], v[68:71]
v_mfma_f32_16x16x32_bf16 v[132:135], a[104:107], a[80:83], v[132:135]
v_mfma_f32_16x16x32_bf16 v[132:135], a[108:111], a[84:87], v[132:135]
v_mfma_f32_16x16x32_bf16 a[4:7], a[104:107], a[88:91], a[4:7]
v_mfma_f32_16x16x32_bf16 a[4:7], a[108:111], a[92:95], a[4:7]
s_waitcnt lgkmcnt(2)
v_mfma_f32_16x16x32_bf16 v[8:11], a[112:115], a[64:67], v[8:11]
s_xor_b32 s96, s41, 384
s_add_u32 m0, s39, 32768
s_waitcnt vmcnt(4)
buffer_load_dwordx4 v224, s[16:19], s96 offen nt lds
ds_read_b128 a[96:99], v232 offset:8192
v_mfma_f32_16x16x32_bf16 v[8:11], a[116:119], a[68:71], v[8:11]
ds_read_b128 a[100:103], v233 offset:8192
v_mfma_f32_16x16x32_bf16 v[72:75], a[112:115], a[72:75], v[72:75]
v_mfma_f32_16x16x32_bf16 v[72:75], a[116:119], a[76:79], v[72:75]
v_mfma_f32_16x16x32_bf16 v[136:139], a[112:115], a[80:83], v[136:139]
v_mfma_f32_16x16x32_bf16 v[136:139], a[116:119], a[84:87], v[136:139]
v_mfma_f32_16x16x32_bf16 a[8:11], a[112:115], a[88:91], a[8:11]
v_mfma_f32_16x16x32_bf16 a[8:11], a[116:119], a[92:95], a[8:11]
s_waitcnt lgkmcnt(2)
v_mfma_f32_16x16x32_bf16 v[12:15], a[120:123], a[64:67], v[12:15]
ds_read_b128 a[104:107], v232 offset:10240
v_mfma_f32_16x16x32_bf16 v[12:15], a[124:127], a[68:71], v[12:15]
ds_read_b128 a[108:111], v233 offset:10240
v_mfma_f32_16x16x32_bf16 v[76:79], a[120:123], a[72:75], v[76:79]
v_mfma_f32_16x16x32_bf16 v[76:79], a[124:127], a[76:79], v[76:79]
s_xor_b32 s96, s41, 8576
s_add_u32 m0, s39, 36864
s_waitcnt vmcnt(4)
buffer_load_dwordx4 v224, s[16:19], s96 offen nt lds
v_mfma_f32_16x16x32_bf16 v[140:143], a[120:123], a[80:83], v[140:143]
v_mfma_f32_16x16x32_bf16 v[140:143], a[124:127], a[84:87], v[140:143]
v_mfma_f32_16x16x32_bf16 a[12:15], a[120:123], a[88:91], a[12:15]
v_mfma_f32_16x16x32_bf16 a[12:15], a[124:127], a[92:95], a[12:15]
s_waitcnt lgkmcnt(2)
v_mfma_f32_16x16x32_bf16 v[16:19], a[96:99], a[64:67], v[16:19]
ds_read_b128 a[112:115], v232 offset:12288
v_mfma_f32_16x16x32_bf16 v[16:19], a[100:103], a[68:71], v[16:19]
ds_read_b128 a[116:119], v233 offset:12288
v_mfma_f32_16x16x32_bf16 v[80:83], a[96:99], a[72:75], v[80:83]
v_mfma_f32_16x16x32_bf16 v[80:83], a[100:103], a[76:79], v[80:83]
v_mfma_f32_16x16x32_bf16 v[144:147], a[96:99], a[80:83], v[144:147]
v_mfma_f32_16x16x32_bf16 v[144:147], a[100:103], a[84:87], v[144:147]
s_xor_b32 s96, s41, 16768
s_add_u32 m0, s39, 40960
s_waitcnt vmcnt(4)
buffer_load_dwordx4 v224, s[16:19], s96 offen nt lds
v_mfma_f32_16x16x32_bf16 a[16:19], a[96:99], a[88:91], a[16:19]
v_mfma_f32_16x16x32_bf16 a[16:19], a[100:103], a[92:95], a[16:19]
s_waitcnt lgkmcnt(2)
v_mfma_f32_16x16x32_bf16 v[20:23], a[104:107], a[64:67], v[20:23]
ds_read_b128 a[120:123], v232 offset:14336
v_mfma_f32_16x16x32_bf16 v[20:23], a[108:111], a[68:71], v[20:23]
ds_read_b128 a[124:127], v233 offset:14336
v_mfma_f32_16x16x32_bf16 v[84:87], a[104:107], a[72:75], v[84:87]
v_mfma_f32_16x16x32_bf16 v[84:87], a[108:111], a[76:79], v[84:87]
v_mfma_f32_16x16x32_bf16 v[148:151], a[104:107], a[80:83], v[148:151]
v_mfma_f32_16x16x32_bf16 v[148:151], a[108:111], a[84:87], v[148:151]
v_mfma_f32_16x16x32_bf16 a[20:23], a[104:107], a[88:91], a[20:23]
v_mfma_f32_16x16x32_bf16 a[20:23], a[108:111], a[92:95], a[20:23]
s_xor_b32 s96, s41, 24960
s_add_u32 m0, s39, 45056
s_waitcnt vmcnt(4)
buffer_load_dwordx4 v224, s[16:19], s96 offen nt lds
s_waitcnt lgkmcnt(2)
v_mfma_f32_16x16x32_bf16 v[24:27], a[112:115], a[64:67], v[24:27]
s_waitcnt lgkmcnt(0)
s_barrier
ds_read_b128 a[96:99], v232 offset:16384
v_mfma_f32_16x16x32_bf16 v[24:27], a[116:119], a[68:71], v[24:27]
ds_read_b128 a[100:103], v233 offset:16384
v_mfma_f32_16x16x32_bf16 v[88:91], a[112:115], a[72:75], v[88:91]
v_mfma_f32_16x16x32_bf16 v[88:91], a[116:119], a[76:79], v[88:91]
v_mfma_f32_16x16x32_bf16 v[152:155], a[112:115], a[80:83], v[152:155]
v_mfma_f32_16x16x32_bf16 v[152:155], a[116:119], a[84:87], v[152:155]
v_mfma_f32_16x16x32_bf16 a[24:27], a[112:115], a[88:91], a[24:27]
v_mfma_f32_16x16x32_bf16 a[24:27], a[116:119], a[92:95], a[24:27]
v_mfma_f32_16x16x32_bf16 v[28:31], a[120:123], a[64:67], v[28:31]
ds_read_b128 a[104:107], v232 offset:18432
v_mfma_f32_16x16x32_bf16 v[28:31], a[124:127], a[68:71], v[28:31]
s_xor_b32 s96, s41, 4480
s_add_u32 m0, s39, 49152
s_waitcnt vmcnt(4)
buffer_load_dwordx4 v224, s[16:19], s96 offen nt lds
ds_read_b128 a[108:111], v233 offset:18432
v_mfma_f32_16x16x32_bf16 v[92:95], a[120:123], a[72:75], v[92:95]
v_mfma_f32_16x16x32_bf16 v[92:95], a[124:127], a[76:79], v[92:95]
v_mfma_f32_16x16x32_bf16 v[156:159], a[120:123], a[80:83], v[156:159]
v_mfma_f32_16x16x32_bf16 v[156:159], a[124:127], a[84:87], v[156:159]
v_mfma_f32_16x16x32_bf16 a[28:31], a[120:123], a[88:91], a[28:31]
v_mfma_f32_16x16x32_bf16 a[28:31], a[124:127], a[92:95], a[28:31]
s_waitcnt lgkmcnt(2)
v_mfma_f32_16x16x32_bf16 v[32:35], a[96:99], a[64:67], v[32:35]
ds_read_b128 a[112:115], v232 offset:20480
v_mfma_f32_16x16x32_bf16 v[32:35], a[100:103], a[68:71], v[32:35]
ds_read_b128 a[116:119], v233 offset:20480
v_mfma_f32_16x16x32_bf16 v[96:99], a[96:99], a[72:75], v[96:99]
v_mfma_f32_16x16x32_bf16 v[96:99], a[100:103], a[76:79], v[96:99]
v_mfma_f32_16x16x32_bf16 v[160:163], a[96:99], a[80:83], v[160:163]
s_xor_b32 s96, s41, 12672
s_add_u32 m0, s39, 53248
s_waitcnt vmcnt(4)
buffer_load_dwordx4 v224, s[16:19], s96 offen nt lds
v_mfma_f32_16x16x32_bf16 v[160:163], a[100:103], a[84:87], v[160:163]
v_mfma_f32_16x16x32_bf16 a[32:35], a[96:99], a[88:91], a[32:35]
v_mfma_f32_16x16x32_bf16 a[32:35], a[100:103], a[92:95], a[32:35]
s_waitcnt lgkmcnt(2)
v_mfma_f32_16x16x32_bf16 v[36:39], a[104:107], a[64:67], v[36:39]
ds_read_b128 a[120:123], v232 offset:22528
v_mfma_f32_16x16x32_bf16 v[36:39], a[108:111], a[68:71], v[36:39]
ds_read_b128 a[124:127], v233 offset:22528
v_mfma_f32_16x16x32_bf16 v[100:103], a[104:107], a[72:75], v[100:103]
v_mfma_f32_16x16x32_bf16 v[100:103], a[108:111], a[76:79], v[100:103]
v_mfma_f32_16x16x32_bf16 v[164:167], a[104:107], a[80:83], v[164:167]
v_mfma_f32_16x16x32_bf16 v[164:167], a[108:111], a[84:87], v[164:167]
v_mfma_f32_16x16x32_bf16 a[36:39], a[104:107], a[88:91], a[36:39]
s_xor_b32 s96, s41, 20864
s_add_u32 m0, s39, 57344
s_waitcnt vmcnt(4)
buffer_load_dwordx4 v224, s[16:19], s96 offen nt lds
v_mfma_f32_16x16x32_bf16 a[36:39], a[108:111], a[92:95], a[36:39]
s_waitcnt lgkmcnt(2)
v_mfma_f32_16x16x32_bf16 v[40:43], a[112:115], a[64:67], v[40:43]
ds_read_b128 a[96:99], v232 offset:24576
v_mfma_f32_16x16x32_bf16 v[40:43], a[116:119], a[68:71], v[40:43]
ds_read_b128 a[100:103], v233 offset:24576
v_mfma_f32_16x16x32_bf16 v[104:107], a[112:115], a[72:75], v[104:107]
v_mfma_f32_16x16x32_bf16 v[104:107], a[116:119], a[76:79], v[104:107]
v_mfma_f32_16x16x32_bf16 v[168:171], a[112:115], a[80:83], v[168:171]
v_mfma_f32_16x16x32_bf16 v[168:171], a[116:119], a[84:87], v[168:171]
v_mfma_f32_16x16x32_bf16 a[40:43], a[112:115], a[88:91], a[40:43]
v_mfma_f32_16x16x32_bf16 a[40:43], a[116:119], a[92:95], a[40:43]
s_waitcnt lgkmcnt(2)
v_mfma_f32_16x16x32_bf16 v[44:47], a[120:123], a[64:67], v[44:47]
s_xor_b32 s96, s41, 29056
s_add_u32 m0, s39, 61440
s_waitcnt vmcnt(4)
buffer_load_dwordx4 v224, s[16:19], s96 offen nt lds
ds_read_b128 a[104:107], v232 offset:26624
v_mfma_f32_16x16x32_bf16 v[44:47], a[124:127], a[68:71], v[44:47]
ds_read_b128 a[108:111], v233 offset:26624
v_mfma_f32_16x16x32_bf16 v[108:111], a[120:123], a[72:75], v[108:111]
v_mfma_f32_16x16x32_bf16 v[108:111], a[124:127], a[76:79], v[108:111]
v_mfma_f32_16x16x32_bf16 v[172:175], a[120:123], a[80:83], v[172:175]
v_mfma_f32_16x16x32_bf16 v[172:175], a[124:127], a[84:87], v[172:175]
v_mfma_f32_16x16x32_bf16 a[44:47], a[120:123], a[88:91], a[44:47]
v_mfma_f32_16x16x32_bf16 a[44:47], a[124:127], a[92:95], a[44:47]
s_waitcnt lgkmcnt(2)
v_mfma_f32_16x16x32_bf16 v[48:51], a[96:99], a[64:67], v[48:51]
ds_read_b128 a[112:115], v232 offset:28672
v_mfma_f32_16x16x32_bf16 v[48:51], a[100:103], a[68:71], v[48:51]
ds_read_b128 a[116:119], v233 offset:28672
v_mfma_f32_16x16x32_bf16 v[112:115], a[96:99], a[72:75], v[112:115]
s_xor_b32 s96, s43, 384
s_add_u32 m0, s39, 65536
s_waitcnt vmcnt(4)
buffer_load_dwordx4 v224, s[20:23], s96 offen nt lds
v_mfma_f32_16x16x32_bf16 v[112:115], a[100:103], a[76:79], v[112:115]
v_mfma_f32_16x16x32_bf16 v[176:179], a[96:99], a[80:83], v[176:179]
v_mfma_f32_16x16x32_bf16 v[176:179], a[100:103], a[84:87], v[176:179]
v_mfma_f32_16x16x32_bf16 a[48:51], a[96:99], a[88:91], a[48:51]
v_mfma_f32_16x16x32_bf16 a[48:51], a[100:103], a[92:95], a[48:51]
s_waitcnt lgkmcnt(2)
v_mfma_f32_16x16x32_bf16 v[52:55], a[104:107], a[64:67], v[52:55]
ds_read_b128 a[120:123], v232 offset:30720
v_mfma_f32_16x16x32_bf16 v[52:55], a[108:111], a[68:71], v[52:55]
ds_read_b128 a[124:127], v233 offset:30720
v_mfma_f32_16x16x32_bf16 v[116:119], a[104:107], a[72:75], v[116:119]
v_mfma_f32_16x16x32_bf16 v[116:119], a[108:111], a[76:79], v[116:119]
v_mfma_f32_16x16x32_bf16 v[180:183], a[104:107], a[80:83], v[180:183]
v_mfma_f32_16x16x32_bf16 v[180:183], a[108:111], a[84:87], v[180:183]
s_xor_b32 s96, s43, 8576
s_add_u32 m0, s39, 69632
s_waitcnt vmcnt(4)
buffer_load_dwordx4 v224, s[20:23], s96 offen nt lds
v_mfma_f32_16x16x32_bf16 a[52:55], a[104:107], a[88:91], a[52:55]
v_mfma_f32_16x16x32_bf16 a[52:55], a[108:111], a[92:95], a[52:55]
s_waitcnt lgkmcnt(2)
v_mfma_f32_16x16x32_bf16 v[56:59], a[112:115], a[64:67], v[56:59]
s_waitcnt lgkmcnt(0)
s_barrier
v_add_u32 v232, 131072, v225
v_xor_b32 v233, 64, v232
ds_read_b128 a[96:99], v232 offset:0
v_mfma_f32_16x16x32_bf16 v[56:59], a[116:119], a[68:71], v[56:59]
ds_read_b128 a[100:103], v233 offset:0
v_mfma_f32_16x16x32_bf16 v[120:123], a[112:115], a[72:75], v[120:123]
v_mfma_f32_16x16x32_bf16 v[120:123], a[116:119], a[76:79], v[120:123]
v_mfma_f32_16x16x32_bf16 v[184:187], a[112:115], a[80:83], v[184:187]
v_mfma_f32_16x16x32_bf16 v[184:187], a[116:119], a[84:87], v[184:187]
v_mfma_f32_16x16x32_bf16 a[56:59], a[112:115], a[88:91], a[56:59]
v_mfma_f32_16x16x32_bf16 a[56:59], a[116:119], a[92:95], a[56:59]
s_xor_b32 s96, s43, 16768
s_add_u32 m0, s39, 73728
s_waitcnt vmcnt(4)
buffer_load_dwordx4 v224, s[20:23], s96 offen nt lds
v_mfma_f32_16x16x32_bf16 v[60:63], a[120:123], a[64:67], v[60:63]
ds_read_b128 a[104:107], v232 offset:2048
v_mfma_f32_16x16x32_bf16 v[60:63], a[124:127], a[68:71], v[60:63]
ds_read_b128 a[108:111], v233 offset:2048
v_mfma_f32_16x16x32_bf16 v[124:127], a[120:123], a[72:75], v[124:127]
v_mfma_f32_16x16x32_bf16 v[124:127], a[124:127], a[76:79], v[124:127]
v_mfma_f32_16x16x32_bf16 v[188:191], a[120:123], a[80:83], v[188:191]
v_mfma_f32_16x16x32_bf16 v[188:191], a[124:127], a[84:87], v[188:191]
v_mfma_f32_16x16x32_bf16 a[60:63], a[120:123], a[88:91], a[60:63]
v_mfma_f32_16x16x32_bf16 a[60:63], a[124:127], a[92:95], a[60:63]
s_waitcnt lgkmcnt(2)
v_mfma_f32_16x16x32_bf16 v[0:3], a[96:99], v[192:195], v[0:3]
ds_read_b128 a[112:115], v232 offset:4096
v_mfma_f32_16x16x32_bf16 v[0:3], a[100:103], v[196:199], v[0:3]
s_xor_b32 s96, s43, 24960
s_add_u32 m0, s39, 77824
s_waitcnt vmcnt(4)
buffer_load_dwordx4 v224, s[20:23], s96 offen nt lds
ds_read_b128 a[116:119], v233 offset:4096
v_mfma_f32_16x16x32_bf16 v[64:67], a[96:99], v[200:203], v[64:67]
v_mfma_f32_16x16x32_bf16 v[64:67], a[100:103], v[204:207], v[64:67]
v_mfma_f32_16x16x32_bf16 v[128:131], a[96:99], v[208:211], v[128:131]
v_mfma_f32_16x16x32_bf16 v[128:131], a[100:103], v[212:215], v[128:131]
v_mfma_f32_16x16x32_bf16 a[0:3], a[96:99], v[216:219], a[0:3]
v_mfma_f32_16x16x32_bf16 a[0:3], a[100:103], v[220:223], a[0:3]
s_waitcnt lgkmcnt(2)
v_mfma_f32_16x16x32_bf16 v[4:7], a[104:107], v[192:195], v[4:7]
ds_read_b128 a[120:123], v232 offset:6144
v_mfma_f32_16x16x32_bf16 v[4:7], a[108:111], v[196:199], v[4:7]
ds_read_b128 a[124:127], v233 offset:6144
v_mfma_f32_16x16x32_bf16 v[68:71], a[104:107], v[200:203], v[68:71]
v_mfma_f32_16x16x32_bf16 v[68:71], a[108:111], v[204:207], v[68:71]
s_xor_b32 s96, s43, 4480
s_add_u32 m0, s39, 81920
s_waitcnt vmcnt(4)
buffer_load_dwordx4 v224, s[20:23], s96 offen nt lds
v_mfma_f32_16x16x32_bf16 v[132:135], a[104:107], v[208:211], v[132:135]
v_add_u32 v236, 32768, v226
v_xor_b32 v237, 64, v236
ds_read_b128 a[64:67], v236 offset:0
ds_read_b128 a[68:71], v237 offset:0
ds_read_b128 a[72:75], v236 offset:8192
ds_read_b128 a[76:79], v237 offset:8192
ds_read_b128 a[80:83], v236 offset:16384
ds_read_b128 a[84:87], v237 offset:16384
ds_read_b128 a[88:91], v236 offset:24576
ds_read_b128 a[92:95], v237 offset:24576
v_mfma_f32_16x16x32_bf16 v[132:135], a[108:111], v[212:215], v[132:135]
v_mfma_f32_16x16x32_bf16 a[4:7], a[104:107], v[216:219], a[4:7]
v_mfma_f32_16x16x32_bf16 a[4:7], a[108:111], v[220:223], a[4:7]
s_waitcnt lgkmcnt(10)
v_mfma_f32_16x16x32_bf16 v[8:11], a[112:115], v[192:195], v[8:11]
ds_read_b128 a[96:99], v232 offset:8192
v_mfma_f32_16x16x32_bf16 v[8:11], a[116:119], v[196:199], v[8:11]
ds_read_b128 a[100:103], v233 offset:8192
v_mfma_f32_16x16x32_bf16 v[72:75], a[112:115], v[200:203], v[72:75]
v_mfma_f32_16x16x32_bf16 v[72:75], a[116:119], v[204:207], v[72:75]
v_mfma_f32_16x16x32_bf16 v[136:139], a[112:115], v[208:211], v[136:139]
v_mfma_f32_16x16x32_bf16 v[136:139], a[116:119], v[212:215], v[136:139]
v_mfma_f32_16x16x32_bf16 a[8:11], a[112:115], v[216:219], a[8:11]
s_xor_b32 s96, s43, 12672
s_add_u32 m0, s39, 86016
s_waitcnt vmcnt(4)
buffer_load_dwordx4 v224, s[20:23], s96 offen nt lds
v_mfma_f32_16x16x32_bf16 a[8:11], a[116:119], v[220:223], a[8:11]
s_waitcnt lgkmcnt(10)
v_mfma_f32_16x16x32_bf16 v[12:15], a[120:123], v[192:195], v[12:15]
ds_read_b128 a[104:107], v232 offset:10240
v_mfma_f32_16x16x32_bf16 v[12:15], a[124:127], v[196:199], v[12:15]
ds_read_b128 a[108:111], v233 offset:10240
v_mfma_f32_16x16x32_bf16 v[76:79], a[120:123], v[200:203], v[76:79]
v_mfma_f32_16x16x32_bf16 v[76:79], a[124:127], v[204:207], v[76:79]
v_mfma_f32_16x16x32_bf16 v[140:143], a[120:123], v[208:211], v[140:143]
v_mfma_f32_16x16x32_bf16 v[140:143], a[124:127], v[212:215], v[140:143]
v_mfma_f32_16x16x32_bf16 a[12:15], a[120:123], v[216:219], a[12:15]
v_mfma_f32_16x16x32_bf16 a[12:15], a[124:127], v[220:223], a[12:15]
s_waitcnt lgkmcnt(2)
v_mfma_f32_16x16x32_bf16 v[16:19], a[96:99], v[192:195], v[16:19]
s_xor_b32 s96, s43, 20864
s_add_u32 m0, s39, 90112
s_waitcnt vmcnt(4)
buffer_load_dwordx4 v224, s[20:23], s96 offen nt lds
ds_read_b128 a[112:115], v232 offset:12288
v_mfma_f32_16x16x32_bf16 v[16:19], a[100:103], v[196:199], v[16:19]
ds_read_b128 a[116:119], v233 offset:12288
v_mfma_f32_16x16x32_bf16 v[80:83], a[96:99], v[200:203], v[80:83]
v_mfma_f32_16x16x32_bf16 v[80:83], a[100:103], v[204:207], v[80:83]
v_mfma_f32_16x16x32_bf16 v[144:147], a[96:99], v[208:211], v[144:147]
v_mfma_f32_16x16x32_bf16 v[144:147], a[100:103], v[212:215], v[144:147]
v_mfma_f32_16x16x32_bf16 a[16:19], a[96:99], v[216:219], a[16:19]
v_mfma_f32_16x16x32_bf16 a[16:19], a[100:103], v[220:223], a[16:19]
s_waitcnt lgkmcnt(2)
v_mfma_f32_16x16x32_bf16 v[20:23], a[104:107], v[192:195], v[20:23]
ds_read_b128 a[120:123], v232 offset:14336
v_mfma_f32_16x16x32_bf16 v[20:23], a[108:111], v[196:199], v[20:23]
ds_read_b128 a[124:127], v233 offset:14336
v_mfma_f32_16x16x32_bf16 v[84:87], a[104:107], v[200:203], v[84:87]
s_xor_b32 s96, s43, 29056
s_add_u32 m0, s39, 94208
s_waitcnt vmcnt(4)
buffer_load_dwordx4 v224, s[20:23], s96 offen nt lds
v_mfma_f32_16x16x32_bf16 v[84:87], a[108:111], v[204:207], v[84:87]
v_mfma_f32_16x16x32_bf16 v[148:151], a[104:107], v[208:211], v[148:151]
v_mfma_f32_16x16x32_bf16 v[148:151], a[108:111], v[212:215], v[148:151]
v_mfma_f32_16x16x32_bf16 a[20:23], a[104:107], v[216:219], a[20:23]
v_mfma_f32_16x16x32_bf16 a[20:23], a[108:111], v[220:223], a[20:23]
s_waitcnt lgkmcnt(2)
v_mfma_f32_16x16x32_bf16 v[24:27], a[112:115], v[192:195], v[24:27]
ds_read_b128 a[96:99], v232 offset:16384
v_mfma_f32_16x16x32_bf16 v[24:27], a[116:119], v[196:199], v[24:27]
ds_read_b128 a[100:103], v233 offset:16384
v_mfma_f32_16x16x32_bf16 v[88:91], a[112:115], v[200:203], v[88:91]
v_mfma_f32_16x16x32_bf16 v[88:91], a[116:119], v[204:207], v[88:91]
v_mfma_f32_16x16x32_bf16 v[152:155], a[112:115], v[208:211], v[152:155]
s_xor_b32 s96, s43, 256
s_add_u32 m0, s39, 32768
s_waitcnt vmcnt(4)
buffer_load_dwordx4 v224, s[24:27], s96 offen nt lds
v_mfma_f32_16x16x32_bf16 v[152:155], a[116:119], v[212:215], v[152:155]
v_mfma_f32_16x16x32_bf16 a[24:27], a[112:115], v[216:219], a[24:27]
v_mfma_f32_16x16x32_bf16 a[24:27], a[116:119], v[220:223], a[24:27]
s_waitcnt lgkmcnt(2)
v_mfma_f32_16x16x32_bf16 v[28:31], a[120:123], v[192:195], v[28:31]
ds_read_b128 a[104:107], v232 offset:18432
v_mfma_f32_16x16x32_bf16 v[28:31], a[124:127], v[196:199], v[28:31]
ds_read_b128 a[108:111], v233 offset:18432
v_mfma_f32_16x16x32_bf16 v[92:95], a[120:123], v[200:203], v[92:95]
v_mfma_f32_16x16x32_bf16 v[92:95], a[124:127], v[204:207], v[92:95]
v_mfma_f32_16x16x32_bf16 v[156:159], a[120:123], v[208:211], v[156:159]
v_mfma_f32_16x16x32_bf16 v[156:159], a[124:127], v[212:215], v[156:159]
v_mfma_f32_16x16x32_bf16 a[28:31], a[120:123], v[216:219], a[28:31]
v_mfma_f32_16x16x32_bf16 a[28:31], a[124:127], v[220:223], a[28:31]
s_xor_b32 s96, s43, 8448
s_add_u32 m0, s39, 36864
s_waitcnt vmcnt(4)
buffer_load_dwordx4 v224, s[24:27], s96 offen nt lds
s_waitcnt lgkmcnt(2)
v_mfma_f32_16x16x32_bf16 v[32:35], a[96:99], v[192:195], v[32:35]
ds_read_b128 a[112:115], v232 offset:20480
v_mfma_f32_16x16x32_bf16 v[32:35], a[100:103], v[196:199], v[32:35]
ds_read_b128 a[116:119], v233 offset:20480
v_mfma_f32_16x16x32_bf16 v[96:99], a[96:99], v[200:203], v[96:99]
v_mfma_f32_16x16x32_bf16 v[96:99], a[100:103], v[204:207], v[96:99]
v_mfma_f32_16x16x32_bf16 v[160:163], a[96:99], v[208:211], v[160:163]
v_mfma_f32_16x16x32_bf16 v[160:163], a[100:103], v[212:215], v[160:163]
v_mfma_f32_16x16x32_bf16 a[32:35], a[96:99], v[216:219], a[32:35]
v_mfma_f32_16x16x32_bf16 a[32:35], a[100:103], v[220:223], a[32:35]
s_waitcnt lgkmcnt(2)
v_mfma_f32_16x16x32_bf16 v[36:39], a[104:107], v[192:195], v[36:39]
ds_read_b128 a[120:123], v232 offset:22528
v_mfma_f32_16x16x32_bf16 v[36:39], a[108:111], v[196:199], v[36:39]
s_xor_b32 s96, s43, 16640
s_add_u32 m0, s39, 40960
s_waitcnt vmcnt(4)
buffer_load_dwordx4 v224, s[24:27], s96 offen nt lds
ds_read_b128 a[124:127], v233 offset:22528
v_mfma_f32_16x16x32_bf16 v[100:103], a[104:107], v[200:203], v[100:103]
v_mfma_f32_16x16x32_bf16 v[100:103], a[108:111], v[204:207], v[100:103]
v_mfma_f32_16x16x32_bf16 v[164:167], a[104:107], v[208:211], v[164:167]
v_mfma_f32_16x16x32_bf16 v[164:167], a[108:111], v[212:215], v[164:167]
v_mfma_f32_16x16x32_bf16 a[36:39], a[104:107], v[216:219], a[36:39]
v_mfma_f32_16x16x32_bf16 a[36:39], a[108:111], v[220:223], a[36:39]
s_waitcnt lgkmcnt(2)
v_mfma_f32_16x16x32_bf16 v[40:43], a[112:115], v[192:195], v[40:43]
ds_read_b128 a[96:99], v232 offset:24576
v_mfma_f32_16x16x32_bf16 v[40:43], a[116:119], v[196:199], v[40:43]
ds_read_b128 a[100:103], v233 offset:24576
v_mfma_f32_16x16x32_bf16 v[104:107], a[112:115], v[200:203], v[104:107]
v_mfma_f32_16x16x32_bf16 v[104:107], a[116:119], v[204:207], v[104:107]
s_xor_b32 s96, s43, 24832
s_add_u32 m0, s39, 45056
s_waitcnt vmcnt(4)
buffer_load_dwordx4 v224, s[24:27], s96 offen nt lds
v_mfma_f32_16x16x32_bf16 v[168:171], a[112:115], v[208:211], v[168:171]
v_mfma_f32_16x16x32_bf16 v[168:171], a[116:119], v[212:215], v[168:171]
v_mfma_f32_16x16x32_bf16 a[40:43], a[112:115], v[216:219], a[40:43]
v_mfma_f32_16x16x32_bf16 a[40:43], a[116:119], v[220:223], a[40:43]
s_waitcnt lgkmcnt(2)
v_mfma_f32_16x16x32_bf16 v[44:47], a[120:123], v[192:195], v[44:47]
ds_read_b128 a[104:107], v232 offset:26624
v_mfma_f32_16x16x32_bf16 v[44:47], a[124:127], v[196:199], v[44:47]
ds_read_b128 a[108:111], v233 offset:26624
v_mfma_f32_16x16x32_bf16 v[108:111], a[120:123], v[200:203], v[108:111]
v_mfma_f32_16x16x32_bf16 v[108:111], a[124:127], v[204:207], v[108:111]
v_mfma_f32_16x16x32_bf16 v[172:175], a[120:123], v[208:211], v[172:175]
v_mfma_f32_16x16x32_bf16 v[172:175], a[124:127], v[212:215], v[172:175]
s_xor_b32 s96, s43, 4352
s_add_u32 m0, s39, 49152
s_waitcnt vmcnt(4)
buffer_load_dwordx4 v224, s[24:27], s96 offen nt lds
v_mfma_f32_16x16x32_bf16 a[44:47], a[120:123], v[216:219], a[44:47]
v_mfma_f32_16x16x32_bf16 a[44:47], a[124:127], v[220:223], a[44:47]
s_waitcnt lgkmcnt(2)
v_mfma_f32_16x16x32_bf16 v[48:51], a[96:99], v[192:195], v[48:51]
ds_read_b128 a[112:115], v232 offset:28672
v_mfma_f32_16x16x32_bf16 v[48:51], a[100:103], v[196:199], v[48:51]
ds_read_b128 a[116:119], v233 offset:28672
v_mfma_f32_16x16x32_bf16 v[112:115], a[96:99], v[200:203], v[112:115]
v_mfma_f32_16x16x32_bf16 v[112:115], a[100:103], v[204:207], v[112:115]
v_mfma_f32_16x16x32_bf16 v[176:179], a[96:99], v[208:211], v[176:179]
v_mfma_f32_16x16x32_bf16 v[176:179], a[100:103], v[212:215], v[176:179]
v_mfma_f32_16x16x32_bf16 a[48:51], a[96:99], v[216:219], a[48:51]
v_mfma_f32_16x16x32_bf16 a[48:51], a[100:103], v[220:223], a[48:51]
s_waitcnt lgkmcnt(2)
v_mfma_f32_16x16x32_bf16 v[52:55], a[104:107], v[192:195], v[52:55]
s_xor_b32 s96, s43, 12544
s_add_u32 m0, s39, 53248
s_waitcnt vmcnt(4)
buffer_load_dwordx4 v224, s[24:27], s96 offen nt lds
ds_read_b128 a[120:123], v232 offset:30720
v_mfma_f32_16x16x32_bf16 v[52:55], a[108:111], v[196:199], v[52:55]
ds_read_b128 a[124:127], v233 offset:30720
v_mfma_f32_16x16x32_bf16 v[116:119], a[104:107], v[200:203], v[116:119]
v_mfma_f32_16x16x32_bf16 v[116:119], a[108:111], v[204:207], v[116:119]
v_mfma_f32_16x16x32_bf16 v[180:183], a[104:107], v[208:211], v[180:183]
v_mfma_f32_16x16x32_bf16 v[180:183], a[108:111], v[212:215], v[180:183]
v_mfma_f32_16x16x32_bf16 a[52:55], a[104:107], v[216:219], a[52:55]
v_mfma_f32_16x16x32_bf16 a[52:55], a[108:111], v[220:223], a[52:55]
s_waitcnt lgkmcnt(2)
v_mfma_f32_16x16x32_bf16 v[56:59], a[112:115], v[192:195], v[56:59]
s_waitcnt lgkmcnt(0)
s_barrier
v_add_u32 v232, 65536, v225
v_xor_b32 v233, 64, v232
ds_read_b128 a[96:99], v232 offset:0
v_mfma_f32_16x16x32_bf16 v[56:59], a[116:119], v[196:199], v[56:59]
ds_read_b128 a[100:103], v233 offset:0
v_mfma_f32_16x16x32_bf16 v[120:123], a[112:115], v[200:203], v[120:123]
s_xor_b32 s96, s43, 20736
s_add_u32 m0, s39, 57344
s_waitcnt vmcnt(4)
buffer_load_dwordx4 v224, s[24:27], s96 offen nt lds
v_mfma_f32_16x16x32_bf16 v[120:123], a[116:119], v[204:207], v[120:123]
v_mfma_f32_16x16x32_bf16 v[184:187], a[112:115], v[208:211], v[184:187]
v_mfma_f32_16x16x32_bf16 v[184:187], a[116:119], v[212:215], v[184:187]
v_mfma_f32_16x16x32_bf16 a[56:59], a[112:115], v[216:219], a[56:59]
v_mfma_f32_16x16x32_bf16 a[56:59], a[116:119], v[220:223], a[56:59]
v_mfma_f32_16x16x32_bf16 v[60:63], a[120:123], v[192:195], v[60:63]
ds_read_b128 a[104:107], v232 offset:2048
v_mfma_f32_16x16x32_bf16 v[60:63], a[124:127], v[196:199], v[60:63]
ds_read_b128 a[108:111], v233 offset:2048
v_mfma_f32_16x16x32_bf16 v[124:127], a[120:123], v[200:203], v[124:127]
v_mfma_f32_16x16x32_bf16 v[124:127], a[124:127], v[204:207], v[124:127]
v_mfma_f32_16x16x32_bf16 v[188:191], a[120:123], v[208:211], v[188:191]
s_xor_b32 s96, s43, 28928
s_add_u32 m0, s39, 61440
s_waitcnt vmcnt(4)
buffer_load_dwordx4 v224, s[24:27], s96 offen nt lds
v_mfma_f32_16x16x32_bf16 v[188:191], a[124:127], v[212:215], v[188:191]
v_mfma_f32_16x16x32_bf16 a[60:63], a[120:123], v[216:219], a[60:63]
v_mfma_f32_16x16x32_bf16 a[60:63], a[124:127], v[220:223], a[60:63]
s_waitcnt lgkmcnt(2)
v_mfma_f32_16x16x32_bf16 v[0:3], a[96:99], a[64:67], v[0:3]
ds_read_b128 a[112:115], v232 offset:4096
v_mfma_f32_16x16x32_bf16 v[0:3], a[100:103], a[68:71], v[0:3]
ds_read_b128 a[116:119], v233 offset:4096
v_mfma_f32_16x16x32_bf16 v[64:67], a[96:99], a[72:75], v[64:67]
v_mfma_f32_16x16x32_bf16 v[64:67], a[100:103], a[76:79], v[64:67]
s_xor_b32 s96, s43, 384
s_add_u32 m0, s39, 131072
s_waitcnt vmcnt(4)
buffer_load_dwordx4 v224, s[24:27], s96 offen nt lds
v_mfma_f32_16x16x32_bf16 v[128:131], a[96:99], a[80:83], v[128:131]
v_mfma_f32_16x16x32_bf16 v[128:131], a[100:103], a[84:87], v[128:131]
v_mfma_f32_16x16x32_bf16 a[0:3], a[96:99], a[88:91], a[0:3]
v_mfma_f32_16x16x32_bf16 a[0:3], a[100:103], a[92:95], a[0:3]
s_waitcnt lgkmcnt(2)
v_mfma_f32_16x16x32_bf16 v[4:7], a[104:107], a[64:67], v[4:7]
ds_read_b128 a[120:123], v232 offset:6144
v_mfma_f32_16x16x32_bf16 v[4:7], a[108:111], a[68:71], v[4:7]
ds_read_b128 a[124:127], v233 offset:6144
v_max_f32 v231, v0, v1
v_mfma_f32_16x16x32_bf16 v[68:71], a[104:107], a[72:75], v[68:71]
s_xor_b32 s96, s43, 8576
s_add_u32 m0, s39, 135168
s_waitcnt vmcnt(4)
buffer_load_dwordx4 v224, s[24:27], s96 offen nt lds
v_max3_f32 v231, v231, v2, v3
v_mfma_f32_16x16x32_bf16 v[68:71], a[108:111], a[76:79], v[68:71]
v_max_f32 v243, v64, v65
v_mfma_f32_16x16x32_bf16 v[132:135], a[104:107], a[80:83], v[132:135]
v_max3_f32 v243, v243, v66, v67
v_mfma_f32_16x16x32_bf16 v[132:135], a[108:111], a[84:87], v[132:135]
v_max_f32 v242, v128, v129
v_mfma_f32_16x16x32_bf16 a[4:7], a[104:107], a[88:91], a[4:7]
v_max3_f32 v242, v242, v130, v131
v_mfma_f32_16x16x32_bf16 a[4:7], a[108:111], a[92:95], a[4:7]
s_waitcnt lgkmcnt(2)
v_accvgpr_read_b32 v192, a0
v_accvgpr_read_b32 v193, a1
v_mfma_f32_16x16x32_bf16 v[8:11], a[112:115], a[64:67], v[8:11]
ds_read_b128 a[96:99], v232 offset:8192
v_mfma_f32_16x16x32_bf16 v[8:11], a[116:119], a[68:71], v[8:11]
s_xor_b32 s96, s43, 16768
s_add_u32 m0, s39, 139264
s_waitcnt vmcnt(4)
buffer_load_dwordx4 v224, s[24:27], s96 offen nt lds
ds_read_b128 a[100:103], v233 offset:8192
v_max3_f32 v231, v231, v4, v5
v_mfma_f32_16x16x32_bf16 v[72:75], a[112:115], a[72:75], v[72:75]
v_accvgpr_read_b32 v194, a2
v_max3_f32 v231, v231, v6, v7
v_mfma_f32_16x16x32_bf16 v[72:75], a[116:119], a[76:79], v[72:75]
v_accvgpr_read_b32 v195, a3
v_max3_f32 v243, v243, v68, v69
v_mfma_f32_16x16x32_bf16 v[136:139], a[112:115], a[80:83], v[136:139]
v_max_f32 v237, v192, v193
v_max3_f32 v243, v243, v70, v71
v_mfma_f32_16x16x32_bf16 v[136:139], a[116:119], a[84:87], v[136:139]
v_max3_f32 v237, v237, v194, v195
v_max3_f32 v242, v242, v132, v133
v_mfma_f32_16x16x32_bf16 a[8:11], a[112:115], a[88:91], a[8:11]
v_max3_f32 v242, v242, v134, v135
v_mfma_f32_16x16x32_bf16 a[8:11], a[116:119], a[92:95], a[8:11]
s_waitcnt lgkmcnt(2)
v_accvgpr_read_b32 v196, a4
v_accvgpr_read_b32 v197, a5
v_mfma_f32_16x16x32_bf16 v[12:15], a[120:123], a[64:67], v[12:15]
s_xor_b32 s96, s43, 24960
s_add_u32 m0, s39, 143360
s_waitcnt vmcnt(4)
buffer_load_dwordx4 v224, s[24:27], s96 offen nt lds
ds_read_b128 a[104:107], v232 offset:10240
v_mfma_f32_16x16x32_bf16 v[12:15], a[124:127], a[68:71], v[12:15]
ds_read_b128 a[108:111], v233 offset:10240
v_max3_f32 v231, v231, v8, v9
v_mfma_f32_16x16x32_bf16 v[76:79], a[120:123], a[72:75], v[76:79]
v_accvgpr_read_b32 v198, a6
v_max3_f32 v231, v231, v10, v11
v_mfma_f32_16x16x32_bf16 v[76:79], a[124:127], a[76:79], v[76:79]
v_accvgpr_read_b32 v199, a7
v_max3_f32 v243, v243, v72, v73
v_mfma_f32_16x16x32_bf16 v[140:143], a[120:123], a[80:83], v[140:143]
v_max3_f32 v237, v237, v196, v197
v_max3_f32 v243, v243, v74, v75
v_mfma_f32_16x16x32_bf16 v[140:143], a[124:127], a[84:87], v[140:143]
v_max3_f32 v237, v237, v198, v199
v_max3_f32 v242, v242, v136, v137
v_mfma_f32_16x16x32_bf16 a[12:15], a[120:123], a[88:91], a[12:15]
v_max3_f32 v242, v242, v138, v139
v_mfma_f32_16x16x32_bf16 a[12:15], a[124:127], a[92:95], a[12:15]
s_xor_b32 s96, s43, 4480
s_add_u32 m0, s39, 147456
s_waitcnt vmcnt(4)
buffer_load_dwordx4 v224, s[24:27], s96 offen nt lds
s_waitcnt lgkmcnt(2)
v_accvgpr_read_b32 v200, a8
v_accvgpr_read_b32 v201, a9
v_mfma_f32_16x16x32_bf16 v[16:19], a[96:99], a[64:67], v[16:19]
ds_read_b128 a[112:115], v232 offset:12288
v_mfma_f32_16x16x32_bf16 v[16:19], a[100:103], a[68:71], v[16:19]
ds_read_b128 a[116:119], v233 offset:12288
v_max3_f32 v231, v231, v12, v13
v_mfma_f32_16x16x32_bf16 v[80:83], a[96:99], a[72:75], v[80:83]
v_accvgpr_read_b32 v202, a10
v_max3_f32 v231, v231, v14, v15
v_mfma_f32_16x16x32_bf16 v[80:83], a[100:103], a[76:79], v[80:83]
v_accvgpr_read_b32 v203, a11
v_max3_f32 v243, v243, v76, v77
v_mfma_f32_16x16x32_bf16 v[144:147], a[96:99], a[80:83], v[144:147]
v_max3_f32 v237, v237, v200, v201
v_max3_f32 v243, v243, v78, v79
v_mfma_f32_16x16x32_bf16 v[144:147], a[100:103], a[84:87], v[144:147]
v_max3_f32 v237, v237, v202, v203
v_max3_f32 v242, v242, v140, v141
v_mfma_f32_16x16x32_bf16 a[16:19], a[96:99], a[88:91], a[16:19]
s_xor_b32 s96, s43, 12672
s_add_u32 m0, s39, 151552
s_waitcnt vmcnt(4)
buffer_load_dwordx4 v224, s[24:27], s96 offen nt lds
v_max3_f32 v242, v242, v142, v143
v_mfma_f32_16x16x32_bf16 a[16:19], a[100:103], a[92:95], a[16:19]
s_waitcnt lgkmcnt(2)
v_accvgpr_read_b32 v204, a12
v_accvgpr_read_b32 v205, a13
v_mfma_f32_16x16x32_bf16 v[20:23], a[104:107], a[64:67], v[20:23]
ds_read_b128 a[120:123], v232 offset:14336
v_mfma_f32_16x16x32_bf16 v[20:23], a[108:111], a[68:71], v[20:23]
ds_read_b128 a[124:127], v233 offset:14336
v_max3_f32 v231, v231, v16, v17
v_mfma_f32_16x16x32_bf16 v[84:87], a[104:107], a[72:75], v[84:87]
v_accvgpr_read_b32 v206, a14
v_max3_f32 v231, v231, v18, v19
v_mfma_f32_16x16x32_bf16 v[84:87], a[108:111], a[76:79], v[84:87]
v_accvgpr_read_b32 v207, a15
v_max3_f32 v243, v243, v80, v81
v_mfma_f32_16x16x32_bf16 v[148:151], a[104:107], a[80:83], v[148:151]
v_max3_f32 v237, v237, v204, v205
v_max3_f32 v243, v243, v82, v83
v_mfma_f32_16x16x32_bf16 v[148:151], a[108:111], a[84:87], v[148:151]
s_xor_b32 s96, s43, 20864
s_add_u32 m0, s39, 155648
s_waitcnt vmcnt(4)
buffer_load_dwordx4 v224, s[24:27], s96 offen nt lds
v_max3_f32 v237, v237, v206, v207
v_max3_f32 v242, v242, v144, v145
v_mfma_f32_16x16x32_bf16 a[20:23], a[104:107], a[88:91], a[20:23]
v_max3_f32 v242, v242, v146, v147
v_mfma_f32_16x16x32_bf16 a[20:23], a[108:111], a[92:95], a[20:23]
s_waitcnt lgkmcnt(2)
v_accvgpr_read_b32 v208, a16
v_accvgpr_read_b32 v209, a17
v_mfma_f32_16x16x32_bf16 v[24:27], a[112:115], a[64:67], v[24:27]
ds_read_b128 a[96:99], v232 offset:16384
v_mfma_f32_16x16x32_bf16 v[24:27], a[116:119], a[68:71], v[24:27]
ds_read_b128 a[100:103], v233 offset:16384
v_max3_f32 v231, v231, v20, v21
v_mfma_f32_16x16x32_bf16 v[88:91], a[112:115], a[72:75], v[88:91]
v_accvgpr_read_b32 v210, a18
v_max3_f32 v231, v231, v22, v23
v_mfma_f32_16x16x32_bf16 v[88:91], a[116:119], a[76:79], v[88:91]
v_accvgpr_read_b32 v211, a19
v_max3_f32 v243, v243, v84, v85
v_mfma_f32_16x16x32_bf16 v[152:155], a[112:115], a[80:83], v[152:155]
s_xor_b32 s96, s43, 29056
s_add_u32 m0, s39, 159744
s_waitcnt vmcnt(4)
buffer_load_dwordx4 v224, s[24:27], s96 offen nt lds
v_max3_f32 v237, v237, v208, v209
v_max3_f32 v243, v243, v86, v87
v_mfma_f32_16x16x32_bf16 v[152:155], a[116:119], a[84:87], v[152:155]
v_max3_f32 v237, v237, v210, v211
v_max3_f32 v242, v242, v148, v149
v_mfma_f32_16x16x32_bf16 a[24:27], a[112:115], a[88:91], a[24:27]
v_max3_f32 v242, v242, v150, v151
v_mfma_f32_16x16x32_bf16 a[24:27], a[116:119], a[92:95], a[24:27]
s_waitcnt lgkmcnt(2)
v_accvgpr_read_b32 v212, a20
v_accvgpr_read_b32 v213, a21
v_mfma_f32_16x16x32_bf16 v[28:31], a[120:123], a[64:67], v[28:31]
ds_read_b128 a[104:107], v232 offset:18432
v_mfma_f32_16x16x32_bf16 v[28:31], a[124:127], a[68:71], v[28:31]
ds_read_b128 a[108:111], v233 offset:18432
v_max3_f32 v231, v231, v24, v25
v_mfma_f32_16x16x32_bf16 v[92:95], a[120:123], a[72:75], v[92:95]
v_accvgpr_read_b32 v214, a22
v_max3_f32 v231, v231, v26, v27
v_mfma_f32_16x16x32_bf16 v[92:95], a[124:127], a[76:79], v[92:95]
v_accvgpr_read_b32 v215, a23
v_max3_f32 v243, v243, v88, v89
v_mfma_f32_16x16x32_bf16 v[156:159], a[120:123], a[80:83], v[156:159]
v_max3_f32 v237, v237, v212, v213
v_max3_f32 v243, v243, v90, v91
v_mfma_f32_16x16x32_bf16 v[156:159], a[124:127], a[84:87], v[156:159]
v_max3_f32 v237, v237, v214, v215
v_max3_f32 v242, v242, v152, v153
v_mfma_f32_16x16x32_bf16 a[28:31], a[120:123], a[88:91], a[28:31]
v_max3_f32 v242, v242, v154, v155
v_mfma_f32_16x16x32_bf16 a[28:31], a[124:127], a[92:95], a[28:31]
s_waitcnt lgkmcnt(2)
v_accvgpr_read_b32 v216, a24
v_accvgpr_read_b32 v217, a25
v_mfma_f32_16x16x32_bf16 v[32:35], a[96:99], a[64:67], v[32:35]
ds_read_b128 a[112:115], v232 offset:20480
v_mfma_f32_16x16x32_bf16 v[32:35], a[100:103], a[68:71], v[32:35]
ds_read_b128 a[116:119], v233 offset:20480
v_max3_f32 v231, v231, v28, v29
v_mfma_f32_16x16x32_bf16 v[96:99], a[96:99], a[72:75], v[96:99]
v_accvgpr_read_b32 v218, a26
v_max3_f32 v231, v231, v30, v31
v_mfma_f32_16x16x32_bf16 v[96:99], a[100:103], a[76:79], v[96:99]
v_accvgpr_read_b32 v219, a27
v_max3_f32 v243, v243, v92, v93
v_mfma_f32_16x16x32_bf16 v[160:163], a[96:99], a[80:83], v[160:163]
v_max3_f32 v237, v237, v216, v217
v_max3_f32 v243, v243, v94, v95
v_mfma_f32_16x16x32_bf16 v[160:163], a[100:103], a[84:87], v[160:163]
v_max3_f32 v237, v237, v218, v219
v_max3_f32 v242, v242, v156, v157
v_mfma_f32_16x16x32_bf16 a[32:35], a[96:99], a[88:91], a[32:35]
v_max3_f32 v242, v242, v158, v159
v_mfma_f32_16x16x32_bf16 a[32:35], a[100:103], a[92:95], a[32:35]
s_waitcnt lgkmcnt(2)
v_accvgpr_read_b32 v220, a28
v_accvgpr_read_b32 v221, a29
v_mfma_f32_16x16x32_bf16 v[36:39], a[104:107], a[64:67], v[36:39]
ds_read_b128 a[120:123], v232 offset:22528
v_mfma_f32_16x16x32_bf16 v[36:39], a[108:111], a[68:71], v[36:39]
ds_read_b128 a[124:127], v233 offset:22528
v_max3_f32 v231, v231, v32, v33
v_mfma_f32_16x16x32_bf16 v[100:103], a[104:107], a[72:75], v[100:103]
v_accvgpr_read_b32 v222, a30
v_max3_f32 v231, v231, v34, v35
v_mfma_f32_16x16x32_bf16 v[100:103], a[108:111], a[76:79], v[100:103]
v_accvgpr_read_b32 v223, a31
v_max3_f32 v243, v243, v96, v97
v_mfma_f32_16x16x32_bf16 v[164:167], a[104:107], a[80:83], v[164:167]
v_max3_f32 v237, v237, v220, v221
v_max3_f32 v243, v243, v98, v99
v_mfma_f32_16x16x32_bf16 v[164:167], a[108:111], a[84:87], v[164:167]
v_max3_f32 v237, v237, v222, v223
v_max3_f32 v242, v242, v160, v161
v_mfma_f32_16x16x32_bf16 a[36:39], a[104:107], a[88:91], a[36:39]
v_max3_f32 v242, v242, v162, v163
v_mfma_f32_16x16x32_bf16 a[36:39], a[108:111], a[92:95], a[36:39]
s_waitcnt lgkmcnt(2)
v_mfma_f32_16x16x32_bf16 v[40:43], a[112:115], a[64:67], v[40:43]
ds_read_b128 a[96:99], v232 offset:24576
v_mfma_f32_16x16x32_bf16 v[40:43], a[116:119], a[68:71], v[40:43]
ds_read_b128 a[100:103], v233 offset:24576
v_max3_f32 v231, v231, v36, v37
v_mfma_f32_16x16x32_bf16 v[104:107], a[112:115], a[72:75], v[104:107]
v_max3_f32 v231, v231, v38, v39
v_mfma_f32_16x16x32_bf16 v[104:107], a[116:119], a[76:79], v[104:107]
v_max3_f32 v243, v243, v100, v101
v_mfma_f32_16x16x32_bf16 v[168:171], a[112:115], a[80:83], v[168:171]
v_max3_f32 v243, v243, v102, v103
v_mfma_f32_16x16x32_bf16 v[168:171], a[116:119], a[84:87], v[168:171]
v_max3_f32 v242, v242, v164, v165
v_mfma_f32_16x16x32_bf16 a[40:43], a[112:115], a[88:91], a[40:43]
v_max3_f32 v242, v242, v166, v167
v_mfma_f32_16x16x32_bf16 a[40:43], a[116:119], a[92:95], a[40:43]
s_waitcnt lgkmcnt(2)
v_mfma_f32_16x16x32_bf16 v[44:47], a[120:123], a[64:67], v[44:47]
ds_read_b128 a[104:107], v232 offset:26624
v_mfma_f32_16x16x32_bf16 v[44:47], a[124:127], a[68:71], v[44:47]
ds_read_b128 a[108:111], v233 offset:26624
v_max3_f32 v231, v231, v40, v41
v_mfma_f32_16x16x32_bf16 v[108:111], a[120:123], a[72:75], v[108:111]
v_max3_f32 v231, v231, v42, v43
v_mfma_f32_16x16x32_bf16 v[108:111], a[124:127], a[76:79], v[108:111]
v_max3_f32 v243, v243, v104, v105
v_mfma_f32_16x16x32_bf16 v[172:175], a[120:123], a[80:83], v[172:175]
v_max3_f32 v243, v243, v106, v107
v_mfma_f32_16x16x32_bf16 v[172:175], a[124:127], a[84:87], v[172:175]
v_max3_f32 v242, v242, v168, v169
v_mfma_f32_16x16x32_bf16 a[44:47], a[120:123], a[88:91], a[44:47]
v_max3_f32 v242, v242, v170, v171
v_mfma_f32_16x16x32_bf16 a[44:47], a[124:127], a[92:95], a[44:47]
s_waitcnt lgkmcnt(2)
v_mfma_f32_16x16x32_bf16 v[48:51], a[96:99], a[64:67], v[48:51]
ds_read_b128 a[112:115], v232 offset:28672
v_mfma_f32_16x16x32_bf16 v[48:51], a[100:103], a[68:71], v[48:51]
ds_read_b128 a[116:119], v233 offset:28672
v_max3_f32 v231, v231, v44, v45
v_mfma_f32_16x16x32_bf16 v[112:115], a[96:99], a[72:75], v[112:115]
v_max3_f32 v231, v231, v46, v47
v_mfma_f32_16x16x32_bf16 v[112:115], a[100:103], a[76:79], v[112:115]
v_max3_f32 v243, v243, v108, v109
v_mfma_f32_16x16x32_bf16 v[176:179], a[96:99], a[80:83], v[176:179]
v_max3_f32 v243, v243, v110, v111
v_mfma_f32_16x16x32_bf16 v[176:179], a[100:103], a[84:87], v[176:179]
v_max3_f32 v242, v242, v172, v173
v_mfma_f32_16x16x32_bf16 a[48:51], a[96:99], a[88:91], a[48:51]
v_max3_f32 v242, v242, v174, v175
v_mfma_f32_16x16x32_bf16 a[48:51], a[100:103], a[92:95], a[48:51]
s_waitcnt lgkmcnt(2)
v_mfma_f32_16x16x32_bf16 v[52:55], a[104:107], a[64:67], v[52:55]
ds_read_b128 a[120:123], v232 offset:30720
v_mfma_f32_16x16x32_bf16 v[52:55], a[108:111], a[68:71], v[52:55]
ds_read_b128 a[124:127], v233 offset:30720
v_max3_f32 v231, v231, v48, v49
v_mfma_f32_16x16x32_bf16 v[116:119], a[104:107], a[72:75], v[116:119]
v_max3_f32 v231, v231, v50, v51
v_mfma_f32_16x16x32_bf16 v[116:119], a[108:111], a[76:79], v[116:119]
v_max3_f32 v243, v243, v112, v113
v_mfma_f32_16x16x32_bf16 v[180:183], a[104:107], a[80:83], v[180:183]
v_max3_f32 v243, v243, v114, v115
v_mfma_f32_16x16x32_bf16 v[180:183], a[108:111], a[84:87], v[180:183]
v_max3_f32 v242, v242, v176, v177
v_mfma_f32_16x16x32_bf16 a[52:55], a[104:107], a[88:91], a[52:55]
v_max3_f32 v242, v242, v178, v179
v_mfma_f32_16x16x32_bf16 a[52:55], a[108:111], a[92:95], a[52:55]
s_waitcnt lgkmcnt(2)
v_mfma_f32_16x16x32_bf16 v[56:59], a[112:115], a[64:67], v[56:59]
v_mfma_f32_16x16x32_bf16 v[56:59], a[116:119], a[68:71], v[56:59]
v_max3_f32 v231, v231, v52, v53
v_mfma_f32_16x16x32_bf16 v[120:123], a[112:115], a[72:75], v[120:123]
v_max3_f32 v231, v231, v54, v55
v_mfma_f32_16x16x32_bf16 v[120:123], a[116:119], a[76:79], v[120:123]
v_max3_f32 v243, v243, v116, v117
v_mfma_f32_16x16x32_bf16 v[184:187], a[112:115], a[80:83], v[184:187]
v_max3_f32 v243, v243, v118, v119
v_mfma_f32_16x16x32_bf16 v[184:187], a[116:119], a[84:87], v[184:187]
v_max3_f32 v242, v242, v180, v181
v_mfma_f32_16x16x32_bf16 a[56:59], a[112:115], a[88:91], a[56:59]
v_max3_f32 v242, v242, v182, v183
v_mfma_f32_16x16x32_bf16 a[56:59], a[116:119], a[92:95], a[56:59]
s_waitcnt lgkmcnt(0)
v_mfma_f32_16x16x32_bf16 v[60:63], a[120:123], a[64:67], v[60:63]
v_mfma_f32_16x16x32_bf16 v[60:63], a[124:127], a[68:71], v[60:63]
v_max3_f32 v231, v231, v56, v57
v_mfma_f32_16x16x32_bf16 v[124:127], a[120:123], a[72:75], v[124:127]
v_max3_f32 v231, v231, v58, v59
v_mfma_f32_16x16x32_bf16 v[124:127], a[124:127], a[76:79], v[124:127]
v_max3_f32 v243, v243, v120, v121
v_mfma_f32_16x16x32_bf16 v[188:191], a[120:123], a[80:83], v[188:191]
v_max3_f32 v243, v243, v122, v123
v_mfma_f32_16x16x32_bf16 v[188:191], a[124:127], a[84:87], v[188:191]
v_max3_f32 v242, v242, v184, v185
v_mfma_f32_16x16x32_bf16 a[60:63], a[120:123], a[88:91], a[60:63]
v_max3_f32 v242, v242, v186, v187
v_mfma_f32_16x16x32_bf16 a[60:63], a[124:127], a[92:95], a[60:63]
v_max3_f32 v231, v231, v60, v61
v_max3_f32 v231, v231, v62, v63
v_max3_f32 v243, v243, v124, v125
v_max3_f32 v243, v243, v126, v127
v_max3_f32 v242, v242, v188, v189
v_max3_f32 v242, v242, v190, v191
v_mov_b32 v249, v231
v_mov_b32 v255, v243
v_mov_b32 v253, v242
v_permlane32_swap_b32 v231, v249
v_permlane32_swap_b32 v243, v255
v_permlane32_swap_b32 v242, v253
v_max_f32 v231, v231, v249
v_max_f32 v243, v243, v255
v_max_f32 v242, v242, v253
v_mov_b32 v249, v231
v_mov_b32 v255, v243
v_mov_b32 v253, v242
v_permlane16_swap_b32 v231, v249
v_permlane16_swap_b32 v243, v255
v_permlane16_swap_b32 v242, v253
v_max_f32 v231, v231, v249
v_max_f32 v243, v243, v255
v_max_f32 v242, v242, v253
v_mul_f32 v248, 0xbdb8aa3b, v231
v_mul_f32 v254, 0xbdb8aa3b, v243
v_pk_fma_f32 v[0:1], v[0:1], s[34:35], v[248:249] op_sel_hi:[1,1,0]
v_pk_fma_f32 v[2:3], v[2:3], s[34:35], v[248:249] op_sel_hi:[1,1,0]
v_exp_f32 v0, v0
v_exp_f32 v1, v1
v_pk_fma_f32 v[4:5], v[4:5], s[34:35], v[248:249] op_sel_hi:[1,1,0]
v_exp_f32 v2, v2
v_exp_f32 v3, v3
v_pk_fma_f32 v[6:7], v[6:7], s[34:35], v[248:249] op_sel_hi:[1,1,0]
v_exp_f32 v4, v4
v_pk_add_f32 v[250:251], v[0:1], v[2:3]
v_exp_f32 v5, v5
v_cvt_pk_bf16_f32 v0, v0, v1
v_cvt_pk_bf16_f32 v1, v2, v3
v_pk_fma_f32 v[8:9], v[8:9], s[34:35], v[248:249] op_sel_hi:[1,1,0]
v_exp_f32 v6, v6
v_pk_add_f32 v[250:251], v[250:251], v[4:5]
v_exp_f32 v7, v7
v_cvt_pk_bf16_f32 v2, v4, v5
v_pk_fma_f32 v[10:11], v[10:11], s[34:35], v[248:249] op_sel_hi:[1,1,0]
v_exp_f32 v8, v8
v_pk_add_f32 v[250:251], v[250:251], v[6:7]
v_exp_f32 v9, v9
v_cvt_pk_bf16_f32 v3, v6, v7
v_pk_fma_f32 v[12:13], v[12:13], s[34:35], v[248:249] op_sel_hi:[1,1,0]
v_exp_f32 v10, v10
v_pk_add_f32 v[250:251], v[250:251], v[8:9]
v_exp_f32 v11, v11
v_cvt_pk_bf16_f32 v4, v8, v9
v_pk_fma_f32 v[14:15], v[14:15], s[34:35], v[248:249] op_sel_hi:[1,1,0]
v_exp_f32 v12, v12
v_pk_add_f32 v[250:251], v[250:251], v[10:11]
v_exp_f32 v13, v13
v_cvt_pk_bf16_f32 v5, v10, v11
v_pk_fma_f32 v[16:17], v[16:17], s[34:35], v[248:249] op_sel_hi:[1,1,0]
v_exp_f32 v14, v14
v_pk_add_f32 v[250:251], v[250:251], v[12:13]
v_exp_f32 v15, v15
v_cvt_pk_bf16_f32 v6, v12, v13
v_pk_fma_f32 v[18:19], v[18:19], s[34:35], v[248:249] op_sel_hi:[1,1,0]
v_exp_f32 v16, v16
v_pk_add_f32 v[250:251], v[250:251], v[14:15]
v_exp_f32 v17, v17
v_cvt_pk_bf16_f32 v7, v14, v15
v_pk_fma_f32 v[20:21], v[20:21], s[34:35], v[248:249] op_sel_hi:[1,1,0]
v_exp_f32 v18, v18
v_pk_add_f32 v[250:251], v[250:251], v[16:17]
v_exp_f32 v19, v19
v_cvt_pk_bf16_f32 v8, v16, v17
v_pk_fma_f32 v[22:23], v[22:23], s[34:35], v[248:249] op_sel_hi:[1,1,0]
v_exp_f32 v20, v20
v_pk_add_f32 v[250:251], v[250:251], v[18:19]
v_exp_f32 v21, v21
v_cvt_pk_bf16_f32 v9, v18, v19
v_pk_fma_f32 v[24:25], v[24:25], s[34:35], v[248:249] op_sel_hi:[1,1,0]
v_exp_f32 v22, v22
v_pk_add_f32 v[250:251], v[250:251], v[20:21]
v_exp_f32 v23, v23
v_cvt_pk_bf16_f32 v10, v20, v21
v_pk_fma_f32 v[26:27], v[26:27], s[34:35], v[248:249] op_sel_hi:[1,1,0]
v_exp_f32 v24, v24
v_pk_add_f32 v[250:251], v[250:251], v[22:23]
v_exp_f32 v25, v25
v_cvt_pk_bf16_f32 v11, v22, v23
v_pk_fma_f32 v[28:29], v[28:29], s[34:35], v[248:249] op_sel_hi:[1,1,0]
v_exp_f32 v26, v26
v_pk_add_f32 v[250:251], v[250:251], v[24:25]
v_exp_f32 v27, v27
v_cvt_pk_bf16_f32 v12, v24, v25
v_pk_fma_f32 v[30:31], v[30:31], s[34:35], v[248:249] op_sel_hi:[1,1,0]
v_exp_f32 v28, v28
v_pk_add_f32 v[250:251], v[250:251], v[26:27]
v_exp_f32 v29, v29
v_cvt_pk_bf16_f32 v13, v26, v27
v_pk_fma_f32 v[32:33], v[32:33], s[34:35], v[248:249] op_sel_hi:[1,1,0]
v_exp_f32 v30, v30
v_pk_add_f32 v[250:251], v[250:251], v[28:29]
v_exp_f32 v31, v31
v_cvt_pk_bf16_f32 v14, v28, v29
v_pk_fma_f32 v[34:35], v[34:35], s[34:35], v[248:249] op_sel_hi:[1,1,0]
v_exp_f32 v32, v32
v_pk_add_f32 v[250:251], v[250:251], v[30:31]
v_exp_f32 v33, v33
v_cvt_pk_bf16_f32 v15, v30, v31
v_pk_fma_f32 v[36:37], v[36:37], s[34:35], v[248:249] op_sel_hi:[1,1,0]
v_exp_f32 v34, v34
v_pk_add_f32 v[250:251], v[250:251], v[32:33]
v_exp_f32 v35, v35
v_cvt_pk_bf16_f32 v16, v32, v33
v_pk_fma_f32 v[38:39], v[38:39], s[34:35], v[248:249] op_sel_hi:[1,1,0]
v_exp_f32 v36, v36
v_pk_add_f32 v[250:251], v[250:251], v[34:35]
v_exp_f32 v37, v37
v_cvt_pk_bf16_f32 v17, v34, v35
v_pk_fma_f32 v[40:41], v[40:41], s[34:35], v[248:249] op_sel_hi:[1,1,0]
v_exp_f32 v38, v38
v_pk_add_f32 v[250:251], v[250:251], v[36:37]
v_exp_f32 v39, v39
v_cvt_pk_bf16_f32 v18, v36, v37
v_pk_fma_f32 v[42:43], v[42:43], s[34:35], v[248:249] op_sel_hi:[1,1,0]
v_exp_f32 v40, v40
v_pk_add_f32 v[250:251], v[250:251], v[38:39]
v_exp_f32 v41, v41
v_cvt_pk_bf16_f32 v19, v38, v39
v_pk_fma_f32 v[44:45], v[44:45], s[34:35], v[248:249] op_sel_hi:[1,1,0]
v_exp_f32 v42, v42
v_pk_add_f32 v[250:251], v[250:251], v[40:41]
v_exp_f32 v43, v43
v_cvt_pk_bf16_f32 v20, v40, v41
v_pk_fma_f32 v[46:47], v[46:47], s[34:35], v[248:249] op_sel_hi:[1,1,0]
v_exp_f32 v44, v44
v_pk_add_f32 v[250:251], v[250:251], v[42:43]
v_exp_f32 v45, v45
v_cvt_pk_bf16_f32 v21, v42, v43
v_pk_fma_f32 v[48:49], v[48:49], s[34:35], v[248:249] op_sel_hi:[1,1,0]
v_exp_f32 v46, v46
v_pk_add_f32 v[250:251], v[250:251], v[44:45]
v_exp_f32 v47, v47
v_cvt_pk_bf16_f32 v22, v44, v45
v_pk_fma_f32 v[50:51], v[50:51], s[34:35], v[248:249] op_sel_hi:[1,1,0]
v_exp_f32 v48, v48
v_pk_add_f32 v[250:251], v[250:251], v[46:47]
v_exp_f32 v49, v49
v_cvt_pk_bf16_f32 v23, v46, v47
v_pk_fma_f32 v[52:53], v[52:53], s[34:35], v[248:249] op_sel_hi:[1,1,0]
v_exp_f32 v50, v50
v_pk_add_f32 v[250:251], v[250:251], v[48:49]
v_exp_f32 v51, v51
v_cvt_pk_bf16_f32 v24, v48, v49
v_pk_fma_f32 v[54:55], v[54:55], s[34:35], v[248:249] op_sel_hi:[1,1,0]
v_exp_f32 v52, v52
v_pk_add_f32 v[250:251], v[250:251], v[50:51]
v_exp_f32 v53, v53
v_cvt_pk_bf16_f32 v25, v50, v51
v_pk_fma_f32 v[56:57], v[56:57], s[34:35], v[248:249] op_sel_hi:[1,1,0]
v_exp_f32 v54, v54
v_pk_add_f32 v[250:251], v[250:251], v[52:53]
v_exp_f32 v55, v55
v_cvt_pk_bf16_f32 v26, v52, v53
v_pk_fma_f32 v[58:59], v[58:59], s[34:35], v[248:249] op_sel_hi:[1,1,0]
v_exp_f32 v56, v56
v_pk_add_f32 v[250:251], v[250:251], v[54:55]
v_exp_f32 v57, v57
v_cvt_pk_bf16_f32 v27, v54, v55
v_pk_fma_f32 v[60:61], v[60:61], s[34:35], v[248:249] op_sel_hi:[1,1,0]
v_exp_f32 v58, v58
v_pk_add_f32 v[250:251], v[250:251], v[56:57]
v_exp_f32 v59, v59
v_cvt_pk_bf16_f32 v28, v56, v57
v_pk_fma_f32 v[62:63], v[62:63], s[34:35], v[248:249] op_sel_hi:[1,1,0]
v_exp_f32 v60, v60
v_pk_add_f32 v[250:251], v[250:251], v[58:59]
v_exp_f32 v61, v61
v_cvt_pk_bf16_f32 v29, v58, v59
v_exp_f32 v62, v62
v_pk_add_f32 v[250:251], v[250:251], v[60:61]
v_exp_f32 v63, v63
v_cvt_pk_bf16_f32 v30, v60, v61
v_pk_add_f32 v[250:251], v[250:251], v[62:63]
v_cvt_pk_bf16_f32 v31, v62, v63
v_add_f32 v244, v250, v251
v_mul_f32 v248, 0xbdb8aa3b, v242
v_pk_fma_f32 v[64:65], v[64:65], s[34:35], v[254:255] op_sel_hi:[1,1,0]
v_pk_fma_f32 v[66:67], v[66:67], s[34:35], v[254:255] op_sel_hi:[1,1,0]
v_exp_f32 v64, v64
v_exp_f32 v65, v65
v_pk_fma_f32 v[68:69], v[68:69], s[34:35], v[254:255] op_sel_hi:[1,1,0]
v_exp_f32 v66, v66
v_exp_f32 v67, v67
v_pk_fma_f32 v[70:71], v[70:71], s[34:35], v[254:255] op_sel_hi:[1,1,0]
v_exp_f32 v68, v68
v_pk_add_f32 v[250:251], v[64:65], v[66:67]
v_exp_f32 v69, v69
v_cvt_pk_bf16_f32 v32, v64, v65
v_cvt_pk_bf16_f32 v33, v66, v67
v_pk_fma_f32 v[72:73], v[72:73], s[34:35], v[254:255] op_sel_hi:[1,1,0]
v_exp_f32 v70, v70
v_pk_add_f32 v[250:251], v[250:251], v[68:69]
v_exp_f32 v71, v71
v_cvt_pk_bf16_f32 v34, v68, v69
v_pk_fma_f32 v[74:75], v[74:75], s[34:35], v[254:255] op_sel_hi:[1,1,0]
v_exp_f32 v72, v72
v_mov_b32 v249, v244
v_pk_add_f32 v[250:251], v[250:251], v[70:71]
v_exp_f32 v73, v73
v_cvt_pk_bf16_f32 v35, v70, v71
v_pk_fma_f32 v[76:77], v[76:77], s[34:35], v[254:255] op_sel_hi:[1,1,0]
v_exp_f32 v74, v74
v_pk_add_f32 v[250:251], v[250:251], v[72:73]
v_exp_f32 v75, v75
v_cvt_pk_bf16_f32 v36, v72, v73
v_pk_fma_f32 v[78:79], v[78:79], s[34:35], v[254:255] op_sel_hi:[1,1,0]
v_exp_f32 v76, v76
v_pk_add_f32 v[250:251], v[250:251], v[74:75]
v_exp_f32 v77, v77
v_cvt_pk_bf16_f32 v37, v74, v75
v_pk_fma_f32 v[80:81], v[80:81], s[34:35], v[254:255] op_sel_hi:[1,1,0]
v_exp_f32 v78, v78
v_pk_add_f32 v[250:251], v[250:251], v[76:77]
v_exp_f32 v79, v79
v_cvt_pk_bf16_f32 v38, v76, v77
v_pk_fma_f32 v[82:83], v[82:83], s[34:35], v[254:255] op_sel_hi:[1,1,0]
v_exp_f32 v80, v80
v_permlane32_swap_b32 v244, v249
v_pk_add_f32 v[250:251], v[250:251], v[78:79]
v_exp_f32 v81, v81
v_cvt_pk_bf16_f32 v39, v78, v79
v_pk_fma_f32 v[84:85], v[84:85], s[34:35], v[254:255] op_sel_hi:[1,1,0]
v_exp_f32 v82, v82
v_pk_add_f32 v[250:251], v[250:251], v[80:81]
v_exp_f32 v83, v83
v_cvt_pk_bf16_f32 v40, v80, v81
v_pk_fma_f32 v[86:87], v[86:87], s[34:35], v[254:255] op_sel_hi:[1,1,0]
v_exp_f32 v84, v84
v_pk_add_f32 v[250:251], v[250:251], v[82:83]
v_exp_f32 v85, v85
v_cvt_pk_bf16_f32 v41, v82, v83
v_pk_fma_f32 v[88:89], v[88:89], s[34:35], v[254:255] op_sel_hi:[1,1,0]
v_exp_f32 v86, v86
v_pk_add_f32 v[250:251], v[250:251], v[84:85]
v_exp_f32 v87, v87
v_cvt_pk_bf16_f32 v42, v84, v85
v_pk_fma_f32 v[90:91], v[90:91], s[34:35], v[254:255] op_sel_hi:[1,1,0]
v_exp_f32 v88, v88
v_add_f32 v244, v244, v249
v_pk_add_f32 v[250:251], v[250:251], v[86:87]
v_exp_f32 v89, v89
v_cvt_pk_bf16_f32 v43, v86, v87
v_pk_fma_f32 v[92:93], v[92:93], s[34:35], v[254:255] op_sel_hi:[1,1,0]
v_exp_f32 v90, v90
v_pk_add_f32 v[250:251], v[250:251], v[88:89]
v_exp_f32 v91, v91
v_cvt_pk_bf16_f32 v44, v88, v89
v_pk_fma_f32 v[94:95], v[94:95], s[34:35], v[254:255] op_sel_hi:[1,1,0]
v_exp_f32 v92, v92
v_pk_add_f32 v[250:251], v[250:251], v[90:91]
v_exp_f32 v93, v93
v_cvt_pk_bf16_f32 v45, v90, v91
v_pk_fma_f32 v[96:97], v[96:97], s[34:35], v[254:255] op_sel_hi:[1,1,0]
v_exp_f32 v94, v94
v_pk_add_f32 v[250:251], v[250:251], v[92:93]
v_exp_f32 v95, v95
v_cvt_pk_bf16_f32 v46, v92, v93
v_pk_fma_f32 v[98:99], v[98:99], s[34:35], v[254:255] op_sel_hi:[1,1,0]
v_exp_f32 v96, v96
v_mov_b32 v249, v244
v_pk_add_f32 v[250:251], v[250:251], v[94:95]
v_exp_f32 v97, v97
v_cvt_pk_bf16_f32 v47, v94, v95
v_pk_fma_f32 v[100:101], v[100:101], s[34:35], v[254:255] op_sel_hi:[1,1,0]
v_exp_f32 v98, v98
v_pk_add_f32 v[250:251], v[250:251], v[96:97]
v_exp_f32 v99, v99
v_cvt_pk_bf16_f32 v48, v96, v97
v_pk_fma_f32 v[102:103], v[102:103], s[34:35], v[254:255] op_sel_hi:[1,1,0]
v_exp_f32 v100, v100
v_pk_add_f32 v[250:251], v[250:251], v[98:99]
v_exp_f32 v101, v101
v_cvt_pk_bf16_f32 v49, v98, v99
v_pk_fma_f32 v[104:105], v[104:105], s[34:35], v[254:255] op_sel_hi:[1,1,0]
v_exp_f32 v102, v102
v_pk_add_f32 v[250:251], v[250:251], v[100:101]
v_exp_f32 v103, v103
v_cvt_pk_bf16_f32 v50, v100, v101
v_pk_fma_f32 v[106:107], v[106:107], s[34:35], v[254:255] op_sel_hi:[1,1,0]
v_exp_f32 v104, v104
v_permlane16_swap_b32 v244, v249
v_pk_add_f32 v[250:251], v[250:251], v[102:103]
v_exp_f32 v105, v105
v_cvt_pk_bf16_f32 v51, v102, v103
v_pk_fma_f32 v[108:109], v[108:109], s[34:35], v[254:255] op_sel_hi:[1,1,0]
v_exp_f32 v106, v106
v_pk_add_f32 v[250:251], v[250:251], v[104:105]
v_exp_f32 v107, v107
v_cvt_pk_bf16_f32 v52, v104, v105
v_pk_fma_f32 v[110:111], v[110:111], s[34:35], v[254:255] op_sel_hi:[1,1,0]
v_exp_f32 v108, v108
v_pk_add_f32 v[250:251], v[250:251], v[106:107]
v_exp_f32 v109, v109
v_cvt_pk_bf16_f32 v53, v106, v107
v_pk_fma_f32 v[112:113], v[112:113], s[34:35], v[254:255] op_sel_hi:[1,1,0]
v_exp_f32 v110, v110
v_pk_add_f32 v[250:251], v[250:251], v[108:109]
v_exp_f32 v111, v111
v_cvt_pk_bf16_f32 v54, v108, v109
v_pk_fma_f32 v[114:115], v[114:115], s[34:35], v[254:255] op_sel_hi:[1,1,0]
v_exp_f32 v112, v112
v_add_f32 v244, v244, v249
v_pk_add_f32 v[250:251], v[250:251], v[110:111]
v_exp_f32 v113, v113
v_cvt_pk_bf16_f32 v55, v110, v111
v_pk_fma_f32 v[116:117], v[116:117], s[34:35], v[254:255] op_sel_hi:[1,1,0]
v_exp_f32 v114, v114
v_pk_add_f32 v[250:251], v[250:251], v[112:113]
v_exp_f32 v115, v115
v_cvt_pk_bf16_f32 v56, v112, v113
v_pk_fma_f32 v[118:119], v[118:119], s[34:35], v[254:255] op_sel_hi:[1,1,0]
v_exp_f32 v116, v116
v_pk_add_f32 v[250:251], v[250:251], v[114:115]
v_exp_f32 v117, v117
v_cvt_pk_bf16_f32 v57, v114, v115
v_pk_fma_f32 v[120:121], v[120:121], s[34:35], v[254:255] op_sel_hi:[1,1,0]
v_exp_f32 v118, v118
v_pk_add_f32 v[250:251], v[250:251], v[116:117]
v_exp_f32 v119, v119
v_cvt_pk_bf16_f32 v58, v116, v117
v_pk_fma_f32 v[122:123], v[122:123], s[34:35], v[254:255] op_sel_hi:[1,1,0]
v_exp_f32 v120, v120
v_rcp_f32 v244, v244
v_pk_add_f32 v[250:251], v[250:251], v[118:119]
v_exp_f32 v121, v121
v_cvt_pk_bf16_f32 v59, v118, v119
v_pk_fma_f32 v[124:125], v[124:125], s[34:35], v[254:255] op_sel_hi:[1,1,0]
v_exp_f32 v122, v122
v_pk_add_f32 v[250:251], v[250:251], v[120:121]
v_exp_f32 v123, v123
v_cvt_pk_bf16_f32 v60, v120, v121
v_pk_fma_f32 v[126:127], v[126:127], s[34:35], v[254:255] op_sel_hi:[1,1,0]
v_exp_f32 v124, v124
v_pk_add_f32 v[250:251], v[250:251], v[122:123]
v_exp_f32 v125, v125
v_cvt_pk_bf16_f32 v61, v122, v123
v_exp_f32 v126, v126
v_pk_add_f32 v[250:251], v[250:251], v[124:125]
v_exp_f32 v127, v127
v_cvt_pk_bf16_f32 v62, v124, v125
v_pk_add_f32 v[250:251], v[250:251], v[126:127]
v_cvt_pk_bf16_f32 v63, v126, v127
v_add_f32 v245, v250, v251
v_mov_b32 v249, v245
v_pk_fma_f32 v[128:129], v[128:129], s[34:35], v[248:249] op_sel_hi:[1,1,0]
v_pk_fma_f32 v[130:131], v[130:131], s[34:35], v[248:249] op_sel_hi:[1,1,0]
v_exp_f32 v128, v128
v_exp_f32 v129, v129
v_pk_fma_f32 v[132:133], v[132:133], s[34:35], v[248:249] op_sel_hi:[1,1,0]
v_exp_f32 v130, v130
v_exp_f32 v131, v131
v_pk_fma_f32 v[134:135], v[134:135], s[34:35], v[248:249] op_sel_hi:[1,1,0]
v_exp_f32 v132, v132
v_pk_add_f32 v[250:251], v[128:129], v[130:131]
v_exp_f32 v133, v133
v_cvt_pk_bf16_f32 v64, v128, v129
v_cvt_pk_bf16_f32 v65, v130, v131
v_pk_fma_f32 v[136:137], v[136:137], s[34:35], v[248:249] op_sel_hi:[1,1,0]
v_exp_f32 v134, v134
v_pk_add_f32 v[250:251], v[250:251], v[132:133]
v_exp_f32 v135, v135
v_cvt_pk_bf16_f32 v66, v132, v133
v_pk_fma_f32 v[138:139], v[138:139], s[34:35], v[248:249] op_sel_hi:[1,1,0]
v_exp_f32 v136, v136
v_pk_add_f32 v[250:251], v[250:251], v[134:135]
v_exp_f32 v137, v137
v_cvt_pk_bf16_f32 v67, v134, v135
v_permlane32_swap_b32 v245, v249
v_pk_fma_f32 v[140:141], v[140:141], s[34:35], v[248:249] op_sel_hi:[1,1,0]
v_exp_f32 v138, v138
v_pk_add_f32 v[250:251], v[250:251], v[136:137]
v_exp_f32 v139, v139
v_cvt_pk_bf16_f32 v68, v136, v137
v_pk_fma_f32 v[142:143], v[142:143], s[34:35], v[248:249] op_sel_hi:[1,1,0]
v_exp_f32 v140, v140
v_pk_add_f32 v[250:251], v[250:251], v[138:139]
v_exp_f32 v141, v141
v_cvt_pk_bf16_f32 v69, v138, v139
v_pk_fma_f32 v[144:145], v[144:145], s[34:35], v[248:249] op_sel_hi:[1,1,0]
v_exp_f32 v142, v142
v_pk_add_f32 v[250:251], v[250:251], v[140:141]
v_exp_f32 v143, v143
v_cvt_pk_bf16_f32 v70, v140, v141
v_pk_fma_f32 v[146:147], v[146:147], s[34:35], v[248:249] op_sel_hi:[1,1,0]
v_exp_f32 v144, v144
v_pk_add_f32 v[250:251], v[250:251], v[142:143]
v_exp_f32 v145, v145
v_cvt_pk_bf16_f32 v71, v142, v143
v_pk_fma_f32 v[148:149], v[148:149], s[34:35], v[248:249] op_sel_hi:[1,1,0]
v_exp_f32 v146, v146
v_pk_add_f32 v[250:251], v[250:251], v[144:145]
v_add_f32 v245, v245, v249
v_exp_f32 v147, v147
v_cvt_pk_bf16_f32 v72, v144, v145
v_pk_fma_f32 v[150:151], v[150:151], s[34:35], v[248:249] op_sel_hi:[1,1,0]
v_exp_f32 v148, v148
v_pk_add_f32 v[250:251], v[250:251], v[146:147]
v_exp_f32 v149, v149
v_cvt_pk_bf16_f32 v73, v146, v147
v_pk_fma_f32 v[152:153], v[152:153], s[34:35], v[248:249] op_sel_hi:[1,1,0]
v_exp_f32 v150, v150
v_pk_add_f32 v[250:251], v[250:251], v[148:149]
v_exp_f32 v151, v151
v_cvt_pk_bf16_f32 v74, v148, v149
v_pk_fma_f32 v[154:155], v[154:155], s[34:35], v[248:249] op_sel_hi:[1,1,0]
v_exp_f32 v152, v152
v_pk_add_f32 v[250:251], v[250:251], v[150:151]
v_exp_f32 v153, v153
v_cvt_pk_bf16_f32 v75, v150, v151
v_pk_fma_f32 v[156:157], v[156:157], s[34:35], v[248:249] op_sel_hi:[1,1,0]
v_exp_f32 v154, v154
v_pk_add_f32 v[250:251], v[250:251], v[152:153]
v_exp_f32 v155, v155
v_cvt_pk_bf16_f32 v76, v152, v153
v_pk_fma_f32 v[158:159], v[158:159], s[34:35], v[248:249] op_sel_hi:[1,1,0]
v_mov_b32 v249, v245
v_exp_f32 v156, v156
v_pk_add_f32 v[250:251], v[250:251], v[154:155]
v_exp_f32 v157, v157
v_cvt_pk_bf16_f32 v77, v154, v155
v_pk_fma_f32 v[160:161], v[160:161], s[34:35], v[248:249] op_sel_hi:[1,1,0]
v_exp_f32 v158, v158
v_pk_add_f32 v[250:251], v[250:251], v[156:157]
v_exp_f32 v159, v159
v_cvt_pk_bf16_f32 v78, v156, v157
v_pk_fma_f32 v[162:163], v[162:163], s[34:35], v[248:249] op_sel_hi:[1,1,0]
s_xor_b32 s97, s40, 0
s_waitcnt vmcnt(0)
buffer_store_dwordx4 a[128:131], v230, s[28:31], s97 offen sc1
v_exp_f32 v160, v160
v_pk_add_f32 v[250:251], v[250:251], v[158:159]
v_exp_f32 v161, v161
v_cvt_pk_bf16_f32 v79, v158, v159
v_pk_fma_f32 v[164:165], v[164:165], s[34:35], v[248:249] op_sel_hi:[1,1,0]
v_exp_f32 v162, v162
v_pk_add_f32 v[250:251], v[250:251], v[160:161]
v_exp_f32 v163, v163
v_cvt_pk_bf16_f32 v80, v160, v161
v_pk_fma_f32 v[166:167], v[166:167], s[34:35], v[248:249] op_sel_hi:[1,1,0]
v_exp_f32 v164, v164
v_pk_add_f32 v[250:251], v[250:251], v[162:163]
v_exp_f32 v165, v165
v_permlane16_swap_b32 v245, v249
v_cvt_pk_bf16_f32 v81, v162, v163
v_pk_fma_f32 v[168:169], v[168:169], s[34:35], v[248:249] op_sel_hi:[1,1,0]
v_exp_f32 v166, v166
v_pk_add_f32 v[250:251], v[250:251], v[164:165]
v_exp_f32 v167, v167
v_cvt_pk_bf16_f32 v82, v164, v165
v_pk_fma_f32 v[170:171], v[170:171], s[34:35], v[248:249] op_sel_hi:[1,1,0]
v_exp_f32 v168, v168
v_pk_add_f32 v[250:251], v[250:251], v[166:167]
v_exp_f32 v169, v169
v_cvt_pk_bf16_f32 v83, v166, v167
v_pk_fma_f32 v[172:173], v[172:173], s[34:35], v[248:249] op_sel_hi:[1,1,0]
v_exp_f32 v170, v170
v_pk_add_f32 v[250:251], v[250:251], v[168:169]
v_exp_f32 v171, v171
v_cvt_pk_bf16_f32 v84, v168, v169
v_pk_fma_f32 v[174:175], v[174:175], s[34:35], v[248:249] op_sel_hi:[1,1,0]
v_exp_f32 v172, v172
v_pk_add_f32 v[250:251], v[250:251], v[170:171]
v_exp_f32 v173, v173
v_cvt_pk_bf16_f32 v85, v170, v171
v_pk_fma_f32 v[176:177], v[176:177], s[34:35], v[248:249] op_sel_hi:[1,1,0]
v_exp_f32 v174, v174
v_add_f32 v245, v245, v249
v_pk_add_f32 v[250:251], v[250:251], v[172:173]
v_exp_f32 v175, v175
v_cvt_pk_bf16_f32 v86, v172, v173
s_xor_b32 s97, s40, 8192
buffer_store_dwordx4 a[132:135], v230, s[28:31], s97 offen sc1
v_pk_fma_f32 v[178:179], v[178:179], s[34:35], v[248:249] op_sel_hi:[1,1,0]
v_exp_f32 v176, v176
v_pk_add_f32 v[250:251], v[250:251], v[174:175]
v_exp_f32 v177, v177
v_cvt_pk_bf16_f32 v87, v174, v175
v_pk_fma_f32 v[180:181], v[180:181], s[34:35], v[248:249] op_sel_hi:[1,1,0]
v_exp_f32 v178, v178
v_pk_add_f32 v[250:251], v[250:251], v[176:177]
v_exp_f32 v179, v179
v_cvt_pk_bf16_f32 v88, v176, v177
v_pk_fma_f32 v[182:183], v[182:183], s[34:35], v[248:249] op_sel_hi:[1,1,0]
v_exp_f32 v180, v180
v_pk_add_f32 v[250:251], v[250:251], v[178:179]
v_exp_f32 v181, v181
v_cvt_pk_bf16_f32 v89, v178, v179
v_pk_fma_f32 v[184:185], v[184:185], s[34:35], v[248:249] op_sel_hi:[1,1,0]
v_exp_f32 v182, v182
v_pk_add_f32 v[250:251], v[250:251], v[180:181]
v_exp_f32 v183, v183
v_cvt_pk_bf16_f32 v90, v180, v181
v_rcp_f32 v245, v245
v_pk_fma_f32 v[186:187], v[186:187], s[34:35], v[248:249] op_sel_hi:[1,1,0]
v_exp_f32 v184, v184
v_pk_add_f32 v[250:251], v[250:251], v[182:183]
v_exp_f32 v185, v185
v_cvt_pk_bf16_f32 v91, v182, v183
v_pk_fma_f32 v[188:189], v[188:189], s[34:35], v[248:249] op_sel_hi:[1,1,0]
v_exp_f32 v186, v186
v_pk_add_f32 v[250:251], v[250:251], v[184:185]
v_exp_f32 v187, v187
v_cvt_pk_bf16_f32 v92, v184, v185
v_pk_fma_f32 v[190:191], v[190:191], s[34:35], v[248:249] op_sel_hi:[1,1,0]
v_exp_f32 v188, v188
v_pk_add_f32 v[250:251], v[250:251], v[186:187]
v_exp_f32 v189, v189
v_cvt_pk_bf16_f32 v93, v186, v187
v_exp_f32 v190, v190
v_pk_add_f32 v[250:251], v[250:251], v[188:189]
v_exp_f32 v191, v191
v_cvt_pk_bf16_f32 v94, v188, v189
s_xor_b32 s97, s40, 16384
buffer_store_dwordx4 a[136:139], v230, s[28:31], s97 offen sc1
v_pk_add_f32 v[250:251], v[250:251], v[190:191]
v_cvt_pk_bf16_f32 v95, v190, v191
v_add_f32 v246, v250, v251
v_accvgpr_read_b32 v160, a32
v_accvgpr_read_b32 v161, a33
v_accvgpr_read_b32 v162, a34
v_accvgpr_read_b32 v163, a35
v_accvgpr_read_b32 v164, a36
v_accvgpr_read_b32 v165, a37
v_accvgpr_read_b32 v166, a38
v_accvgpr_read_b32 v167, a39
v_max3_f32 v237, v237, v160, v161
v_max3_f32 v237, v237, v162, v163
v_accvgpr_read_b32 v168, a40
v_accvgpr_read_b32 v169, a41
v_accvgpr_read_b32 v170, a42
v_accvgpr_read_b32 v171, a43
v_max3_f32 v237, v237, v164, v165
v_max3_f32 v237, v237, v166, v167
v_accvgpr_read_b32 v172, a44
v_accvgpr_read_b32 v173, a45
v_accvgpr_read_b32 v174, a46
v_accvgpr_read_b32 v175, a47
v_max3_f32 v237, v237, v168, v169
v_max3_f32 v237, v237, v170, v171
v_accvgpr_read_b32 v176, a48
v_accvgpr_read_b32 v177, a49
v_accvgpr_read_b32 v178, a50
v_accvgpr_read_b32 v179, a51
v_max3_f32 v237, v237, v172, v173
v_max3_f32 v237, v237, v174, v175
v_accvgpr_read_b32 v180, a52
v_accvgpr_read_b32 v181, a53
v_accvgpr_read_b32 v182, a54
v_accvgpr_read_b32 v183, a55
v_max3_f32 v237, v237, v176, v177
v_max3_f32 v237, v237, v178, v179
v_accvgpr_read_b32 v184, a56
v_accvgpr_read_b32 v185, a57
v_accvgpr_read_b32 v186, a58
v_accvgpr_read_b32 v187, a59
v_max3_f32 v237, v237, v180, v181
v_max3_f32 v237, v237, v182, v183
v_accvgpr_read_b32 v188, a60
v_accvgpr_read_b32 v189, a61
v_accvgpr_read_b32 v190, a62
v_accvgpr_read_b32 v191, a63
v_max3_f32 v237, v237, v184, v185
v_max3_f32 v237, v237, v186, v187
v_max3_f32 v237, v237, v188, v189
v_max3_f32 v237, v237, v190, v191
v_mov_b32 v255, v237
v_mov_b32 v249, v246
s_nop 0
v_permlane32_swap_b32 v237, v255
v_permlane32_swap_b32 v246, v249
s_xor_b32 s97, s40, 24576
buffer_store_dwordx4 a[140:143], v230, s[28:31], s97 offen sc1
v_max_f32 v237, v237, v255
v_add_f32 v246, v246, v249
v_mov_b32 v255, v237
v_mov_b32 v249, v246
s_nop 0
v_permlane16_swap_b32 v237, v255
v_permlane16_swap_b32 v246, v249
v_max_f32 v237, v237, v255
v_add_f32 v246, v246, v249
v_mul_f32 v254, 0xbdb8aa3b, v237
v_rcp_f32 v246, v246
v_pk_fma_f32 v[192:193], v[192:193], s[34:35], v[254:255] op_sel_hi:[1,1,0]
v_pk_fma_f32 v[194:195], v[194:195], s[34:35], v[254:255] op_sel_hi:[1,1,0]
v_exp_f32 v192, v192
v_exp_f32 v193, v193
v_pk_fma_f32 v[196:197], v[196:197], s[34:35], v[254:255] op_sel_hi:[1,1,0]
v_exp_f32 v194, v194
v_exp_f32 v195, v195
v_pk_fma_f32 v[198:199], v[198:199], s[34:35], v[254:255] op_sel_hi:[1,1,0]
v_exp_f32 v196, v196
v_pk_add_f32 v[250:251], v[192:193], v[194:195]
v_exp_f32 v197, v197
v_cvt_pk_bf16_f32 v96, v192, v193
v_cvt_pk_bf16_f32 v97, v194, v195
v_pk_fma_f32 v[200:201], v[200:201], s[34:35], v[254:255] op_sel_hi:[1,1,0]
v_exp_f32 v198, v198
v_pk_add_f32 v[250:251], v[250:251], v[196:197]
v_exp_f32 v199, v199
v_cvt_pk_bf16_f32 v98, v196, v197
v_pk_fma_f32 v[202:203], v[202:203], s[34:35], v[254:255] op_sel_hi:[1,1,0]
v_exp_f32 v200, v200
v_pk_add_f32 v[250:251], v[250:251], v[198:199]
v_exp_f32 v201, v201
v_cvt_pk_bf16_f32 v99, v198, v199
v_pk_fma_f32 v[204:205], v[204:205], s[34:35], v[254:255] op_sel_hi:[1,1,0]
v_exp_f32 v202, v202
v_pk_add_f32 v[250:251], v[250:251], v[200:201]
v_exp_f32 v203, v203
v_cvt_pk_bf16_f32 v100, v200, v201
v_pk_fma_f32 v[206:207], v[206:207], s[34:35], v[254:255] op_sel_hi:[1,1,0]
v_exp_f32 v204, v204
v_pk_add_f32 v[250:251], v[250:251], v[202:203]
s_xor_b32 s97, s40, 4096
buffer_store_dwordx4 a[144:147], v230, s[28:31], s97 offen sc1
v_exp_f32 v205, v205
v_cvt_pk_bf16_f32 v101, v202, v203
v_pk_fma_f32 v[208:209], v[208:209], s[34:35], v[254:255] op_sel_hi:[1,1,0]
v_exp_f32 v206, v206
v_pk_add_f32 v[250:251], v[250:251], v[204:205]
v_exp_f32 v207, v207
v_cvt_pk_bf16_f32 v102, v204, v205
v_pk_fma_f32 v[210:211], v[210:211], s[34:35], v[254:255] op_sel_hi:[1,1,0]
v_exp_f32 v208, v208
v_pk_add_f32 v[250:251], v[250:251], v[206:207]
v_exp_f32 v209, v209
v_cvt_pk_bf16_f32 v103, v206, v207
v_pk_fma_f32 v[212:213], v[212:213], s[34:35], v[254:255] op_sel_hi:[1,1,0]
v_exp_f32 v210, v210
v_pk_add_f32 v[250:251], v[250:251], v[208:209]
v_exp_f32 v211, v211
v_cvt_pk_bf16_f32 v104, v208, v209
v_pk_fma_f32 v[214:215], v[214:215], s[34:35], v[254:255] op_sel_hi:[1,1,0]
v_exp_f32 v212, v212
v_pk_add_f32 v[250:251], v[250:251], v[210:211]
v_exp_f32 v213, v213
v_cvt_pk_bf16_f32 v105, v210, v211
v_pk_fma_f32 v[216:217], v[216:217], s[34:35], v[254:255] op_sel_hi:[1,1,0]
v_exp_f32 v214, v214
v_pk_add_f32 v[250:251], v[250:251], v[212:213]
v_exp_f32 v215, v215
v_cvt_pk_bf16_f32 v106, v212, v213
v_pk_fma_f32 v[218:219], v[218:219], s[34:35], v[254:255] op_sel_hi:[1,1,0]
v_exp_f32 v216, v216
v_pk_add_f32 v[250:251], v[250:251], v[214:215]
v_exp_f32 v217, v217
v_cvt_pk_bf16_f32 v107, v214, v215
v_pk_fma_f32 v[220:221], v[220:221], s[34:35], v[254:255] op_sel_hi:[1,1,0]
v_exp_f32 v218, v218
v_pk_add_f32 v[250:251], v[250:251], v[216:217]
v_exp_f32 v219, v219
v_cvt_pk_bf16_f32 v108, v216, v217
v_pk_fma_f32 v[222:223], v[222:223], s[34:35], v[254:255] op_sel_hi:[1,1,0]
v_exp_f32 v220, v220
s_xor_b32 s97, s40, 12288
buffer_store_dwordx4 a[148:151], v230, s[28:31], s97 offen sc1
v_pk_add_f32 v[250:251], v[250:251], v[218:219]
v_exp_f32 v221, v221
v_cvt_pk_bf16_f32 v109, v218, v219
v_pk_fma_f32 v[160:161], v[160:161], s[34:35], v[254:255] op_sel_hi:[1,1,0]
v_exp_f32 v222, v222
v_pk_add_f32 v[250:251], v[250:251], v[220:221]
v_exp_f32 v223, v223
v_cvt_pk_bf16_f32 v110, v220, v221
v_pk_fma_f32 v[162:163], v[162:163], s[34:35], v[254:255] op_sel_hi:[1,1,0]
v_exp_f32 v160, v160
s_barrier
v_add_u32 v232, 98304, v227
v_xor_b32 v233, 32, v232
v_xor_b32 v234, 64, v232
v_xor_b32 v235, 96, v232
ds_read_b64_tr_b16 a[0:1], v232 offset:0
v_pk_add_f32 v[250:251], v[250:251], v[222:223]
v_exp_f32 v161, v161
v_cvt_pk_bf16_f32 v111, v222, v223
v_pk_fma_f32 v[164:165], v[164:165], s[34:35], v[254:255] op_sel_hi:[1,1,0]
ds_read_b64_tr_b16 a[2:3], v232 offset:2048
v_exp_f32 v162, v162
v_pk_add_f32 v[250:251], v[250:251], v[160:161]
v_exp_f32 v163, v163
v_cvt_pk_bf16_f32 v112, v160, v161
ds_read_b64_tr_b16 a[4:5], v232 offset:4096
v_pk_fma_f32 v[166:167], v[166:167], s[34:35], v[254:255] op_sel_hi:[1,1,0]
v_exp_f32 v164, v164
v_pk_add_f32 v[250:251], v[250:251], v[162:163]
v_exp_f32 v165, v165
ds_read_b64_tr_b16 a[6:7], v232 offset:6144
v_cvt_pk_bf16_f32 v113, v162, v163
v_pk_fma_f32 v[168:169], v[168:169], s[34:35], v[254:255] op_sel_hi:[1,1,0]
v_exp_f32 v166, v166
ds_read_b64_tr_b16 a[8:9], v232 offset:8192
v_pk_add_f32 v[250:251], v[250:251], v[164:165]
v_exp_f32 v167, v167
v_cvt_pk_bf16_f32 v114, v164, v165
v_pk_fma_f32 v[170:171], v[170:171], s[34:35], v[254:255] op_sel_hi:[1,1,0]
ds_read_b64_tr_b16 a[10:11], v232 offset:10240
v_exp_f32 v168, v168
v_pk_add_f32 v[250:251], v[250:251], v[166:167]
v_exp_f32 v169, v169
v_cvt_pk_bf16_f32 v115, v166, v167
ds_read_b64_tr_b16 a[12:13], v232 offset:12288
v_pk_fma_f32 v[172:173], v[172:173], s[34:35], v[254:255] op_sel_hi:[1,1,0]
v_exp_f32 v170, v170
v_pk_add_f32 v[250:251], v[250:251], v[168:169]
v_exp_f32 v171, v171
ds_read_b64_tr_b16 a[14:15], v232 offset:14336
v_cvt_pk_bf16_f32 v116, v168, v169
v_pk_fma_f32 v[174:175], v[174:175], s[34:35], v[254:255] op_sel_hi:[1,1,0]
v_exp_f32 v172, v172
s_xor_b32 s97, s40, 20480
buffer_store_dwordx4 a[152:155], v230, s[28:31], s97 offen sc1
ds_read_b64_tr_b16 a[16:17], v232 offset:16384
v_pk_add_f32 v[250:251], v[250:251], v[170:171]
v_exp_f32 v173, v173
v_cvt_pk_bf16_f32 v117, v170, v171
v_pk_fma_f32 v[176:177], v[176:177], s[34:35], v[254:255] op_sel_hi:[1,1,0]
ds_read_b64_tr_b16 a[18:19], v232 offset:18432
v_exp_f32 v174, v174
v_pk_add_f32 v[250:251], v[250:251], v[172:173]
v_exp_f32 v175, v175
v_cvt_pk_bf16_f32 v118, v172, v173
ds_read_b64_tr_b16 a[20:21], v232 offset:20480
v_pk_fma_f32 v[178:179], v[178:179], s[34:35], v[254:255] op_sel_hi:[1,1,0]
v_exp_f32 v176, v176
v_pk_add_f32 v[250:251], v[250:251], v[174:175]
v_exp_f32 v177, v177
ds_read_b64_tr_b16 a[22:23], v232 offset:22528
v_cvt_pk_bf16_f32 v119, v174, v175
v_pk_fma_f32 v[180:181], v[180:181], s[34:35], v[254:255] op_sel_hi:[1,1,0]
v_exp_f32 v178, v178
ds_read_b64_tr_b16 a[24:25], v232 offset:24576
v_pk_add_f32 v[250:251], v[250:251], v[176:177]
v_exp_f32 v179, v179
v_cvt_pk_bf16_f32 v120, v176, v177
v_pk_fma_f32 v[182:183], v[182:183], s[34:35], v[254:255] op_sel_hi:[1,1,0]
ds_read_b64_tr_b16 a[26:27], v232 offset:26624
v_exp_f32 v180, v180
v_pk_add_f32 v[250:251], v[250:251], v[178:179]
v_exp_f32 v181, v181
v_cvt_pk_bf16_f32 v121, v178, v179
ds_read_b64_tr_b16 a[28:29], v232 offset:28672
v_pk_fma_f32 v[184:185], v[184:185], s[34:35], v[254:255] op_sel_hi:[1,1,0]
v_exp_f32 v182, v182
v_pk_add_f32 v[250:251], v[250:251], v[180:181]
v_exp_f32 v183, v183
s_waitcnt lgkmcnt(8)
ds_read_b64_tr_b16 a[30:31], v232 offset:30720
v_cvt_pk_bf16_f32 v122, v180, v181
v_pk_fma_f32 v[186:187], v[186:187], s[34:35], v[254:255] op_sel_hi:[1,1,0]
v_exp_f32 v184, v184
v_pk_add_f32 v[250:251], v[250:251], v[182:183]
v_exp_f32 v185, v185
v_cvt_pk_bf16_f32 v123, v182, v183
v_pk_fma_f32 v[188:189], v[188:189], s[34:35], v[254:255] op_sel_hi:[1,1,0]
v_exp_f32 v186, v186
v_pk_add_f32 v[250:251], v[250:251], v[184:185]
v_exp_f32 v187, v187
v_cvt_pk_bf16_f32 v124, v184, v185
v_pk_fma_f32 v[190:191], v[190:191], s[34:35], v[254:255] op_sel_hi:[1,1,0]
s_xor_b32 s97, s40, 28672
buffer_store_dwordx4 a[156:159], v230, s[28:31], s97 offen sc1
v_exp_f32 v188, v188
v_pk_add_f32 v[250:251], v[250:251], v[186:187]
v_exp_f32 v189, v189
v_cvt_pk_bf16_f32 v125, v186, v187
v_exp_f32 v190, v190
v_pk_add_f32 v[250:251], v[250:251], v[188:189]
v_exp_f32 v191, v191
v_cvt_pk_bf16_f32 v126, v188, v189
v_pk_add_f32 v[250:251], v[250:251], v[190:191]
v_cvt_pk_bf16_f32 v127, v190, v191
v_add_f32 v247, v250, v251
s_waitcnt lgkmcnt(0)
v_mfma_f32_16x16x32_bf16 v[176:179], a[0:3], v[0:3], 0
v_mov_b32 v249, v247
v_mfma_f32_16x16x32_bf16 v[176:179], a[4:7], v[4:7], v[176:179]
ds_read_b64_tr_b16 a[32:33], v233 offset:0
v_permlane32_swap_b32 v247, v249
v_mfma_f32_16x16x32_bf16 v[176:179], a[8:11], v[8:11], v[176:179]
ds_read_b64_tr_b16 a[34:35], v233 offset:2048
v_add_f32 v247, v247, v249
v_mfma_f32_16x16x32_bf16 v[176:179], a[12:15], v[12:15], v[176:179]
s_xor_b32 s97, s40, 128
s_waitcnt vmcnt(7)
buffer_store_dwordx4 a[160:163], v230, s[28:31], s97 offen sc1
v_mfma_f32_16x16x32_bf16 v[176:179], a[16:19], v[16:19], v[176:179]
ds_read_b64_tr_b16 a[36:37], v233 offset:4096
v_mov_b32 v249, v247
v_mfma_f32_16x16x32_bf16 v[176:179], a[20:23], v[20:23], v[176:179]
ds_read_b64_tr_b16 a[38:39], v233 offset:6144
v_permlane16_swap_b32 v247, v249
v_mfma_f32_16x16x32_bf16 v[176:179], a[24:27], v[24:27], v[176:179]
v_mfma_f32_16x16x32_bf16 v[176:179], a[28:31], v[28:31], v[176:179]
ds_read_b64_tr_b16 a[40:41], v233 offset:8192
v_add_f32 v247, v247, v249
v_mfma_f32_16x16x32_bf16 v[180:183], a[0:3], v[32:35], 0
ds_read_b64_tr_b16 a[42:43], v233 offset:10240
v_rcp_f32 v247, v247
v_mfma_f32_16x16x32_bf16 v[180:183], a[4:7], v[36:39], v[180:183]
v_mfma_f32_16x16x32_bf16 v[180:183], a[8:11], v[40:43], v[180:183]
ds_read_b64_tr_b16 a[44:45], v233 offset:12288
v_mfma_f32_16x16x32_bf16 v[180:183], a[12:15], v[44:47], v[180:183]
s_xor_b32 s97, s40, 8320
s_waitcnt vmcnt(7)
buffer_store_dwordx4 a[164:167], v230, s[28:31], s97 offen sc1
ds_read_b64_tr_b16 a[46:47], v233 offset:14336
v_mul_f32 v176, v244, v176
v_mfma_f32_16x16x32_bf16 v[180:183], a[16:19], v[48:51], v[180:183]
v_mul_f32 v177, v244, v177
v_mfma_f32_16x16x32_bf16 v[180:183], a[20:23], v[52:55], v[180:183]
ds_read_b64_tr_b16 a[48:49], v233 offset:16384
v_mul_f32 v178, v244, v178
v_mfma_f32_16x16x32_bf16 v[180:183], a[24:27], v[56:59], v[180:183]
ds_read_b64_tr_b16 a[50:51], v233 offset:18432
v_mul_f32 v179, v244, v179
v_mfma_f32_16x16x32_bf16 v[180:183], a[28:31], v[60:63], v[180:183]
v_cvt_pk_bf16_f32 v152, v176, v177
v_mfma_f32_16x16x32_bf16 v[184:187], a[0:3], v[64:67], 0
ds_read_b64_tr_b16 a[52:53], v233 offset:20480
v_cvt_pk_bf16_f32 v153, v178, v179
v_mfma_f32_16x16x32_bf16 v[184:187], a[4:7], v[68:71], v[184:187]
ds_read_b64_tr_b16 a[54:55], v233 offset:22528
v_mfma_f32_16x16x32_bf16 v[184:187], a[8:11], v[72:75], v[184:187]
s_xor_b32 s97, s40, 16512
s_waitcnt vmcnt(7)
buffer_store_dwordx4 a[168:171], v230, s[28:31], s97 offen sc1
v_mfma_f32_16x16x32_bf16 v[184:187], a[12:15], v[76:79], v[184:187]
ds_read_b64_tr_b16 a[56:57], v233 offset:24576
v_mul_f32 v180, v245, v180
v_mfma_f32_16x16x32_bf16 v[184:187], a[16:19], v[80:83], v[184:187]
ds_read_b64_tr_b16 a[58:59], v233 offset:26624
v_mul_f32 v181, v245, v181
v_mfma_f32_16x16x32_bf16 v[184:187], a[20:23], v[84:87], v[184:187]
v_mul_f32 v182, v245, v182
v_mfma_f32_16x16x32_bf16 v[184:187], a[24:27], v[88:91], v[184:187]
ds_read_b64_tr_b16 a[60:61], v233 offset:28672
v_mul_f32 v183, v245, v183
v_mfma_f32_16x16x32_bf16 v[184:187], a[28:31], v[92:95], v[184:187]
s_waitcnt lgkmcnt(8)
ds_read_b64_tr_b16 a[62:63], v233 offset:30720
v_cvt_pk_bf16_f32 v158, v180, v181
v_mfma_f32_16x16x32_bf16 v[188:191], a[0:3], v[96:99], 0
v_cvt_pk_bf16_f32 v159, v182, v183
v_mfma_f32_16x16x32_bf16 v[188:191], a[4:7], v[100:103], v[188:191]
v_mfma_f32_16x16x32_bf16 v[188:191], a[8:11], v[104:107], v[188:191]
s_xor_b32 s97, s40, 24704
s_waitcnt vmcnt(7)
buffer_store_dwordx4 a[172:175], v230, s[28:31], s97 offen sc1
v_mfma_f32_16x16x32_bf16 v[188:191], a[12:15], v[108:111], v[188:191]
v_mul_f32 v184, v246, v184
v_mfma_f32_16x16x32_bf16 v[188:191], a[16:19], v[112:115], v[188:191]
v_mul_f32 v185, v246, v185
v_mfma_f32_16x16x32_bf16 v[188:191], a[20:23], v[116:119], v[188:191]
v_mul_f32 v186, v246, v186
v_mfma_f32_16x16x32_bf16 v[188:191], a[24:27], v[120:123], v[188:191]
v_mul_f32 v187, v246, v187
v_mfma_f32_16x16x32_bf16 v[188:191], a[28:31], v[124:127], v[188:191]
v_cvt_pk_bf16_f32 v164, v184, v185
s_waitcnt lgkmcnt(0)
v_mfma_f32_16x16x32_bf16 v[176:179], a[32:35], v[0:3], 0
v_cvt_pk_bf16_f32 v165, v186, v187
v_mfma_f32_16x16x32_bf16 v[176:179], a[36:39], v[4:7], v[176:179]
s_xor_b32 s97, s40, 4224
s_waitcnt vmcnt(7)
buffer_store_dwordx4 a[176:179], v230, s[28:31], s97 offen sc1
ds_read_b64_tr_b16 a[0:1], v234 offset:0
v_mfma_f32_16x16x32_bf16 v[176:179], a[40:43], v[8:11], v[176:179]
ds_read_b64_tr_b16 a[2:3], v234 offset:2048
v_mfma_f32_16x16x32_bf16 v[176:179], a[44:47], v[12:15], v[176:179]
v_mul_f32 v188, v247, v188
v_mfma_f32_16x16x32_bf16 v[176:179], a[48:51], v[16:19], v[176:179]
ds_read_b64_tr_b16 a[4:5], v234 offset:4096
v_mul_f32 v189, v247, v189
v_mfma_f32_16x16x32_bf16 v[176:179], a[52:55], v[20:23], v[176:179]
ds_read_b64_tr_b16 a[6:7], v234 offset:6144
v_mul_f32 v190, v247, v190
v_mfma_f32_16x16x32_bf16 v[176:179], a[56:59], v[24:27], v[176:179]
v_mul_f32 v191, v247, v191
v_mfma_f32_16x16x32_bf16 v[176:179], a[60:63], v[28:31], v[176:179]
ds_read_b64_tr_b16 a[8:9], v234 offset:8192
v_cvt_pk_bf16_f32 v170, v188, v189
v_mfma_f32_16x16x32_bf16 v[180:183], a[32:35], v[32:35], 0
ds_read_b64_tr_b16 a[10:11], v234 offset:10240
v_cvt_pk_bf16_f32 v171, v190, v191
v_mfma_f32_16x16x32_bf16 v[180:183], a[36:39], v[36:39], v[180:183]
s_xor_b32 s97, s40, 12416
s_waitcnt vmcnt(7)
buffer_store_dwordx4 a[180:183], v230, s[28:31], s97 offen sc1
v_mfma_f32_16x16x32_bf16 v[180:183], a[40:43], v[40:43], v[180:183]
ds_read_b64_tr_b16 a[12:13], v234 offset:12288
v_mfma_f32_16x16x32_bf16 v[180:183], a[44:47], v[44:47], v[180:183]
ds_read_b64_tr_b16 a[14:15], v234 offset:14336
v_mul_f32 v176, v244, v176
v_mfma_f32_16x16x32_bf16 v[180:183], a[48:51], v[48:51], v[180:183]
v_mul_f32 v177, v244, v177
v_mfma_f32_16x16x32_bf16 v[180:183], a[52:55], v[52:55], v[180:183]
ds_read_b64_tr_b16 a[16:17], v234 offset:16384
v_mul_f32 v178, v244, v178
v_mfma_f32_16x16x32_bf16 v[180:183], a[56:59], v[56:59], v[180:183]
ds_read_b64_tr_b16 a[18:19], v234 offset:18432
v_mul_f32 v179, v244, v179
v_mfma_f32_16x16x32_bf16 v[180:183], a[60:63], v[60:63], v[180:183]
v_cvt_pk_bf16_f32 v154, v176, v177
v_mfma_f32_16x16x32_bf16 v[184:187], a[32:35], v[64:67], 0
s_xor_b32 s97, s40, 20608
s_waitcnt vmcnt(7)
buffer_store_dwordx4 a[184:187], v230, s[28:31], s97 offen sc1
ds_read_b64_tr_b16 a[20:21], v234 offset:20480
v_cvt_pk_bf16_f32 v155, v178, v179
v_mfma_f32_16x16x32_bf16 v[184:187], a[36:39], v[68:71], v[184:187]
ds_read_b64_tr_b16 a[22:23], v234 offset:22528
v_mfma_f32_16x16x32_bf16 v[184:187], a[40:43], v[72:75], v[184:187]
v_mfma_f32_16x16x32_bf16 v[184:187], a[44:47], v[76:79], v[184:187]
ds_read_b64_tr_b16 a[24:25], v234 offset:24576
v_mul_f32 v180, v245, v180
v_mfma_f32_16x16x32_bf16 v[184:187], a[48:51], v[80:83], v[184:187]
ds_read_b64_tr_b16 a[26:27], v234 offset:26624
v_mul_f32 v181, v245, v181
v_mfma_f32_16x16x32_bf16 v[184:187], a[52:55], v[84:87], v[184:187]
v_mul_f32 v182, v245, v182
v_mfma_f32_16x16x32_bf16 v[184:187], a[56:59], v[88:91], v[184:187]
ds_read_b64_tr_b16 a[28:29], v234 offset:28672
v_mul_f32 v183, v245, v183
v_mfma_f32_16x16x32_bf16 v[184:187], a[60:63], v[92:95], v[184:187]
s_waitcnt lgkmcnt(8)
ds_read_b64_tr_b16 a[30:31], v234 offset:30720
v_cvt_pk_bf16_f32 v160, v180, v181
v_mfma_f32_16x16x32_bf16 v[188:191], a[32:35], v[96:99], 0
s_xor_b32 s97, s40, 28800
s_waitcnt vmcnt(7)
buffer_store_dwordx4 a[188:191], v230, s[28:31], s97 offen sc1
v_cvt_pk_bf16_f32 v161, v182, v183
v_mfma_f32_16x16x32_bf16 v[188:191], a[36:39], v[100:103], v[188:191]
v_mfma_f32_16x16x32_bf16 v[188:191], a[40:43], v[104:107], v[188:191]
v_mfma_f32_16x16x32_bf16 v[188:191], a[44:47], v[108:111], v[188:191]
v_mul_f32 v184, v246, v184
v_mfma_f32_16x16x32_bf16 v[188:191], a[48:51], v[112:115], v[188:191]
v_mul_f32 v185, v246, v185
v_mfma_f32_16x16x32_bf16 v[188:191], a[52:55], v[116:119], v[188:191]
v_mul_f32 v186, v246, v186
v_mfma_f32_16x16x32_bf16 v[188:191], a[56:59], v[120:123], v[188:191]
v_mul_f32 v187, v246, v187
v_mfma_f32_16x16x32_bf16 v[188:191], a[60:63], v[124:127], v[188:191]
s_xor_b32 s97, s40, 256
s_waitcnt vmcnt(7)
buffer_store_dwordx4 a[192:195], v230, s[28:31], s97 offen sc1
v_cvt_pk_bf16_f32 v166, v184, v185
s_waitcnt lgkmcnt(0)
v_mfma_f32_16x16x32_bf16 v[176:179], a[0:3], v[0:3], 0
v_cvt_pk_bf16_f32 v167, v186, v187
v_mfma_f32_16x16x32_bf16 v[176:179], a[4:7], v[4:7], v[176:179]
ds_read_b64_tr_b16 a[32:33], v235 offset:0
v_mfma_f32_16x16x32_bf16 v[176:179], a[8:11], v[8:11], v[176:179]
ds_read_b64_tr_b16 a[34:35], v235 offset:2048
v_mfma_f32_16x16x32_bf16 v[176:179], a[12:15], v[12:15], v[176:179]
ds_read_b64_tr_b16 a[36:37], v235 offset:4096
v_mul_f32 v188, v247, v188
v_mfma_f32_16x16x32_bf16 v[176:179], a[16:19], v[16:19], v[176:179]
v_mul_f32 v189, v247, v189
v_mfma_f32_16x16x32_bf16 v[176:179], a[20:23], v[20:23], v[176:179]
ds_read_b64_tr_b16 a[38:39], v235 offset:6144
v_mul_f32 v190, v247, v190
v_mfma_f32_16x16x32_bf16 v[176:179], a[24:27], v[24:27], v[176:179]
ds_read_b64_tr_b16 a[40:41], v235 offset:8192
v_mul_f32 v191, v247, v191
v_mfma_f32_16x16x32_bf16 v[176:179], a[28:31], v[28:31], v[176:179]
s_xor_b32 s97, s40, 8448
s_waitcnt vmcnt(7)
buffer_store_dwordx4 a[196:199], v230, s[28:31], s97 offen sc1
v_cvt_pk_bf16_f32 v172, v188, v189
v_mfma_f32_16x16x32_bf16 v[180:183], a[0:3], v[32:35], 0
ds_read_b64_tr_b16 a[42:43], v235 offset:10240
v_cvt_pk_bf16_f32 v173, v190, v191
v_mfma_f32_16x16x32_bf16 v[180:183], a[4:7], v[36:39], v[180:183]
ds_read_b64_tr_b16 a[44:45], v235 offset:12288
v_mfma_f32_16x16x32_bf16 v[180:183], a[8:11], v[40:43], v[180:183]
ds_read_b64_tr_b16 a[46:47], v235 offset:14336
v_mfma_f32_16x16x32_bf16 v[180:183], a[12:15], v[44:47], v[180:183]
v_mul_f32 v176, v244, v176
v_mfma_f32_16x16x32_bf16 v[180:183], a[16:19], v[48:51], v[180:183]
ds_read_b64_tr_b16 a[48:49], v235 offset:16384
v_mul_f32 v177, v244, v177
v_mfma_f32_16x16x32_bf16 v[180:183], a[20:23], v[52:55], v[180:183]
ds_read_b64_tr_b16 a[50:51], v235 offset:18432
v_mul_f32 v178, v244, v178
v_mfma_f32_16x16x32_bf16 v[180:183], a[24:27], v[56:59], v[180:183]
s_xor_b32 s97, s40, 16640
s_waitcnt vmcnt(7)
buffer_store_dwordx4 a[200:203], v230, s[28:31], s97 offen sc1
v_mul_f32 v179, v244, v179
v_mfma_f32_16x16x32_bf16 v[180:183], a[28:31], v[60:63], v[180:183]
ds_read_b64_tr_b16 a[52:53], v235 offset:20480
v_cvt_pk_bf16_f32 v156, v176, v177
v_mfma_f32_16x16x32_bf16 v[184:187], a[0:3], v[64:67], 0
ds_read_b64_tr_b16 a[54:55], v235 offset:22528
v_cvt_pk_bf16_f32 v157, v178, v179
v_mfma_f32_16x16x32_bf16 v[184:187], a[4:7], v[68:71], v[184:187]
ds_read_b64_tr_b16 a[56:57], v235 offset:24576
v_mfma_f32_16x16x32_bf16 v[184:187], a[8:11], v[72:75], v[184:187]
v_mfma_f32_16x16x32_bf16 v[184:187], a[12:15], v[76:79], v[184:187]
ds_read_b64_tr_b16 a[58:59], v235 offset:26624
v_mul_f32 v180, v245, v180
v_mfma_f32_16x16x32_bf16 v[184:187], a[16:19], v[80:83], v[184:187]
ds_read_b64_tr_b16 a[60:61], v235 offset:28672
v_mul_f32 v181, v245, v181
v_mfma_f32_16x16x32_bf16 v[184:187], a[20:23], v[84:87], v[184:187]
v_mul_f32 v182, v245, v182
v_mfma_f32_16x16x32_bf16 v[184:187], a[24:27], v[88:91], v[184:187]
s_xor_b32 s97, s40, 24832
s_waitcnt vmcnt(7)
buffer_store_dwordx4 a[204:207], v230, s[28:31], s97 offen sc1
s_waitcnt lgkmcnt(8)
ds_read_b64_tr_b16 a[62:63], v235 offset:30720
v_mul_f32 v183, v245, v183
v_mfma_f32_16x16x32_bf16 v[184:187], a[28:31], v[92:95], v[184:187]
v_cvt_pk_bf16_f32 v162, v180, v181
v_mfma_f32_16x16x32_bf16 v[188:191], a[0:3], v[96:99], 0
v_cvt_pk_bf16_f32 v163, v182, v183
v_mfma_f32_16x16x32_bf16 v[188:191], a[4:7], v[100:103], v[188:191]
v_mfma_f32_16x16x32_bf16 v[188:191], a[8:11], v[104:107], v[188:191]
v_mfma_f32_16x16x32_bf16 v[188:191], a[12:15], v[108:111], v[188:191]
s_nop 1
v_mul_f32 v184, v246, v184
v_mfma_f32_16x16x32_bf16 v[188:191], a[16:19], v[112:115], v[188:191]
v_mul_f32 v185, v246, v185
v_mfma_f32_16x16x32_bf16 v[188:191], a[20:23], v[116:119], v[188:191]
s_xor_b32 s97, s40, 4352
s_waitcnt vmcnt(7)
buffer_store_dwordx4 a[208:211], v230, s[28:31], s97 offen sc1
v_mul_f32 v186, v246, v186
v_mfma_f32_16x16x32_bf16 v[188:191], a[24:27], v[120:123], v[188:191]
v_mul_f32 v187, v246, v187
v_mfma_f32_16x16x32_bf16 v[188:191], a[28:31], v[124:127], v[188:191]
v_cvt_pk_bf16_f32 v168, v184, v185
s_waitcnt lgkmcnt(0)
v_mfma_f32_16x16x32_bf16 v[176:179], a[32:35], v[0:3], 0
v_cvt_pk_bf16_f32 v169, v186, v187
s_barrier
v_add_u32 v232, 0, v227
v_xor_b32 v233, 32, v232
v_xor_b32 v234, 64, v232
v_xor_b32 v235, 96, v232
v_mfma_f32_16x16x32_bf16 v[176:179], a[36:39], v[4:7], v[176:179]
ds_read_b64_tr_b16 a[0:1], v232 offset:0
v_mfma_f32_16x16x32_bf16 v[176:179], a[40:43], v[8:11], v[176:179]
ds_read_b64_tr_b16 a[2:3], v232 offset:2048
v_mfma_f32_16x16x32_bf16 v[176:179], a[44:47], v[12:15], v[176:179]
v_mul_f32 v188, v247, v188
v_mfma_f32_16x16x32_bf16 v[176:179], a[48:51], v[16:19], v[176:179]
ds_read_b64_tr_b16 a[4:5], v232 offset:4096
v_mul_f32 v189, v247, v189
v_mfma_f32_16x16x32_bf16 v[176:179], a[52:55], v[20:23], v[176:179]
s_xor_b32 s97, s40, 12544
s_waitcnt vmcnt(7)
buffer_store_dwordx4 a[212:215], v230, s[28:31], s97 offen sc1
ds_read_b64_tr_b16 a[6:7], v232 offset:6144
v_mul_f32 v190, v247, v190
v_mfma_f32_16x16x32_bf16 v[176:179], a[56:59], v[24:27], v[176:179]
v_mul_f32 v191, v247, v191
v_add_u32 v238, 98304, v228
v_xor_b32 v239, 32, v238
v_xor_b32 v240, 64, v238
v_xor_b32 v241, 96, v238
v_mfma_f32_16x16x32_bf16 v[176:179], a[60:63], v[28:31], v[176:179]
ds_read_b64_tr_b16 a[8:9], v232 offset:8192
v_cvt_pk_bf16_f32 v174, v188, v189
v_mfma_f32_16x16x32_bf16 v[180:183], a[32:35], v[32:35], 0
ds_read_b64_tr_b16 a[10:11], v232 offset:10240
v_cvt_pk_bf16_f32 v175, v190, v191
v_mfma_f32_16x16x32_bf16 v[180:183], a[36:39], v[36:39], v[180:183]
v_mfma_f32_16x16x32_bf16 v[180:183], a[40:43], v[40:43], v[180:183]
ds_read_b64_tr_b16 a[12:13], v232 offset:12288
v_mfma_f32_16x16x32_bf16 v[180:183], a[44:47], v[44:47], v[180:183]
ds_read_b64_tr_b16 a[14:15], v232 offset:14336
v_mul_f32 v176, v244, v176
v_mfma_f32_16x16x32_bf16 v[180:183], a[48:51], v[48:51], v[180:183]
s_xor_b32 s97, s40, 20736
s_waitcnt vmcnt(7)
buffer_store_dwordx4 a[216:219], v230, s[28:31], s97 offen sc1
ds_write_b64 v238, v[152:153] offset:0
v_mul_f32 v177, v244, v177
v_mfma_f32_16x16x32_bf16 v[180:183], a[52:55], v[52:55], v[180:183]
ds_write_b64 v239, v[154:155] offset:0
ds_read_b64_tr_b16 a[16:17], v232 offset:16384
v_mul_f32 v178, v244, v178
v_mfma_f32_16x16x32_bf16 v[180:183], a[56:59], v[56:59], v[180:183]
ds_read_b64_tr_b16 a[18:19], v232 offset:18432
v_mul_f32 v179, v244, v179
v_mfma_f32_16x16x32_bf16 v[180:183], a[60:63], v[60:63], v[180:183]
ds_write_b64 v240, v[156:157] offset:0
v_cvt_pk_bf16_f32 v176, v176, v177
v_mfma_f32_16x16x32_bf16 v[184:187], a[32:35], v[64:67], 0
ds_read_b64_tr_b16 a[20:21], v232 offset:20480
v_cvt_pk_bf16_f32 v177, v178, v179
v_mfma_f32_16x16x32_bf16 v[184:187], a[36:39], v[68:71], v[184:187]
ds_write_b64 v241, v[176:177] offset:0
s_waitcnt lgkmcnt(8)
ds_read_b64_tr_b16 a[22:23], v232 offset:22528
v_mfma_f32_16x16x32_bf16 v[184:187], a[40:43], v[72:75], v[184:187]
v_mfma_f32_16x16x32_bf16 v[184:187], a[44:47], v[76:79], v[184:187]
ds_read_b64_tr_b16 a[24:25], v232 offset:24576
v_mul_f32 v180, v245, v180
v_mfma_f32_16x16x32_bf16 v[184:187], a[48:51], v[80:83], v[184:187]
s_xor_b32 s97, s40, 28928
s_waitcnt vmcnt(7)
buffer_store_dwordx4 a[220:223], v230, s[28:31], s97 offen sc1
ds_write_b64 v238, v[158:159] offset:8192
ds_read_b64_tr_b16 a[26:27], v232 offset:26624
v_mul_f32 v181, v245, v181
v_mfma_f32_16x16x32_bf16 v[184:187], a[52:55], v[84:87], v[184:187]
ds_write_b64 v239, v[160:161] offset:8192
v_mul_f32 v182, v245, v182
v_mfma_f32_16x16x32_bf16 v[184:187], a[56:59], v[88:91], v[184:187]
ds_read_b64_tr_b16 a[28:29], v232 offset:28672
v_mul_f32 v183, v245, v183
v_mfma_f32_16x16x32_bf16 v[184:187], a[60:63], v[92:95], v[184:187]
ds_write_b64 v240, v[162:163] offset:8192
s_waitcnt lgkmcnt(8)
ds_read_b64_tr_b16 a[30:31], v232 offset:30720
v_cvt_pk_bf16_f32 v180, v180, v181
v_mfma_f32_16x16x32_bf16 v[188:191], a[32:35], v[96:99], 0
v_cvt_pk_bf16_f32 v181, v182, v183
v_mfma_f32_16x16x32_bf16 v[188:191], a[36:39], v[100:103], v[188:191]
ds_write_b64 v241, v[180:181] offset:8192
v_mfma_f32_16x16x32_bf16 v[188:191], a[40:43], v[104:107], v[188:191]
v_mfma_f32_16x16x32_bf16 v[188:191], a[44:47], v[108:111], v[188:191]
s_xor_b32 s97, s40, 384
s_waitcnt vmcnt(7)
buffer_store_dwordx4 a[224:227], v230, s[28:31], s97 offen sc1
v_mul_f32 v184, v246, v184
v_mfma_f32_16x16x32_bf16 v[188:191], a[48:51], v[112:115], v[188:191]
ds_write_b64 v238, v[164:165] offset:16384
v_mul_f32 v185, v246, v185
v_mfma_f32_16x16x32_bf16 v[188:191], a[52:55], v[116:119], v[188:191]
ds_write_b64 v239, v[166:167] offset:16384
v_mul_f32 v186, v246, v186
v_mfma_f32_16x16x32_bf16 v[188:191], a[56:59], v[120:123], v[188:191]
v_mul_f32 v187, v246, v187
v_mfma_f32_16x16x32_bf16 v[188:191], a[60:63], v[124:127], v[188:191]
ds_write_b64 v240, v[168:169] offset:16384
v_cvt_pk_bf16_f32 v184, v184, v185
s_waitcnt lgkmcnt(4)
v_mfma_f32_16x16x32_bf16 v[176:179], a[0:3], v[0:3], 0
v_cvt_pk_bf16_f32 v185, v186, v187
v_mfma_f32_16x16x32_bf16 v[176:179], a[4:7], v[4:7], v[176:179]
ds_write_b64 v241, v[184:185] offset:16384
ds_read_b64_tr_b16 a[32:33], v233 offset:0
v_mfma_f32_16x16x32_bf16 v[176:179], a[8:11], v[8:11], v[176:179]
ds_read_b64_tr_b16 a[34:35], v233 offset:2048
v_mfma_f32_16x16x32_bf16 v[176:179], a[12:15], v[12:15], v[176:179]
s_xor_b32 s97, s40, 8576
s_waitcnt vmcnt(7)
buffer_store_dwordx4 a[228:231], v230, s[28:31], s97 offen sc1
v_mul_f32 v188, v247, v188
v_mfma_f32_16x16x32_bf16 v[176:179], a[16:19], v[16:19], v[176:179]
ds_write_b64 v238, v[170:171] offset:24576
ds_read_b64_tr_b16 a[36:37], v233 offset:4096
v_mul_f32 v189, v247, v189
v_mfma_f32_16x16x32_bf16 v[176:179], a[20:23], v[20:23], v[176:179]
ds_write_b64 v239, v[172:173] offset:24576
ds_read_b64_tr_b16 a[38:39], v233 offset:6144
v_mul_f32 v190, v247, v190
v_mfma_f32_16x16x32_bf16 v[176:179], a[24:27], v[24:27], v[176:179]
v_mul_f32 v191, v247, v191
v_mfma_f32_16x16x32_bf16 v[176:179], a[28:31], v[28:31], v[176:179]
ds_write_b64 v240, v[174:175] offset:24576
ds_read_b64_tr_b16 a[40:41], v233 offset:8192
v_cvt_pk_bf16_f32 v188, v188, v189
v_mfma_f32_16x16x32_bf16 v[180:183], a[0:3], v[32:35], 0
ds_read_b64_tr_b16 a[42:43], v233 offset:10240
v_cvt_pk_bf16_f32 v189, v190, v191
v_mfma_f32_16x16x32_bf16 v[180:183], a[4:7], v[36:39], v[180:183]
ds_write_b64 v241, v[188:189] offset:24576
v_mfma_f32_16x16x32_bf16 v[180:183], a[8:11], v[40:43], v[180:183]
v_add_u32 v242, 98304, v229
s_waitcnt lgkmcnt(8)
ds_read_b128 a[128:131], v242 offset:0
ds_read_b128 a[132:135], v242 offset:4096
ds_read_b128 a[136:139], v242 offset:8192
ds_read_b128 a[140:143], v242 offset:12288
ds_read_b128 a[144:147], v242 offset:16384
ds_read_b128 a[148:151], v242 offset:20480
ds_read_b128 a[152:155], v242 offset:24576
s_waitcnt lgkmcnt(8)
ds_read_b128 a[156:159], v242 offset:28672
ds_read_b64_tr_b16 a[44:45], v233 offset:12288
v_mfma_f32_16x16x32_bf16 v[180:183], a[12:15], v[44:47], v[180:183]
s_xor_b32 s97, s40, 16768
s_waitcnt vmcnt(7)
buffer_store_dwordx4 a[232:235], v230, s[28:31], s97 offen sc1
ds_read_b64_tr_b16 a[46:47], v233 offset:14336
v_mul_f32 v176, v244, v176
v_mfma_f32_16x16x32_bf16 v[180:183], a[16:19], v[48:51], v[180:183]
v_mul_f32 v177, v244, v177
v_mfma_f32_16x16x32_bf16 v[180:183], a[20:23], v[52:55], v[180:183]
ds_read_b64_tr_b16 a[48:49], v233 offset:16384
v_mul_f32 v178, v244, v178
v_mfma_f32_16x16x32_bf16 v[180:183], a[24:27], v[56:59], v[180:183]
ds_read_b64_tr_b16 a[50:51], v233 offset:18432
v_mul_f32 v179, v244, v179
v_mfma_f32_16x16x32_bf16 v[180:183], a[28:31], v[60:63], v[180:183]
v_cvt_pk_bf16_f32 v152, v176, v177
v_mfma_f32_16x16x32_bf16 v[184:187], a[0:3], v[64:67], 0
ds_read_b64_tr_b16 a[52:53], v233 offset:20480
v_cvt_pk_bf16_f32 v153, v178, v179
v_mfma_f32_16x16x32_bf16 v[184:187], a[4:7], v[68:71], v[184:187]
ds_read_b64_tr_b16 a[54:55], v233 offset:22528
v_mfma_f32_16x16x32_bf16 v[184:187], a[8:11], v[72:75], v[184:187]
s_xor_b32 s97, s40, 24960
s_waitcnt vmcnt(7)
buffer_store_dwordx4 a[236:239], v230, s[28:31], s97 offen sc1
v_mfma_f32_16x16x32_bf16 v[184:187], a[12:15], v[76:79], v[184:187]
s_waitcnt lgkmcnt(8)
ds_read_b64_tr_b16 a[56:57], v233 offset:24576
v_mul_f32 v180, v245, v180
v_mfma_f32_16x16x32_bf16 v[184:187], a[16:19], v[80:83], v[184:187]
ds_read_b64_tr_b16 a[58:59], v233 offset:26624
v_mul_f32 v181, v245, v181
v_mfma_f32_16x16x32_bf16 v[184:187], a[20:23], v[84:87], v[184:187]
v_mul_f32 v182, v245, v182
v_mfma_f32_16x16x32_bf16 v[184:187], a[24:27], v[88:91], v[184:187]
ds_read_b64_tr_b16 a[60:61], v233 offset:28672
v_mul_f32 v183, v245, v183
v_mfma_f32_16x16x32_bf16 v[184:187], a[28:31], v[92:95], v[184:187]
ds_read_b64_tr_b16 a[62:63], v233 offset:30720
v_cvt_pk_bf16_f32 v158, v180, v181
v_mfma_f32_16x16x32_bf16 v[188:191], a[0:3], v[96:99], 0
v_cvt_pk_bf16_f32 v159, v182, v183
v_mfma_f32_16x16x32_bf16 v[188:191], a[4:7], v[100:103], v[188:191]
v_mfma_f32_16x16x32_bf16 v[188:191], a[8:11], v[104:107], v[188:191]
s_xor_b32 s97, s40, 4480
s_waitcnt vmcnt(7)
buffer_store_dwordx4 a[240:243], v230, s[28:31], s97 offen sc1
v_mfma_f32_16x16x32_bf16 v[188:191], a[12:15], v[108:111], v[188:191]
v_mul_f32 v184, v246, v184
v_mfma_f32_16x16x32_bf16 v[188:191], a[16:19], v[112:115], v[188:191]
v_mul_f32 v185, v246, v185
v_mfma_f32_16x16x32_bf16 v[188:191], a[20:23], v[116:119], v[188:191]
v_mul_f32 v186, v246, v186
v_mfma_f32_16x16x32_bf16 v[188:191], a[24:27], v[120:123], v[188:191]
v_mul_f32 v187, v246, v187
v_mfma_f32_16x16x32_bf16 v[188:191], a[28:31], v[124:127], v[188:191]
v_cvt_pk_bf16_f32 v164, v184, v185
s_waitcnt lgkmcnt(0)
v_mfma_f32_16x16x32_bf16 v[176:179], a[32:35], v[0:3], 0
v_cvt_pk_bf16_f32 v165, v186, v187
v_mfma_f32_16x16x32_bf16 v[176:179], a[36:39], v[4:7], v[176:179]
ds_read_b64_tr_b16 a[0:1], v234 offset:0
v_mfma_f32_16x16x32_bf16 v[176:179], a[40:43], v[8:11], v[176:179]
s_xor_b32 s97, s40, 12672
s_waitcnt vmcnt(7)
buffer_store_dwordx4 a[244:247], v230, s[28:31], s97 offen sc1
ds_read_b64_tr_b16 a[2:3], v234 offset:2048
v_mfma_f32_16x16x32_bf16 v[176:179], a[44:47], v[12:15], v[176:179]
v_mul_f32 v188, v247, v188
v_mfma_f32_16x16x32_bf16 v[176:179], a[48:51], v[16:19], v[176:179]
ds_read_b64_tr_b16 a[4:5], v234 offset:4096
v_mul_f32 v189, v247, v189
v_mfma_f32_16x16x32_bf16 v[176:179], a[52:55], v[20:23], v[176:179]
ds_read_b64_tr_b16 a[6:7], v234 offset:6144
v_mul_f32 v190, v247, v190
v_mfma_f32_16x16x32_bf16 v[176:179], a[56:59], v[24:27], v[176:179]
v_mul_f32 v191, v247, v191
v_mfma_f32_16x16x32_bf16 v[176:179], a[60:63], v[28:31], v[176:179]
ds_read_b64_tr_b16 a[8:9], v234 offset:8192
v_cvt_pk_bf16_f32 v170, v188, v189
v_mfma_f32_16x16x32_bf16 v[180:183], a[32:35], v[32:35], 0
ds_read_b64_tr_b16 a[10:11], v234 offset:10240
v_cvt_pk_bf16_f32 v171, v190, v191
v_mfma_f32_16x16x32_bf16 v[180:183], a[36:39], v[36:39], v[180:183]
v_mfma_f32_16x16x32_bf16 v[180:183], a[40:43], v[40:43], v[180:183]
s_xor_b32 s97, s40, 20864
s_waitcnt vmcnt(7)
buffer_store_dwordx4 a[248:251], v230, s[28:31], s97 offen sc1
ds_read_b64_tr_b16 a[12:13], v234 offset:12288
v_mfma_f32_16x16x32_bf16 v[180:183], a[44:47], v[44:47], v[180:183]
ds_read_b64_tr_b16 a[14:15], v234 offset:14336
v_mul_f32 v176, v244, v176
v_mfma_f32_16x16x32_bf16 v[180:183], a[48:51], v[48:51], v[180:183]
v_mul_f32 v177, v244, v177
v_mfma_f32_16x16x32_bf16 v[180:183], a[52:55], v[52:55], v[180:183]
ds_read_b64_tr_b16 a[16:17], v234 offset:16384
v_mul_f32 v178, v244, v178
v_mfma_f32_16x16x32_bf16 v[180:183], a[56:59], v[56:59], v[180:183]
ds_read_b64_tr_b16 a[18:19], v234 offset:18432
v_mul_f32 v179, v244, v179
v_mfma_f32_16x16x32_bf16 v[180:183], a[60:63], v[60:63], v[180:183]
v_cvt_pk_bf16_f32 v154, v176, v177
v_mfma_f32_16x16x32_bf16 v[184:187], a[32:35], v[64:67], 0
ds_read_b64_tr_b16 a[20:21], v234 offset:20480
v_cvt_pk_bf16_f32 v155, v178, v179
v_mfma_f32_16x16x32_bf16 v[184:187], a[36:39], v[68:71], v[184:187]
s_xor_b32 s97, s40, 29056
s_waitcnt vmcnt(7)
buffer_store_dwordx4 a[252:255], v230, s[28:31], s97 offen sc1
ds_read_b64_tr_b16 a[22:23], v234 offset:22528
v_mfma_f32_16x16x32_bf16 v[184:187], a[40:43], v[72:75], v[184:187]
v_mfma_f32_16x16x32_bf16 v[184:187], a[44:47], v[76:79], v[184:187]
ds_read_b64_tr_b16 a[24:25], v234 offset:24576
v_mul_f32 v180, v245, v180
v_mfma_f32_16x16x32_bf16 v[184:187], a[48:51], v[80:83], v[184:187]
ds_read_b64_tr_b16 a[26:27], v234 offset:26624
v_mul_f32 v181, v245, v181
v_mfma_f32_16x16x32_bf16 v[184:187], a[52:55], v[84:87], v[184:187]
v_mul_f32 v182, v245, v182
v_mfma_f32_16x16x32_bf16 v[184:187], a[56:59], v[88:91], v[184:187]
ds_read_b64_tr_b16 a[28:29], v234 offset:28672
v_mul_f32 v183, v245, v183
v_mfma_f32_16x16x32_bf16 v[184:187], a[60:63], v[92:95], v[184:187]
s_waitcnt lgkmcnt(8)
ds_read_b64_tr_b16 a[30:31], v234 offset:30720
v_cvt_pk_bf16_f32 v160, v180, v181
v_mfma_f32_16x16x32_bf16 v[188:191], a[32:35], v[96:99], 0
v_cvt_pk_bf16_f32 v161, v182, v183
v_mfma_f32_16x16x32_bf16 v[188:191], a[36:39], v[100:103], v[188:191]
s_xor_b32 s97, s41, 0
s_waitcnt vmcnt(7)
buffer_store_dwordx4 a[128:131], v230, s[28:31], s97 offen sc1
v_mfma_f32_16x16x32_bf16 v[188:191], a[40:43], v[104:107], v[188:191]
v_mfma_f32_16x16x32_bf16 v[188:191], a[44:47], v[108:111], v[188:191]
v_mul_f32 v184, v246, v184
v_mfma_f32_16x16x32_bf16 v[188:191], a[48:51], v[112:115], v[188:191]
v_mul_f32 v185, v246, v185
v_mfma_f32_16x16x32_bf16 v[188:191], a[52:55], v[116:119], v[188:191]
v_mul_f32 v186, v246, v186
v_mfma_f32_16x16x32_bf16 v[188:191], a[56:59], v[120:123], v[188:191]
v_mul_f32 v187, v246, v187
v_mfma_f32_16x16x32_bf16 v[188:191], a[60:63], v[124:127], v[188:191]
v_cvt_pk_bf16_f32 v166, v184, v185
s_waitcnt lgkmcnt(0)
v_mfma_f32_16x16x32_bf16 v[176:179], a[0:3], v[0:3], 0
v_cvt_pk_bf16_f32 v167, v186, v187
v_mfma_f32_16x16x32_bf16 v[176:179], a[4:7], v[4:7], v[176:179]
s_xor_b32 s97, s41, 8192
s_waitcnt vmcnt(7)
buffer_store_dwordx4 a[132:135], v230, s[28:31], s97 offen sc1
ds_read_b64_tr_b16 a[32:33], v235 offset:0
v_mfma_f32_16x16x32_bf16 v[176:179], a[8:11], v[8:11], v[176:179]
ds_read_b64_tr_b16 a[34:35], v235 offset:2048
v_mfma_f32_16x16x32_bf16 v[176:179], a[12:15], v[12:15], v[176:179]
ds_read_b64_tr_b16 a[36:37], v235 offset:4096
v_mul_f32 v188, v247, v188
v_mfma_f32_16x16x32_bf16 v[176:179], a[16:19], v[16:19], v[176:179]
v_mul_f32 v189, v247, v189
v_mfma_f32_16x16x32_bf16 v[176:179], a[20:23], v[20:23], v[176:179]
ds_read_b64_tr_b16 a[38:39], v235 offset:6144
v_mul_f32 v190, v247, v190
v_mfma_f32_16x16x32_bf16 v[176:179], a[24:27], v[24:27], v[176:179]
ds_read_b64_tr_b16 a[40:41], v235 offset:8192
v_mul_f32 v191, v247, v191
v_mfma_f32_16x16x32_bf16 v[176:179], a[28:31], v[28:31], v[176:179]
v_cvt_pk_bf16_f32 v172, v188, v189
v_mfma_f32_16x16x32_bf16 v[180:183], a[0:3], v[32:35], 0
ds_read_b64_tr_b16 a[42:43], v235 offset:10240
v_cvt_pk_bf16_f32 v173, v190, v191
v_mfma_f32_16x16x32_bf16 v[180:183], a[4:7], v[36:39], v[180:183]
s_xor_b32 s97, s41, 16384
s_waitcnt vmcnt(7)
buffer_store_dwordx4 a[136:139], v230, s[28:31], s97 offen sc1
ds_read_b64_tr_b16 a[44:45], v235 offset:12288
v_mfma_f32_16x16x32_bf16 v[180:183], a[8:11], v[40:43], v[180:183]
ds_read_b64_tr_b16 a[46:47], v235 offset:14336
v_mfma_f32_16x16x32_bf16 v[180:183], a[12:15], v[44:47], v[180:183]
v_mul_f32 v176, v244, v176
v_mfma_f32_16x16x32_bf16 v[180:183], a[16:19], v[48:51], v[180:183]
ds_read_b64_tr_b16 a[48:49], v235 offset:16384
v_mul_f32 v177, v244, v177
v_mfma_f32_16x16x32_bf16 v[180:183], a[20:23], v[52:55], v[180:183]
ds_read_b64_tr_b16 a[50:51], v235 offset:18432
v_mul_f32 v178, v244, v178
v_mfma_f32_16x16x32_bf16 v[180:183], a[24:27], v[56:59], v[180:183]
v_mul_f32 v179, v244, v179
v_mfma_f32_16x16x32_bf16 v[180:183], a[28:31], v[60:63], v[180:183]
ds_read_b64_tr_b16 a[52:53], v235 offset:20480
v_cvt_pk_bf16_f32 v156, v176, v177
v_mfma_f32_16x16x32_bf16 v[184:187], a[0:3], v[64:67], 0
s_xor_b32 s97, s41, 24576
s_waitcnt vmcnt(7)
buffer_store_dwordx4 a[140:143], v230, s[28:31], s97 offen sc1
ds_read_b64_tr_b16 a[54:55], v235 offset:22528
v_cvt_pk_bf16_f32 v157, v178, v179
v_mfma_f32_16x16x32_bf16 v[184:187], a[4:7], v[68:71], v[184:187]
ds_read_b64_tr_b16 a[56:57], v235 offset:24576
v_mfma_f32_16x16x32_bf16 v[184:187], a[8:11], v[72:75], v[184:187]
v_mfma_f32_16x16x32_bf16 v[184:187], a[12:15], v[76:79], v[184:187]
ds_read_b64_tr_b16 a[58:59], v235 offset:26624
v_mul_f32 v180, v245, v180
v_mfma_f32_16x16x32_bf16 v[184:187], a[16:19], v[80:83], v[184:187]
ds_read_b64_tr_b16 a[60:61], v235 offset:28672
v_mul_f32 v181, v245, v181
v_mfma_f32_16x16x32_bf16 v[184:187], a[20:23], v[84:87], v[184:187]
v_mul_f32 v182, v245, v182
v_mfma_f32_16x16x32_bf16 v[184:187], a[24:27], v[88:91], v[184:187]
s_waitcnt lgkmcnt(8)
ds_read_b64_tr_b16 a[62:63], v235 offset:30720
v_mul_f32 v183, v245, v183
v_mfma_f32_16x16x32_bf16 v[184:187], a[28:31], v[92:95], v[184:187]
v_cvt_pk_bf16_f32 v162, v180, v181
v_mfma_f32_16x16x32_bf16 v[188:191], a[0:3], v[96:99], 0
s_xor_b32 s97, s41, 4096
s_waitcnt vmcnt(7)
buffer_store_dwordx4 a[144:147], v230, s[28:31], s97 offen sc1
v_cvt_pk_bf16_f32 v163, v182, v183
v_mfma_f32_16x16x32_bf16 v[188:191], a[4:7], v[100:103], v[188:191]
v_mfma_f32_16x16x32_bf16 v[188:191], a[8:11], v[104:107], v[188:191]
v_mfma_f32_16x16x32_bf16 v[188:191], a[12:15], v[108:111], v[188:191]
v_mul_f32 v184, v246, v184
v_mfma_f32_16x16x32_bf16 v[188:191], a[16:19], v[112:115], v[188:191]
v_mul_f32 v185, v246, v185
v_mfma_f32_16x16x32_bf16 v[188:191], a[20:23], v[116:119], v[188:191]
v_mul_f32 v186, v246, v186
v_mfma_f32_16x16x32_bf16 v[188:191], a[24:27], v[120:123], v[188:191]
v_mul_f32 v187, v246, v187
v_mfma_f32_16x16x32_bf16 v[188:191], a[28:31], v[124:127], v[188:191]
v_cvt_pk_bf16_f32 v168, v184, v185
s_waitcnt lgkmcnt(0)
v_mfma_f32_16x16x32_bf16 v[176:179], a[32:35], v[0:3], 0
s_xor_b32 s97, s41, 12288
s_waitcnt vmcnt(7)
buffer_store_dwordx4 a[148:151], v230, s[28:31], s97 offen sc1
v_cvt_pk_bf16_f32 v169, v186, v187
s_barrier
v_add_u32 v232, 32768, v227
v_xor_b32 v233, 32, v232
v_xor_b32 v234, 64, v232
v_xor_b32 v235, 96, v232
v_mfma_f32_16x16x32_bf16 v[176:179], a[36:39], v[4:7], v[176:179]
ds_read_b64_tr_b16 a[0:1], v232 offset:0
v_mfma_f32_16x16x32_bf16 v[176:179], a[40:43], v[8:11], v[176:179]
ds_read_b64_tr_b16 a[2:3], v232 offset:2048
v_mfma_f32_16x16x32_bf16 v[176:179], a[44:47], v[12:15], v[176:179]
v_mul_f32 v188, v247, v188
v_mfma_f32_16x16x32_bf16 v[176:179], a[48:51], v[16:19], v[176:179]
ds_read_b64_tr_b16 a[4:5], v232 offset:4096
v_mul_f32 v189, v247, v189
v_mfma_f32_16x16x32_bf16 v[176:179], a[52:55], v[20:23], v[176:179]
ds_read_b64_tr_b16 a[6:7], v232 offset:6144
v_mul_f32 v190, v247, v190
v_mfma_f32_16x16x32_bf16 v[176:179], a[56:59], v[24:27], v[176:179]
v_mul_f32 v191, v247, v191
v_add_u32 v238, 0, v228
v_xor_b32 v239, 32, v238
v_xor_b32 v240, 64, v238
v_xor_b32 v241, 96, v238
v_mfma_f32_16x16x32_bf16 v[176:179], a[60:63], v[28:31], v[176:179]
ds_read_b64_tr_b16 a[8:9], v232 offset:8192
v_cvt_pk_bf16_f32 v174, v188, v189
v_mfma_f32_16x16x32_bf16 v[180:183], a[32:35], v[32:35], 0
s_xor_b32 s97, s41, 20480
s_waitcnt vmcnt(7)
buffer_store_dwordx4 a[152:155], v230, s[28:31], s97 offen sc1
ds_read_b64_tr_b16 a[10:11], v232 offset:10240
v_cvt_pk_bf16_f32 v175, v190, v191
v_mfma_f32_16x16x32_bf16 v[180:183], a[36:39], v[36:39], v[180:183]
v_mfma_f32_16x16x32_bf16 v[180:183], a[40:43], v[40:43], v[180:183]
ds_read_b64_tr_b16 a[12:13], v232 offset:12288
v_mfma_f32_16x16x32_bf16 v[180:183], a[44:47], v[44:47], v[180:183]
ds_read_b64_tr_b16 a[14:15], v232 offset:14336
v_mul_f32 v176, v244, v176
v_mfma_f32_16x16x32_bf16 v[180:183], a[48:51], v[48:51], v[180:183]
ds_write_b64 v238, v[152:153] offset:0
v_mul_f32 v177, v244, v177
v_mfma_f32_16x16x32_bf16 v[180:183], a[52:55], v[52:55], v[180:183]
ds_write_b64 v239, v[154:155] offset:0
ds_read_b64_tr_b16 a[16:17], v232 offset:16384
v_mul_f32 v178, v244, v178
v_mfma_f32_16x16x32_bf16 v[180:183], a[56:59], v[56:59], v[180:183]
ds_read_b64_tr_b16 a[18:19], v232 offset:18432
v_mul_f32 v179, v244, v179
v_mfma_f32_16x16x32_bf16 v[180:183], a[60:63], v[60:63], v[180:183]
s_xor_b32 s97, s41, 28672
s_waitcnt vmcnt(7)
buffer_store_dwordx4 a[156:159], v230, s[28:31], s97 offen sc1
ds_write_b64 v240, v[156:157] offset:0
v_cvt_pk_bf16_f32 v176, v176, v177
v_mfma_f32_16x16x32_bf16 v[184:187], a[32:35], v[64:67], 0
ds_read_b64_tr_b16 a[20:21], v232 offset:20480
v_cvt_pk_bf16_f32 v177, v178, v179
v_mfma_f32_16x16x32_bf16 v[184:187], a[36:39], v[68:71], v[184:187]
ds_write_b64 v241, v[176:177] offset:0
s_waitcnt lgkmcnt(8)
ds_read_b64_tr_b16 a[22:23], v232 offset:22528
v_mfma_f32_16x16x32_bf16 v[184:187], a[40:43], v[72:75], v[184:187]
v_mfma_f32_16x16x32_bf16 v[184:187], a[44:47], v[76:79], v[184:187]
ds_read_b64_tr_b16 a[24:25], v232 offset:24576
v_mul_f32 v180, v245, v180
v_mfma_f32_16x16x32_bf16 v[184:187], a[48:51], v[80:83], v[184:187]
ds_write_b64 v238, v[158:159] offset:8192
ds_read_b64_tr_b16 a[26:27], v232 offset:26624
v_mul_f32 v181, v245, v181
v_mfma_f32_16x16x32_bf16 v[184:187], a[52:55], v[84:87], v[184:187]
ds_write_b64 v239, v[160:161] offset:8192
v_mul_f32 v182, v245, v182
v_mfma_f32_16x16x32_bf16 v[184:187], a[56:59], v[88:91], v[184:187]
ds_read_b64_tr_b16 a[28:29], v232 offset:28672
v_mul_f32 v183, v245, v183
v_mfma_f32_16x16x32_bf16 v[184:187], a[60:63], v[92:95], v[184:187]
ds_write_b64 v240, v[162:163] offset:8192
s_waitcnt lgkmcnt(8)
ds_read_b64_tr_b16 a[30:31], v232 offset:30720
v_cvt_pk_bf16_f32 v180, v180, v181
v_mfma_f32_16x16x32_bf16 v[188:191], a[32:35], v[96:99], 0
v_cvt_pk_bf16_f32 v181, v182, v183
v_mfma_f32_16x16x32_bf16 v[188:191], a[36:39], v[100:103], v[188:191]
ds_write_b64 v241, v[180:181] offset:8192
v_mfma_f32_16x16x32_bf16 v[188:191], a[40:43], v[104:107], v[188:191]
v_mfma_f32_16x16x32_bf16 v[188:191], a[44:47], v[108:111], v[188:191]
v_mul_f32 v184, v246, v184
v_mfma_f32_16x16x32_bf16 v[188:191], a[48:51], v[112:115], v[188:191]
ds_write_b64 v238, v[164:165] offset:16384
v_mul_f32 v185, v246, v185
v_mfma_f32_16x16x32_bf16 v[188:191], a[52:55], v[116:119], v[188:191]
ds_write_b64 v239, v[166:167] offset:16384
v_mul_f32 v186, v246, v186
v_mfma_f32_16x16x32_bf16 v[188:191], a[56:59], v[120:123], v[188:191]
v_mul_f32 v187, v246, v187
v_mfma_f32_16x16x32_bf16 v[188:191], a[60:63], v[124:127], v[188:191]
ds_write_b64 v240, v[168:169] offset:16384
v_cvt_pk_bf16_f32 v184, v184, v185
s_waitcnt lgkmcnt(4)
v_mfma_f32_16x16x32_bf16 v[176:179], a[0:3], v[0:3], 0
v_cvt_pk_bf16_f32 v185, v186, v187
v_mfma_f32_16x16x32_bf16 v[176:179], a[4:7], v[4:7], v[176:179]
ds_write_b64 v241, v[184:185] offset:16384
ds_read_b64_tr_b16 a[32:33], v233 offset:0
v_mfma_f32_16x16x32_bf16 v[176:179], a[8:11], v[8:11], v[176:179]
ds_read_b64_tr_b16 a[34:35], v233 offset:2048
v_mfma_f32_16x16x32_bf16 v[176:179], a[12:15], v[12:15], v[176:179]
v_mul_f32 v188, v247, v188
v_mfma_f32_16x16x32_bf16 v[176:179], a[16:19], v[16:19], v[176:179]
ds_write_b64 v238, v[170:171] offset:24576
ds_read_b64_tr_b16 a[36:37], v233 offset:4096
v_mul_f32 v189, v247, v189
v_mfma_f32_16x16x32_bf16 v[176:179], a[20:23], v[20:23], v[176:179]
ds_write_b64 v239, v[172:173] offset:24576
ds_read_b64_tr_b16 a[38:39], v233 offset:6144
v_mul_f32 v190, v247, v190
v_mfma_f32_16x16x32_bf16 v[176:179], a[24:27], v[24:27], v[176:179]
v_mul_f32 v191, v247, v191
v_mfma_f32_16x16x32_bf16 v[176:179], a[28:31], v[28:31], v[176:179]
ds_write_b64 v240, v[174:175] offset:24576
ds_read_b64_tr_b16 a[40:41], v233 offset:8192
v_cvt_pk_bf16_f32 v188, v188, v189
v_mfma_f32_16x16x32_bf16 v[180:183], a[0:3], v[32:35], 0
ds_read_b64_tr_b16 a[42:43], v233 offset:10240
v_cvt_pk_bf16_f32 v189, v190, v191
v_mfma_f32_16x16x32_bf16 v[180:183], a[4:7], v[36:39], v[180:183]
ds_write_b64 v241, v[188:189] offset:24576
v_mfma_f32_16x16x32_bf16 v[180:183], a[8:11], v[40:43], v[180:183]
v_add_u32 v242, 0, v229
s_waitcnt lgkmcnt(8)
ds_read_b128 a[160:163], v242 offset:0
ds_read_b128 a[164:167], v242 offset:4096
ds_read_b128 a[168:171], v242 offset:8192
ds_read_b128 a[172:175], v242 offset:12288
ds_read_b128 a[176:179], v242 offset:16384
ds_read_b128 a[180:183], v242 offset:20480
ds_read_b128 a[184:187], v242 offset:24576
s_waitcnt lgkmcnt(8)
ds_read_b128 a[188:191], v242 offset:28672
s_xor_b32 s97, s41, 128
s_waitcnt vmcnt(7)
s_waitcnt lgkmcnt(7)
buffer_store_dwordx4 a[160:163], v230, s[28:31], s97 offen sc1
ds_read_b64_tr_b16 a[44:45], v233 offset:12288
v_mfma_f32_16x16x32_bf16 v[180:183], a[12:15], v[44:47], v[180:183]
ds_read_b64_tr_b16 a[46:47], v233 offset:14336
v_mul_f32 v176, v244, v176
v_mfma_f32_16x16x32_bf16 v[180:183], a[16:19], v[48:51], v[180:183]
v_mul_f32 v177, v244, v177
v_mfma_f32_16x16x32_bf16 v[180:183], a[20:23], v[52:55], v[180:183]
ds_read_b64_tr_b16 a[48:49], v233 offset:16384
v_mul_f32 v178, v244, v178
v_mfma_f32_16x16x32_bf16 v[180:183], a[24:27], v[56:59], v[180:183]
ds_read_b64_tr_b16 a[50:51], v233 offset:18432
v_mul_f32 v179, v244, v179
v_mfma_f32_16x16x32_bf16 v[180:183], a[28:31], v[60:63], v[180:183]
v_cvt_pk_bf16_f32 v152, v176, v177
v_mfma_f32_16x16x32_bf16 v[184:187], a[0:3], v[64:67], 0
ds_read_b64_tr_b16 a[52:53], v233 offset:20480
v_cvt_pk_bf16_f32 v153, v178, v179
v_mfma_f32_16x16x32_bf16 v[184:187], a[4:7], v[68:71], v[184:187]
ds_read_b64_tr_b16 a[54:55], v233 offset:22528
v_mfma_f32_16x16x32_bf16 v[184:187], a[8:11], v[72:75], v[184:187]
s_xor_b32 s97, s41, 8320
s_waitcnt vmcnt(7)
s_waitcnt lgkmcnt(12)
buffer_store_dwordx4 a[164:167], v230, s[28:31], s97 offen sc1
v_mfma_f32_16x16x32_bf16 v[184:187], a[12:15], v[76:79], v[184:187]
ds_read_b64_tr_b16 a[56:57], v233 offset:24576
v_mul_f32 v180, v245, v180
v_mfma_f32_16x16x32_bf16 v[184:187], a[16:19], v[80:83], v[184:187]
ds_read_b64_tr_b16 a[58:59], v233 offset:26624
v_mul_f32 v181, v245, v181
v_mfma_f32_16x16x32_bf16 v[184:187], a[20:23], v[84:87], v[184:187]
v_mul_f32 v182, v245, v182
v_mfma_f32_16x16x32_bf16 v[184:187], a[24:27], v[88:91], v[184:187]
ds_read_b64_tr_b16 a[60:61], v233 offset:28672
v_mul_f32 v183, v245, v183
v_mfma_f32_16x16x32_bf16 v[184:187], a[28:31], v[92:95], v[184:187]
s_waitcnt lgkmcnt(8)
ds_read_b64_tr_b16 a[62:63], v233 offset:30720
v_cvt_pk_bf16_f32 v158, v180, v181
v_mfma_f32_16x16x32_bf16 v[188:191], a[0:3], v[96:99], 0
v_cvt_pk_bf16_f32 v159, v182, v183
v_mfma_f32_16x16x32_bf16 v[188:191], a[4:7], v[100:103], v[188:191]
v_mfma_f32_16x16x32_bf16 v[188:191], a[8:11], v[104:107], v[188:191]
v_mfma_f32_16x16x32_bf16 v[188:191], a[12:15], v[108:111], v[188:191]
v_mul_f32 v184, v246, v184
v_mfma_f32_16x16x32_bf16 v[188:191], a[16:19], v[112:115], v[188:191]
v_mul_f32 v185, v246, v185
v_mfma_f32_16x16x32_bf16 v[188:191], a[20:23], v[116:119], v[188:191]
s_xor_b32 s97, s41, 16512
s_waitcnt vmcnt(7)
buffer_store_dwordx4 a[168:171], v230, s[28:31], s97 offen sc1
v_mul_f32 v186, v246, v186
v_mfma_f32_16x16x32_bf16 v[188:191], a[24:27], v[120:123], v[188:191]
v_mul_f32 v187, v246, v187
v_mfma_f32_16x16x32_bf16 v[188:191], a[28:31], v[124:127], v[188:191]
v_cvt_pk_bf16_f32 v164, v184, v185
s_waitcnt lgkmcnt(0)
v_mfma_f32_16x16x32_bf16 v[176:179], a[32:35], v[0:3], 0
v_cvt_pk_bf16_f32 v165, v186, v187
v_mfma_f32_16x16x32_bf16 v[176:179], a[36:39], v[4:7], v[176:179]
ds_read_b64_tr_b16 a[0:1], v234 offset:0
v_mfma_f32_16x16x32_bf16 v[176:179], a[40:43], v[8:11], v[176:179]
ds_read_b64_tr_b16 a[2:3], v234 offset:2048
v_mfma_f32_16x16x32_bf16 v[176:179], a[44:47], v[12:15], v[176:179]
v_mul_f32 v188, v247, v188
v_mfma_f32_16x16x32_bf16 v[176:179], a[48:51], v[16:19], v[176:179]
ds_read_b64_tr_b16 a[4:5], v234 offset:4096
v_mul_f32 v189, v247, v189
v_mfma_f32_16x16x32_bf16 v[176:179], a[52:55], v[20:23], v[176:179]
ds_read_b64_tr_b16 a[6:7], v234 offset:6144
v_mul_f32 v190, v247, v190
v_mfma_f32_16x16x32_bf16 v[176:179], a[56:59], v[24:27], v[176:179]
v_mul_f32 v191, v247, v191
v_mfma_f32_16x16x32_bf16 v[176:179], a[60:63], v[28:31], v[176:179]
ds_read_b64_tr_b16 a[8:9], v234 offset:8192
v_cvt_pk_bf16_f32 v170, v188, v189
v_mfma_f32_16x16x32_bf16 v[180:183], a[32:35], v[32:35], 0
s_xor_b32 s97, s41, 24704
s_waitcnt vmcnt(7)
buffer_store_dwordx4 a[172:175], v230, s[28:31], s97 offen sc1
ds_read_b64_tr_b16 a[10:11], v234 offset:10240
v_cvt_pk_bf16_f32 v171, v190, v191
v_mfma_f32_16x16x32_bf16 v[180:183], a[36:39], v[36:39], v[180:183]
v_mfma_f32_16x16x32_bf16 v[180:183], a[40:43], v[40:43], v[180:183]
ds_read_b64_tr_b16 a[12:13], v234 offset:12288
v_mfma_f32_16x16x32_bf16 v[180:183], a[44:47], v[44:47], v[180:183]
ds_read_b64_tr_b16 a[14:15], v234 offset:14336
v_mul_f32 v176, v244, v176
v_mfma_f32_16x16x32_bf16 v[180:183], a[48:51], v[48:51], v[180:183]
v_mul_f32 v177, v244, v177
v_mfma_f32_16x16x32_bf16 v[180:183], a[52:55], v[52:55], v[180:183]
ds_read_b64_tr_b16 a[16:17], v234 offset:16384
v_mul_f32 v178, v244, v178
v_mfma_f32_16x16x32_bf16 v[180:183], a[56:59], v[56:59], v[180:183]
ds_read_b64_tr_b16 a[18:19], v234 offset:18432
v_mul_f32 v179, v244, v179
v_mfma_f32_16x16x32_bf16 v[180:183], a[60:63], v[60:63], v[180:183]
v_cvt_pk_bf16_f32 v154, v176, v177
v_mfma_f32_16x16x32_bf16 v[184:187], a[32:35], v[64:67], 0
ds_read_b64_tr_b16 a[20:21], v234 offset:20480
v_cvt_pk_bf16_f32 v155, v178, v179
v_mfma_f32_16x16x32_bf16 v[184:187], a[36:39], v[68:71], v[184:187]
ds_read_b64_tr_b16 a[22:23], v234 offset:22528
v_mfma_f32_16x16x32_bf16 v[184:187], a[40:43], v[72:75], v[184:187]
s_xor_b32 s97, s41, 4224
s_waitcnt vmcnt(7)
buffer_store_dwordx4 a[176:179], v230, s[28:31], s97 offen sc1
v_mfma_f32_16x16x32_bf16 v[184:187], a[44:47], v[76:79], v[184:187]
ds_read_b64_tr_b16 a[24:25], v234 offset:24576
v_mul_f32 v180, v245, v180
v_mfma_f32_16x16x32_bf16 v[184:187], a[48:51], v[80:83], v[184:187]
ds_read_b64_tr_b16 a[26:27], v234 offset:26624
v_mul_f32 v181, v245, v181
v_mfma_f32_16x16x32_bf16 v[184:187], a[52:55], v[84:87], v[184:187]
v_mul_f32 v182, v245, v182
v_mfma_f32_16x16x32_bf16 v[184:187], a[56:59], v[88:91], v[184:187]
ds_read_b64_tr_b16 a[28:29], v234 offset:28672
v_mul_f32 v183, v245, v183
v_mfma_f32_16x16x32_bf16 v[184:187], a[60:63], v[92:95], v[184:187]
s_waitcnt lgkmcnt(8)
ds_read_b64_tr_b16 a[30:31], v234 offset:30720
v_cvt_pk_bf16_f32 v160, v180, v181
v_mfma_f32_16x16x32_bf16 v[188:191], a[32:35], v[96:99], 0
v_cvt_pk_bf16_f32 v161, v182, v183
v_mfma_f32_16x16x32_bf16 v[188:191], a[36:39], v[100:103], v[188:191]
v_mfma_f32_16x16x32_bf16 v[188:191], a[40:43], v[104:107], v[188:191]
v_mfma_f32_16x16x32_bf16 v[188:191], a[44:47], v[108:111], v[188:191]
v_mul_f32 v184, v246, v184
v_mfma_f32_16x16x32_bf16 v[188:191], a[48:51], v[112:115], v[188:191]
v_mul_f32 v185, v246, v185
v_mfma_f32_16x16x32_bf16 v[188:191], a[52:55], v[116:119], v[188:191]
s_xor_b32 s97, s41, 12416
s_waitcnt vmcnt(7)
buffer_store_dwordx4 a[180:183], v230, s[28:31], s97 offen sc1
v_mul_f32 v186, v246, v186
v_mfma_f32_16x16x32_bf16 v[188:191], a[56:59], v[120:123], v[188:191]
v_mul_f32 v187, v246, v187
v_mfma_f32_16x16x32_bf16 v[188:191], a[60:63], v[124:127], v[188:191]
v_cvt_pk_bf16_f32 v166, v184, v185
s_waitcnt lgkmcnt(0)
v_mfma_f32_16x16x32_bf16 v[176:179], a[0:3], v[0:3], 0
v_cvt_pk_bf16_f32 v167, v186, v187
v_mfma_f32_16x16x32_bf16 v[176:179], a[4:7], v[4:7], v[176:179]
ds_read_b64_tr_b16 a[32:33], v235 offset:0
v_mfma_f32_16x16x32_bf16 v[176:179], a[8:11], v[8:11], v[176:179]
ds_read_b64_tr_b16 a[34:35], v235 offset:2048
v_mfma_f32_16x16x32_bf16 v[176:179], a[12:15], v[12:15], v[176:179]
ds_read_b64_tr_b16 a[36:37], v235 offset:4096
v_mul_f32 v188, v247, v188
v_mfma_f32_16x16x32_bf16 v[176:179], a[16:19], v[16:19], v[176:179]
v_mul_f32 v189, v247, v189
v_mfma_f32_16x16x32_bf16 v[176:179], a[20:23], v[20:23], v[176:179]
ds_read_b64_tr_b16 a[38:39], v235 offset:6144
v_mul_f32 v190, v247, v190
v_mfma_f32_16x16x32_bf16 v[176:179], a[24:27], v[24:27], v[176:179]
ds_read_b64_tr_b16 a[40:41], v235 offset:8192
v_mul_f32 v191, v247, v191
v_mfma_f32_16x16x32_bf16 v[176:179], a[28:31], v[28:31], v[176:179]
v_cvt_pk_bf16_f32 v172, v188, v189
v_mfma_f32_16x16x32_bf16 v[180:183], a[0:3], v[32:35], 0
s_xor_b32 s97, s41, 20608
s_waitcnt vmcnt(7)
buffer_store_dwordx4 a[184:187], v230, s[28:31], s97 offen sc1
ds_read_b64_tr_b16 a[42:43], v235 offset:10240
v_cvt_pk_bf16_f32 v173, v190, v191
v_mfma_f32_16x16x32_bf16 v[180:183], a[4:7], v[36:39], v[180:183]
ds_read_b64_tr_b16 a[44:45], v235 offset:12288
v_mfma_f32_16x16x32_bf16 v[180:183], a[8:11], v[40:43], v[180:183]
ds_read_b64_tr_b16 a[46:47], v235 offset:14336
v_mfma_f32_16x16x32_bf16 v[180:183], a[12:15], v[44:47], v[180:183]
v_mul_f32 v176, v244, v176
v_mfma_f32_16x16x32_bf16 v[180:183], a[16:19], v[48:51], v[180:183]
ds_read_b64_tr_b16 a[48:49], v235 offset:16384
v_mul_f32 v177, v244, v177
v_mfma_f32_16x16x32_bf16 v[180:183], a[20:23], v[52:55], v[180:183]
ds_read_b64_tr_b16 a[50:51], v235 offset:18432
v_mul_f32 v178, v244, v178
v_mfma_f32_16x16x32_bf16 v[180:183], a[24:27], v[56:59], v[180:183]
v_mul_f32 v179, v244, v179
v_mfma_f32_16x16x32_bf16 v[180:183], a[28:31], v[60:63], v[180:183]
ds_read_b64_tr_b16 a[52:53], v235 offset:20480
v_cvt_pk_bf16_f32 v156, v176, v177
v_mfma_f32_16x16x32_bf16 v[184:187], a[0:3], v[64:67], 0
ds_read_b64_tr_b16 a[54:55], v235 offset:22528
v_cvt_pk_bf16_f32 v157, v178, v179
v_mfma_f32_16x16x32_bf16 v[184:187], a[4:7], v[68:71], v[184:187]
ds_read_b64_tr_b16 a[56:57], v235 offset:24576
v_mfma_f32_16x16x32_bf16 v[184:187], a[8:11], v[72:75], v[184:187]
v_mfma_f32_16x16x32_bf16 v[184:187], a[12:15], v[76:79], v[184:187]
s_xor_b32 s97, s41, 28800
s_waitcnt vmcnt(7)
buffer_store_dwordx4 a[188:191], v230, s[28:31], s97 offen sc1
ds_read_b64_tr_b16 a[58:59], v235 offset:26624
v_mul_f32 v180, v245, v180
v_mfma_f32_16x16x32_bf16 v[184:187], a[16:19], v[80:83], v[184:187]
ds_read_b64_tr_b16 a[60:61], v235 offset:28672
v_mul_f32 v181, v245, v181
v_mfma_f32_16x16x32_bf16 v[184:187], a[20:23], v[84:87], v[184:187]
v_mul_f32 v182, v245, v182
v_mfma_f32_16x16x32_bf16 v[184:187], a[24:27], v[88:91], v[184:187]
s_waitcnt lgkmcnt(8)
ds_read_b64_tr_b16 a[62:63], v235 offset:30720
v_mul_f32 v183, v245, v183
v_mfma_f32_16x16x32_bf16 v[184:187], a[28:31], v[92:95], v[184:187]
v_cvt_pk_bf16_f32 v162, v180, v181
v_mfma_f32_16x16x32_bf16 v[188:191], a[0:3], v[96:99], 0
v_cvt_pk_bf16_f32 v163, v182, v183
v_mfma_f32_16x16x32_bf16 v[188:191], a[4:7], v[100:103], v[188:191]
v_mfma_f32_16x16x32_bf16 v[188:191], a[8:11], v[104:107], v[188:191]
v_mfma_f32_16x16x32_bf16 v[188:191], a[12:15], v[108:111], v[188:191]
s_nop 1
v_mul_f32 v184, v246, v184
v_mfma_f32_16x16x32_bf16 v[188:191], a[16:19], v[112:115], v[188:191]
v_mul_f32 v185, v246, v185
v_mfma_f32_16x16x32_bf16 v[188:191], a[20:23], v[116:119], v[188:191]
v_mul_f32 v186, v246, v186
v_mfma_f32_16x16x32_bf16 v[188:191], a[24:27], v[120:123], v[188:191]
v_mul_f32 v187, v246, v187
v_mfma_f32_16x16x32_bf16 v[188:191], a[28:31], v[124:127], v[188:191]
v_cvt_pk_bf16_f32 v168, v184, v185
s_waitcnt lgkmcnt(0)
v_mfma_f32_16x16x32_bf16 v[176:179], a[32:35], v[0:3], 0
v_cvt_pk_bf16_f32 v169, v186, v187
s_barrier
v_add_u32 v232, 131072, v227
v_xor_b32 v233, 32, v232
v_xor_b32 v234, 64, v232
v_xor_b32 v235, 96, v232
v_mfma_f32_16x16x32_bf16 v[176:179], a[36:39], v[4:7], v[176:179]
ds_read_b64_tr_b16 a[0:1], v232 offset:0
v_mfma_f32_16x16x32_bf16 v[176:179], a[40:43], v[8:11], v[176:179]
ds_read_b64_tr_b16 a[2:3], v232 offset:2048
v_mfma_f32_16x16x32_bf16 v[176:179], a[44:47], v[12:15], v[176:179]
v_mul_f32 v188, v247, v188
v_mfma_f32_16x16x32_bf16 v[176:179], a[48:51], v[16:19], v[176:179]
ds_read_b64_tr_b16 a[4:5], v232 offset:4096
v_mul_f32 v189, v247, v189
v_mfma_f32_16x16x32_bf16 v[176:179], a[52:55], v[20:23], v[176:179]
ds_read_b64_tr_b16 a[6:7], v232 offset:6144
v_mul_f32 v190, v247, v190
v_mfma_f32_16x16x32_bf16 v[176:179], a[56:59], v[24:27], v[176:179]
v_mul_f32 v191, v247, v191
v_add_u32 v238, 32768, v228
v_xor_b32 v239, 32, v238
v_xor_b32 v240, 64, v238
v_xor_b32 v241, 96, v238
v_mfma_f32_16x16x32_bf16 v[176:179], a[60:63], v[28:31], v[176:179]
ds_read_b64_tr_b16 a[8:9], v232 offset:8192
v_cvt_pk_bf16_f32 v174, v188, v189
v_mfma_f32_16x16x32_bf16 v[180:183], a[32:35], v[32:35], 0
ds_read_b64_tr_b16 a[10:11], v232 offset:10240
v_cvt_pk_bf16_f32 v175, v190, v191
v_mfma_f32_16x16x32_bf16 v[180:183], a[36:39], v[36:39], v[180:183]
v_mfma_f32_16x16x32_bf16 v[180:183], a[40:43], v[40:43], v[180:183]
ds_read_b64_tr_b16 a[12:13], v232 offset:12288
v_mfma_f32_16x16x32_bf16 v[180:183], a[44:47], v[44:47], v[180:183]
ds_read_b64_tr_b16 a[14:15], v232 offset:14336
v_mul_f32 v176, v244, v176
v_mfma_f32_16x16x32_bf16 v[180:183], a[48:51], v[48:51], v[180:183]
ds_write_b64 v238, v[152:153] offset:0
v_mul_f32 v177, v244, v177
v_mfma_f32_16x16x32_bf16 v[180:183], a[52:55], v[52:55], v[180:183]
ds_write_b64 v239, v[154:155] offset:0
ds_read_b64_tr_b16 a[16:17], v232 offset:16384
v_mul_f32 v178, v244, v178
v_mfma_f32_16x16x32_bf16 v[180:183], a[56:59], v[56:59], v[180:183]
ds_read_b64_tr_b16 a[18:19], v232 offset:18432
v_mul_f32 v179, v244, v179
v_mfma_f32_16x16x32_bf16 v[180:183], a[60:63], v[60:63], v[180:183]
ds_write_b64 v240, v[156:157] offset:0
v_cvt_pk_bf16_f32 v176, v176, v177
v_mfma_f32_16x16x32_bf16 v[184:187], a[32:35], v[64:67], 0
ds_read_b64_tr_b16 a[20:21], v232 offset:20480
v_cvt_pk_bf16_f32 v177, v178, v179
v_mfma_f32_16x16x32_bf16 v[184:187], a[36:39], v[68:71], v[184:187]
ds_write_b64 v241, v[176:177] offset:0
s_waitcnt lgkmcnt(8)
ds_read_b64_tr_b16 a[22:23], v232 offset:22528
v_mfma_f32_16x16x32_bf16 v[184:187], a[40:43], v[72:75], v[184:187]
v_mfma_f32_16x16x32_bf16 v[184:187], a[44:47], v[76:79], v[184:187]
ds_read_b64_tr_b16 a[24:25], v232 offset:24576
v_mul_f32 v180, v245, v180
v_mfma_f32_16x16x32_bf16 v[184:187], a[48:51], v[80:83], v[184:187]
ds_write_b64 v238, v[158:159] offset:8192
ds_read_b64_tr_b16 a[26:27], v232 offset:26624
v_mul_f32 v181, v245, v181
v_mfma_f32_16x16x32_bf16 v[184:187], a[52:55], v[84:87], v[184:187]
ds_write_b64 v239, v[160:161] offset:8192
v_mul_f32 v182, v245, v182
v_mfma_f32_16x16x32_bf16 v[184:187], a[56:59], v[88:91], v[184:187]
ds_read_b64_tr_b16 a[28:29], v232 offset:28672
v_mul_f32 v183, v245, v183
v_mfma_f32_16x16x32_bf16 v[184:187], a[60:63], v[92:95], v[184:187]
ds_write_b64 v240, v[162:163] offset:8192
s_waitcnt lgkmcnt(8)
ds_read_b64_tr_b16 a[30:31], v232 offset:30720
v_cvt_pk_bf16_f32 v180, v180, v181
v_mfma_f32_16x16x32_bf16 v[188:191], a[32:35], v[96:99], 0
v_cvt_pk_bf16_f32 v181, v182, v183
v_mfma_f32_16x16x32_bf16 v[188:191], a[36:39], v[100:103], v[188:191]
ds_write_b64 v241, v[180:181] offset:8192
v_mfma_f32_16x16x32_bf16 v[188:191], a[40:43], v[104:107], v[188:191]
v_mfma_f32_16x16x32_bf16 v[188:191], a[44:47], v[108:111], v[188:191]
v_mul_f32 v184, v246, v184
v_mfma_f32_16x16x32_bf16 v[188:191], a[48:51], v[112:115], v[188:191]
ds_write_b64 v238, v[164:165] offset:16384
v_mul_f32 v185, v246, v185
v_mfma_f32_16x16x32_bf16 v[188:191], a[52:55], v[116:119], v[188:191]
ds_write_b64 v239, v[166:167] offset:16384
v_mul_f32 v186, v246, v186
v_mfma_f32_16x16x32_bf16 v[188:191], a[56:59], v[120:123], v[188:191]
v_mul_f32 v187, v246, v187
v_mfma_f32_16x16x32_bf16 v[188:191], a[60:63], v[124:127], v[188:191]
ds_write_b64 v240, v[168:169] offset:16384
v_cvt_pk_bf16_f32 v184, v184, v185
s_waitcnt lgkmcnt(4)
v_mfma_f32_16x16x32_bf16 v[176:179], a[0:3], v[0:3], 0
v_cvt_pk_bf16_f32 v185, v186, v187
v_mfma_f32_16x16x32_bf16 v[176:179], a[4:7], v[4:7], v[176:179]
ds_write_b64 v241, v[184:185] offset:16384
ds_read_b64_tr_b16 a[32:33], v233 offset:0
v_mfma_f32_16x16x32_bf16 v[176:179], a[8:11], v[8:11], v[176:179]
ds_read_b64_tr_b16 a[34:35], v233 offset:2048
v_mfma_f32_16x16x32_bf16 v[176:179], a[12:15], v[12:15], v[176:179]
v_mul_f32 v188, v247, v188
v_mfma_f32_16x16x32_bf16 v[176:179], a[16:19], v[16:19], v[176:179]
ds_write_b64 v238, v[170:171] offset:24576
ds_read_b64_tr_b16 a[36:37], v233 offset:4096
v_mul_f32 v189, v247, v189
v_mfma_f32_16x16x32_bf16 v[176:179], a[20:23], v[20:23], v[176:179]
ds_write_b64 v239, v[172:173] offset:24576
ds_read_b64_tr_b16 a[38:39], v233 offset:6144
v_mul_f32 v190, v247, v190
v_mfma_f32_16x16x32_bf16 v[176:179], a[24:27], v[24:27], v[176:179]
v_mul_f32 v191, v247, v191
v_mfma_f32_16x16x32_bf16 v[176:179], a[28:31], v[28:31], v[176:179]
ds_write_b64 v240, v[174:175] offset:24576
ds_read_b64_tr_b16 a[40:41], v233 offset:8192
v_cvt_pk_bf16_f32 v188, v188, v189
v_mfma_f32_16x16x32_bf16 v[180:183], a[0:3], v[32:35], 0
ds_read_b64_tr_b16 a[42:43], v233 offset:10240
v_cvt_pk_bf16_f32 v189, v190, v191
v_mfma_f32_16x16x32_bf16 v[180:183], a[4:7], v[36:39], v[180:183]
ds_write_b64 v241, v[188:189] offset:24576
v_mfma_f32_16x16x32_bf16 v[180:183], a[8:11], v[40:43], v[180:183]
v_add_u32 v242, 32768, v229
s_waitcnt lgkmcnt(8)
ds_read_b128 a[192:195], v242 offset:0
ds_read_b128 a[196:199], v242 offset:4096
ds_read_b128 a[200:203], v242 offset:8192
ds_read_b128 a[204:207], v242 offset:12288
ds_read_b128 a[208:211], v242 offset:16384
ds_read_b128 a[212:215], v242 offset:20480
ds_read_b128 a[216:219], v242 offset:24576
s_waitcnt lgkmcnt(8)
ds_read_b128 a[220:223], v242 offset:28672
s_xor_b32 s97, s41, 256
s_waitcnt vmcnt(7)
s_waitcnt lgkmcnt(7)
buffer_store_dwordx4 a[192:195], v230, s[28:31], s97 offen sc1
ds_read_b64_tr_b16 a[44:45], v233 offset:12288
v_mfma_f32_16x16x32_bf16 v[180:183], a[12:15], v[44:47], v[180:183]
ds_read_b64_tr_b16 a[46:47], v233 offset:14336
v_mul_f32 v176, v244, v176
v_mfma_f32_16x16x32_bf16 v[180:183], a[16:19], v[48:51], v[180:183]
v_mul_f32 v177, v244, v177
v_mfma_f32_16x16x32_bf16 v[180:183], a[20:23], v[52:55], v[180:183]
ds_read_b64_tr_b16 a[48:49], v233 offset:16384
v_mul_f32 v178, v244, v178
v_mfma_f32_16x16x32_bf16 v[180:183], a[24:27], v[56:59], v[180:183]
ds_read_b64_tr_b16 a[50:51], v233 offset:18432
v_mul_f32 v179, v244, v179
v_mfma_f32_16x16x32_bf16 v[180:183], a[28:31], v[60:63], v[180:183]
v_cvt_pk_bf16_f32 v152, v176, v177
v_mfma_f32_16x16x32_bf16 v[184:187], a[0:3], v[64:67], 0
ds_read_b64_tr_b16 a[52:53], v233 offset:20480
v_cvt_pk_bf16_f32 v153, v178, v179
v_mfma_f32_16x16x32_bf16 v[184:187], a[4:7], v[68:71], v[184:187]
ds_read_b64_tr_b16 a[54:55], v233 offset:22528
v_mfma_f32_16x16x32_bf16 v[184:187], a[8:11], v[72:75], v[184:187]
v_mfma_f32_16x16x32_bf16 v[184:187], a[12:15], v[76:79], v[184:187]
ds_read_b64_tr_b16 a[56:57], v233 offset:24576
v_mul_f32 v180, v245, v180
v_mfma_f32_16x16x32_bf16 v[184:187], a[16:19], v[80:83], v[184:187]
s_xor_b32 s97, s41, 8448
s_waitcnt vmcnt(7)
s_waitcnt lgkmcnt(13)
buffer_store_dwordx4 a[196:199], v230, s[28:31], s97 offen sc1
ds_read_b64_tr_b16 a[58:59], v233 offset:26624
v_mul_f32 v181, v245, v181
v_mfma_f32_16x16x32_bf16 v[184:187], a[20:23], v[84:87], v[184:187]
v_mul_f32 v182, v245, v182
v_mfma_f32_16x16x32_bf16 v[184:187], a[24:27], v[88:91], v[184:187]
ds_read_b64_tr_b16 a[60:61], v233 offset:28672
v_mul_f32 v183, v245, v183
v_mfma_f32_16x16x32_bf16 v[184:187], a[28:31], v[92:95], v[184:187]
s_waitcnt lgkmcnt(8)
ds_read_b64_tr_b16 a[62:63], v233 offset:30720
v_cvt_pk_bf16_f32 v158, v180, v181
v_mfma_f32_16x16x32_bf16 v[188:191], a[0:3], v[96:99], 0
v_cvt_pk_bf16_f32 v159, v182, v183
v_mfma_f32_16x16x32_bf16 v[188:191], a[4:7], v[100:103], v[188:191]
v_mfma_f32_16x16x32_bf16 v[188:191], a[8:11], v[104:107], v[188:191]
v_mfma_f32_16x16x32_bf16 v[188:191], a[12:15], v[108:111], v[188:191]
v_mul_f32 v184, v246, v184
v_mfma_f32_16x16x32_bf16 v[188:191], a[16:19], v[112:115], v[188:191]
v_mul_f32 v185, v246, v185
v_mfma_f32_16x16x32_bf16 v[188:191], a[20:23], v[116:119], v[188:191]
v_mul_f32 v186, v246, v186
v_mfma_f32_16x16x32_bf16 v[188:191], a[24:27], v[120:123], v[188:191]
v_mul_f32 v187, v246, v187
v_mfma_f32_16x16x32_bf16 v[188:191], a[28:31], v[124:127], v[188:191]
v_cvt_pk_bf16_f32 v164, v184, v185
s_waitcnt lgkmcnt(0)
v_mfma_f32_16x16x32_bf16 v[176:179], a[32:35], v[0:3], 0
s_xor_b32 s97, s41, 16640
s_waitcnt vmcnt(7)
buffer_store_dwordx4 a[200:203], v230, s[28:31], s97 offen sc1
v_cvt_pk_bf16_f32 v165, v186, v187
v_mfma_f32_16x16x32_bf16 v[176:179], a[36:39], v[4:7], v[176:179]
ds_read_b64_tr_b16 a[0:1], v234 offset:0
v_mfma_f32_16x16x32_bf16 v[176:179], a[40:43], v[8:11], v[176:179]
ds_read_b64_tr_b16 a[2:3], v234 offset:2048
v_mfma_f32_16x16x32_bf16 v[176:179], a[44:47], v[12:15], v[176:179]
v_mul_f32 v188, v247, v188
v_mfma_f32_16x16x32_bf16 v[176:179], a[48:51], v[16:19], v[176:179]
ds_read_b64_tr_b16 a[4:5], v234 offset:4096
v_mul_f32 v189, v247, v189
v_mfma_f32_16x16x32_bf16 v[176:179], a[52:55], v[20:23], v[176:179]
ds_read_b64_tr_b16 a[6:7], v234 offset:6144
v_mul_f32 v190, v247, v190
v_mfma_f32_16x16x32_bf16 v[176:179], a[56:59], v[24:27], v[176:179]
v_mul_f32 v191, v247, v191
v_mfma_f32_16x16x32_bf16 v[176:179], a[60:63], v[28:31], v[176:179]
ds_read_b64_tr_b16 a[8:9], v234 offset:8192
v_cvt_pk_bf16_f32 v170, v188, v189
v_mfma_f32_16x16x32_bf16 v[180:183], a[32:35], v[32:35], 0
ds_read_b64_tr_b16 a[10:11], v234 offset:10240
v_cvt_pk_bf16_f32 v171, v190, v191
v_mfma_f32_16x16x32_bf16 v[180:183], a[36:39], v[36:39], v[180:183]
v_mfma_f32_16x16x32_bf16 v[180:183], a[40:43], v[40:43], v[180:183]
ds_read_b64_tr_b16 a[12:13], v234 offset:12288
v_mfma_f32_16x16x32_bf16 v[180:183], a[44:47], v[44:47], v[180:183]
ds_read_b64_tr_b16 a[14:15], v234 offset:14336
v_mul_f32 v176, v244, v176
v_mfma_f32_16x16x32_bf16 v[180:183], a[48:51], v[48:51], v[180:183]
v_mul_f32 v177, v244, v177
v_mfma_f32_16x16x32_bf16 v[180:183], a[52:55], v[52:55], v[180:183]
s_xor_b32 s97, s41, 24832
s_waitcnt vmcnt(7)
buffer_store_dwordx4 a[204:207], v230, s[28:31], s97 offen sc1
ds_read_b64_tr_b16 a[16:17], v234 offset:16384
v_mul_f32 v178, v244, v178
v_mfma_f32_16x16x32_bf16 v[180:183], a[56:59], v[56:59], v[180:183]
ds_read_b64_tr_b16 a[18:19], v234 offset:18432
v_mul_f32 v179, v244, v179
v_mfma_f32_16x16x32_bf16 v[180:183], a[60:63], v[60:63], v[180:183]
v_cvt_pk_bf16_f32 v154, v176, v177
v_mfma_f32_16x16x32_bf16 v[184:187], a[32:35], v[64:67], 0
ds_read_b64_tr_b16 a[20:21], v234 offset:20480
v_cvt_pk_bf16_f32 v155, v178, v179
v_mfma_f32_16x16x32_bf16 v[184:187], a[36:39], v[68:71], v[184:187]
ds_read_b64_tr_b16 a[22:23], v234 offset:22528
v_mfma_f32_16x16x32_bf16 v[184:187], a[40:43], v[72:75], v[184:187]
v_mfma_f32_16x16x32_bf16 v[184:187], a[44:47], v[76:79], v[184:187]
ds_read_b64_tr_b16 a[24:25], v234 offset:24576
v_mul_f32 v180, v245, v180
v_mfma_f32_16x16x32_bf16 v[184:187], a[48:51], v[80:83], v[184:187]
ds_read_b64_tr_b16 a[26:27], v234 offset:26624
v_mul_f32 v181, v245, v181
v_mfma_f32_16x16x32_bf16 v[184:187], a[52:55], v[84:87], v[184:187]
v_mul_f32 v182, v245, v182
v_mfma_f32_16x16x32_bf16 v[184:187], a[56:59], v[88:91], v[184:187]
ds_read_b64_tr_b16 a[28:29], v234 offset:28672
v_mul_f32 v183, v245, v183
v_mfma_f32_16x16x32_bf16 v[184:187], a[60:63], v[92:95], v[184:187]
s_waitcnt lgkmcnt(8)
ds_read_b64_tr_b16 a[30:31], v234 offset:30720
v_cvt_pk_bf16_f32 v160, v180, v181
v_mfma_f32_16x16x32_bf16 v[188:191], a[32:35], v[96:99], 0
v_cvt_pk_bf16_f32 v161, v182, v183
v_mfma_f32_16x16x32_bf16 v[188:191], a[36:39], v[100:103], v[188:191]
s_xor_b32 s97, s41, 4352
s_waitcnt vmcnt(7)
buffer_store_dwordx4 a[208:211], v230, s[28:31], s97 offen sc1
v_mfma_f32_16x16x32_bf16 v[188:191], a[40:43], v[104:107], v[188:191]
v_mfma_f32_16x16x32_bf16 v[188:191], a[44:47], v[108:111], v[188:191]
v_mul_f32 v184, v246, v184
v_mfma_f32_16x16x32_bf16 v[188:191], a[48:51], v[112:115], v[188:191]
v_mul_f32 v185, v246, v185
v_mfma_f32_16x16x32_bf16 v[188:191], a[52:55], v[116:119], v[188:191]
v_mul_f32 v186, v246, v186
v_mfma_f32_16x16x32_bf16 v[188:191], a[56:59], v[120:123], v[188:191]
v_mul_f32 v187, v246, v187
v_mfma_f32_16x16x32_bf16 v[188:191], a[60:63], v[124:127], v[188:191]
v_cvt_pk_bf16_f32 v166, v184, v185
s_waitcnt lgkmcnt(0)
v_mfma_f32_16x16x32_bf16 v[176:179], a[0:3], v[0:3], 0
v_cvt_pk_bf16_f32 v167, v186, v187
v_mfma_f32_16x16x32_bf16 v[176:179], a[4:7], v[4:7], v[176:179]
ds_read_b64_tr_b16 a[32:33], v235 offset:0
v_mfma_f32_16x16x32_bf16 v[176:179], a[8:11], v[8:11], v[176:179]
ds_read_b64_tr_b16 a[34:35], v235 offset:2048
v_mfma_f32_16x16x32_bf16 v[176:179], a[12:15], v[12:15], v[176:179]
ds_read_b64_tr_b16 a[36:37], v235 offset:4096
v_mul_f32 v188, v247, v188
v_mfma_f32_16x16x32_bf16 v[176:179], a[16:19], v[16:19], v[176:179]
v_mul_f32 v189, v247, v189
v_mfma_f32_16x16x32_bf16 v[176:179], a[20:23], v[20:23], v[176:179]
ds_read_b64_tr_b16 a[38:39], v235 offset:6144
v_mul_f32 v190, v247, v190
v_mfma_f32_16x16x32_bf16 v[176:179], a[24:27], v[24:27], v[176:179]
s_xor_b32 s97, s41, 12544
s_waitcnt vmcnt(7)
buffer_store_dwordx4 a[212:215], v230, s[28:31], s97 offen sc1
ds_read_b64_tr_b16 a[40:41], v235 offset:8192
v_mul_f32 v191, v247, v191
v_mfma_f32_16x16x32_bf16 v[176:179], a[28:31], v[28:31], v[176:179]
v_cvt_pk_bf16_f32 v172, v188, v189
v_mfma_f32_16x16x32_bf16 v[180:183], a[0:3], v[32:35], 0
ds_read_b64_tr_b16 a[42:43], v235 offset:10240
v_cvt_pk_bf16_f32 v173, v190, v191
v_mfma_f32_16x16x32_bf16 v[180:183], a[4:7], v[36:39], v[180:183]
ds_read_b64_tr_b16 a[44:45], v235 offset:12288
v_mfma_f32_16x16x32_bf16 v[180:183], a[8:11], v[40:43], v[180:183]
ds_read_b64_tr_b16 a[46:47], v235 offset:14336
v_mfma_f32_16x16x32_bf16 v[180:183], a[12:15], v[44:47], v[180:183]
v_mul_f32 v176, v244, v176
v_mfma_f32_16x16x32_bf16 v[180:183], a[16:19], v[48:51], v[180:183]
ds_read_b64_tr_b16 a[48:49], v235 offset:16384
v_mul_f32 v177, v244, v177
v_mfma_f32_16x16x32_bf16 v[180:183], a[20:23], v[52:55], v[180:183]
ds_read_b64_tr_b16 a[50:51], v235 offset:18432
v_mul_f32 v178, v244, v178
v_mfma_f32_16x16x32_bf16 v[180:183], a[24:27], v[56:59], v[180:183]
v_mul_f32 v179, v244, v179
v_mfma_f32_16x16x32_bf16 v[180:183], a[28:31], v[60:63], v[180:183]
ds_read_b64_tr_b16 a[52:53], v235 offset:20480
v_cvt_pk_bf16_f32 v156, v176, v177
v_mfma_f32_16x16x32_bf16 v[184:187], a[0:3], v[64:67], 0
ds_read_b64_tr_b16 a[54:55], v235 offset:22528
v_cvt_pk_bf16_f32 v157, v178, v179
v_mfma_f32_16x16x32_bf16 v[184:187], a[4:7], v[68:71], v[184:187]
ds_read_b64_tr_b16 a[56:57], v235 offset:24576
v_mfma_f32_16x16x32_bf16 v[184:187], a[8:11], v[72:75], v[184:187]
s_xor_b32 s97, s41, 20736
s_waitcnt vmcnt(7)
buffer_store_dwordx4 a[216:219], v230, s[28:31], s97 offen sc1
v_mfma_f32_16x16x32_bf16 v[184:187], a[12:15], v[76:79], v[184:187]
ds_read_b64_tr_b16 a[58:59], v235 offset:26624
v_mul_f32 v180, v245, v180
v_mfma_f32_16x16x32_bf16 v[184:187], a[16:19], v[80:83], v[184:187]
ds_read_b64_tr_b16 a[60:61], v235 offset:28672
v_mul_f32 v181, v245, v181
v_mfma_f32_16x16x32_bf16 v[184:187], a[20:23], v[84:87], v[184:187]
v_mul_f32 v182, v245, v182
v_mfma_f32_16x16x32_bf16 v[184:187], a[24:27], v[88:91], v[184:187]
s_waitcnt lgkmcnt(8)
ds_read_b64_tr_b16 a[62:63], v235 offset:30720
v_mul_f32 v183, v245, v183
v_mfma_f32_16x16x32_bf16 v[184:187], a[28:31], v[92:95], v[184:187]
v_cvt_pk_bf16_f32 v162, v180, v181
v_mfma_f32_16x16x32_bf16 v[188:191], a[0:3], v[96:99], 0
v_cvt_pk_bf16_f32 v163, v182, v183
v_mfma_f32_16x16x32_bf16 v[188:191], a[4:7], v[100:103], v[188:191]
v_mfma_f32_16x16x32_bf16 v[188:191], a[8:11], v[104:107], v[188:191]
v_mfma_f32_16x16x32_bf16 v[188:191], a[12:15], v[108:111], v[188:191]
s_nop 1
v_mul_f32 v184, v246, v184
v_mfma_f32_16x16x32_bf16 v[188:191], a[16:19], v[112:115], v[188:191]
v_mul_f32 v185, v246, v185
v_mfma_f32_16x16x32_bf16 v[188:191], a[20:23], v[116:119], v[188:191]
v_mul_f32 v186, v246, v186
v_mfma_f32_16x16x32_bf16 v[188:191], a[24:27], v[120:123], v[188:191]
v_mul_f32 v187, v246, v187
v_mfma_f32_16x16x32_bf16 v[188:191], a[28:31], v[124:127], v[188:191]
s_xor_b32 s97, s41, 28928
s_waitcnt vmcnt(7)
buffer_store_dwordx4 a[220:223], v230, s[28:31], s97 offen sc1
v_cvt_pk_bf16_f32 v168, v184, v185
s_waitcnt lgkmcnt(0)
v_mfma_f32_16x16x32_bf16 v[176:179], a[32:35], v[0:3], 0
v_cvt_pk_bf16_f32 v169, v186, v187
s_barrier
v_mfma_f32_16x16x32_bf16 v[176:179], a[36:39], v[4:7], v[176:179]
v_mfma_f32_16x16x32_bf16 v[176:179], a[40:43], v[8:11], v[176:179]
v_mfma_f32_16x16x32_bf16 v[176:179], a[44:47], v[12:15], v[176:179]
v_mul_f32 v188, v247, v188
v_mfma_f32_16x16x32_bf16 v[176:179], a[48:51], v[16:19], v[176:179]
v_mul_f32 v189, v247, v189
v_mfma_f32_16x16x32_bf16 v[176:179], a[52:55], v[20:23], v[176:179]
v_mul_f32 v190, v247, v190
v_mfma_f32_16x16x32_bf16 v[176:179], a[56:59], v[24:27], v[176:179]
v_mul_f32 v191, v247, v191
v_add_u32 v238, 131072, v228
v_xor_b32 v239, 32, v238
v_xor_b32 v240, 64, v238
v_xor_b32 v241, 96, v238
v_mfma_f32_16x16x32_bf16 v[176:179], a[60:63], v[28:31], v[176:179]
v_cvt_pk_bf16_f32 v174, v188, v189
v_mfma_f32_16x16x32_bf16 v[180:183], a[32:35], v[32:35], 0
v_cvt_pk_bf16_f32 v175, v190, v191
v_mfma_f32_16x16x32_bf16 v[180:183], a[36:39], v[36:39], v[180:183]
v_mfma_f32_16x16x32_bf16 v[180:183], a[40:43], v[40:43], v[180:183]
v_mfma_f32_16x16x32_bf16 v[180:183], a[44:47], v[44:47], v[180:183]
s_nop 1
v_mul_f32 v176, v244, v176
v_mfma_f32_16x16x32_bf16 v[180:183], a[48:51], v[48:51], v[180:183]
ds_write_b64 v238, v[152:153] offset:0
v_mul_f32 v177, v244, v177
v_mfma_f32_16x16x32_bf16 v[180:183], a[52:55], v[52:55], v[180:183]
ds_write_b64 v239, v[154:155] offset:0
v_mul_f32 v178, v244, v178
v_mfma_f32_16x16x32_bf16 v[180:183], a[56:59], v[56:59], v[180:183]
v_mul_f32 v179, v244, v179
v_mfma_f32_16x16x32_bf16 v[180:183], a[60:63], v[60:63], v[180:183]
ds_write_b64 v240, v[156:157] offset:0
v_cvt_pk_bf16_f32 v176, v176, v177
v_mfma_f32_16x16x32_bf16 v[184:187], a[32:35], v[64:67], 0
v_cvt_pk_bf16_f32 v177, v178, v179
v_mfma_f32_16x16x32_bf16 v[184:187], a[36:39], v[68:71], v[184:187]
ds_write_b64 v241, v[176:177] offset:0
v_mfma_f32_16x16x32_bf16 v[184:187], a[40:43], v[72:75], v[184:187]
v_add_u32 v236, 131072, v229
ds_read_b128 a[224:227], v236 offset:0
ds_read_b128 a[228:231], v236 offset:4096
v_mfma_f32_16x16x32_bf16 v[184:187], a[44:47], v[76:79], v[184:187]
v_mul_f32 v180, v245, v180
v_mfma_f32_16x16x32_bf16 v[184:187], a[48:51], v[80:83], v[184:187]
ds_write_b64 v238, v[158:159] offset:8192
v_mul_f32 v181, v245, v181
v_mfma_f32_16x16x32_bf16 v[184:187], a[52:55], v[84:87], v[184:187]
s_xor_b32 s97, s41, 384
s_waitcnt lgkmcnt(2)
buffer_store_dwordx4 a[224:227], v230, s[28:31], s97 offen sc1
ds_write_b64 v239, v[160:161] offset:8192
v_mul_f32 v182, v245, v182
v_mfma_f32_16x16x32_bf16 v[184:187], a[56:59], v[88:91], v[184:187]
s_xor_b32 s97, s41, 8576
s_waitcnt lgkmcnt(2)
buffer_store_dwordx4 a[228:231], v230, s[28:31], s97 offen sc1
v_mul_f32 v183, v245, v183
v_mfma_f32_16x16x32_bf16 v[184:187], a[60:63], v[92:95], v[184:187]
ds_write_b64 v240, v[162:163] offset:8192
v_cvt_pk_bf16_f32 v180, v180, v181
v_mfma_f32_16x16x32_bf16 v[188:191], a[32:35], v[96:99], 0
v_cvt_pk_bf16_f32 v181, v182, v183
v_mfma_f32_16x16x32_bf16 v[188:191], a[36:39], v[100:103], v[188:191]
ds_write_b64 v241, v[180:181] offset:8192
v_mfma_f32_16x16x32_bf16 v[188:191], a[40:43], v[104:107], v[188:191]
v_add_u32 v236, 131072, v229
ds_read_b128 a[232:235], v236 offset:8192
ds_read_b128 a[236:239], v236 offset:12288
v_mfma_f32_16x16x32_bf16 v[188:191], a[44:47], v[108:111], v[188:191]
v_mul_f32 v184, v246, v184
v_mfma_f32_16x16x32_bf16 v[188:191], a[48:51], v[112:115], v[188:191]
ds_write_b64 v238, v[164:165] offset:16384
v_mul_f32 v185, v246, v185
v_mfma_f32_16x16x32_bf16 v[188:191], a[52:55], v[116:119], v[188:191]
s_xor_b32 s97, s41, 16768
s_waitcnt lgkmcnt(2)
buffer_store_dwordx4 a[232:235], v230, s[28:31], s97 offen sc1
ds_write_b64 v239, v[166:167] offset:16384
v_mul_f32 v186, v246, v186
v_mfma_f32_16x16x32_bf16 v[188:191], a[56:59], v[120:123], v[188:191]
s_xor_b32 s97, s41, 24960
s_waitcnt lgkmcnt(2)
buffer_store_dwordx4 a[236:239], v230, s[28:31], s97 offen sc1
v_mul_f32 v187, v246, v187
v_mfma_f32_16x16x32_bf16 v[188:191], a[60:63], v[124:127], v[188:191]
ds_write_b64 v240, v[168:169] offset:16384
v_cvt_pk_bf16_f32 v184, v184, v185
v_cvt_pk_bf16_f32 v185, v186, v187
ds_write_b64 v241, v[184:185] offset:16384
v_add_u32 v236, 131072, v229
ds_read_b128 a[240:243], v236 offset:16384
ds_read_b128 a[244:247], v236 offset:20480
s_nop 0
v_mul_f32 v188, v247, v188
v_mul_f32 v189, v247, v189
ds_write_b64 v238, v[170:171] offset:24576
v_mul_f32 v190, v247, v190
ds_write_b64 v239, v[172:173] offset:24576
v_mul_f32 v191, v247, v191
v_cvt_pk_bf16_f32 v188, v188, v189
ds_write_b64 v240, v[174:175] offset:24576
v_cvt_pk_bf16_f32 v189, v190, v191
ds_write_b64 v241, v[188:189] offset:24576
v_add_u32 v236, 131072, v229
ds_read_b128 a[248:251], v236 offset:24576
ds_read_b128 a[252:255], v236 offset:28672
s_xor_b32 s97, s41, 4480
s_waitcnt lgkmcnt(7)
buffer_store_dwordx4 a[240:243], v230, s[28:31], s97 offen sc1
s_xor_b32 s97, s41, 12672
s_waitcnt lgkmcnt(6)
buffer_store_dwordx4 a[244:247], v230, s[28:31], s97 offen sc1
s_xor_b32 s97, s41, 20864
s_waitcnt lgkmcnt(1)
buffer_store_dwordx4 a[248:251], v230, s[28:31], s97 offen sc1
s_xor_b32 s97, s41, 29056
s_waitcnt lgkmcnt(0)
buffer_store_dwordx4 a[252:255], v230, s[28:31], s97 offen sc1
L_end:
s_endpgm
.section .rodata,"a"
.p2align 6
.amdhsa_kernel standalone__mha_softmax__near_ridge_kernel
  .amdhsa_next_free_vgpr 512
  .amdhsa_next_free_sgpr 102
  .amdhsa_accum_offset 256
  .amdhsa_group_segment_fixed_size 0
  .amdhsa_kernarg_size 48
  .amdhsa_user_sgpr_count 2
  .amdhsa_user_sgpr_kernarg_segment_ptr 1
  .amdhsa_system_sgpr_workgroup_id_x 1
.end_amdhsa_kernel
```
